```python
import torch

def _softmax(x, axis=-1):
    return torch.softmax(x, dim=axis)
def _gelu(x):
    return torch.nn.functional.gelu(x, approximate="tanh")
def _silu(x):
    return torch.nn.functional.silu(x)
def _sigmoid(x):
    return torch.sigmoid(x)
def _layernorm(x, axis=-1, eps=1e-5):
    m = x.mean(dim=axis, keepdim=True)
    v = x.var(dim=axis, keepdim=True, unbiased=False)
    return (x - m) / torch.sqrt(v + eps)
def _scatter_add(tgt, idx, src, axis=0):
    return tgt.clone().index_add_(axis, idx, src)
def _segment_sum(src, seg, n):
    out = torch.zeros((n,) + src.shape[1:], dtype=src.dtype)
    return out.index_add_(0, seg, src)
def _pad(x, pw):
    flat = tuple(v for pair in reversed(pw) for v in pair)
    return torch.nn.functional.pad(x, flat)

kernel_name = 'sequential_preLN__softmax_full_mha__dense_activation_silu__prompt'

def setup_inputs():

    _w = (lambda a: (lambda t: t.to(torch.bfloat16) if t.is_floating_point() else t)(torch.as_tensor(a)))
    def _A_setup():
        B, S, D = 1, 2048, 640
        return {
            "x": _w((lambda *s: torch.randn(*s, dtype=torch.bfloat16) * 0.05)(B, S, D)),
            "wqkv": _w((lambda *s: torch.randn(*s, dtype=torch.bfloat16) * 0.05)(D, 3 * D)),
            "wo": _w((lambda *s: torch.randn(*s, dtype=torch.bfloat16) * 0.05)(D, D)),
        }
    _A_in = _A_setup()

    def _B_setup():
        B, S, D, F = 1, 2048, 640, 1536
        return {
            "x": _w((lambda *s: torch.randn(*s, dtype=torch.bfloat16) * 0.05)(B, S, D)),
            "w1": _w((lambda *s: torch.randn(*s, dtype=torch.bfloat16) * 3.2)(D, F) * (D ** -0.5)),
            "w2": _w((lambda *s: torch.randn(*s, dtype=torch.bfloat16) * 0.2)(F, D) * (F ** -0.5)),
        }
    _B_in = _B_setup()

    return {
        "A_x": _A_in["x"],
        "A_wqkv": _A_in["wqkv"],
        "A_wo": _A_in["wo"],
        "B_x": _B_in["x"],
        "B_w1": _B_in["w1"],
        "B_w2": _B_in["w2"],
    }

def reference(A_x, A_wqkv, A_wo, B_x, B_w1, B_w2):
    def _A_ref(x, wqkv, wo):
        B, S, D = x.shape
        H = 32; Dh = D // H
        qkv = (lambda x, *d: x.permute(*d))((x @ wqkv).reshape(B, S, 3, H, Dh), 2, 0, 3, 1, 4)
        q, k, v = qkv[0], qkv[1], qkv[2]
        scale = Dh ** -0.5
        scores = torch.einsum("bhqd,bhkd->bhqk", q, k) * scale
        p = _softmax(scores, axis=-1)
        o = torch.einsum("bhqk,bhkd->bhqd", p, v)
        return (lambda x, *d: x.permute(*d))(o, 0, 2, 1, 3).reshape(B, S, D) @ wo

    def _B_ref(x, w1, w2):
        h = torch.einsum("bsd,df->bsf", x, w1)
        h = _silu(h)
        out = torch.einsum("bsf,fd->bsd", h, w2)
        return out

    x = A_x
    h = x + _A_ref(_layernorm(x, axis=-1), A_wqkv, A_wo)
    h2 = h + _B_ref(_layernorm(h, axis=-1), B_w1, B_w2)
    return h2
```

```asm
; @launch grid=(256,1,1) block=(512,1,1) lds=163840
.amdgcn_target "amdgcn-amd-amdhsa--gfx950"
.text
.globl sequential_preLN__softmax_full_mha__dense_activation_silu__prompt_kernel
.p2align 8
.type sequential_preLN__softmax_full_mha__dense_activation_silu__prompt_kernel,@function
sequential_preLN__softmax_full_mha__dense_activation_silu__prompt_kernel:
    s_cmp_ge_u32 s2, 256
    s_cbranch_scc1 L_exit
    s_load_dwordx16 s[40:55], s[0:1], 0
    s_load_dwordx2 s[56:57], s[0:1], 64
    v_and_b32 v1, 63, v0
    v_lshrrev_b32 v3, 6, v0
    v_lshlrev_b32 v2, 4, v1
    v_readfirstlane_b32 s20, v3
    s_and_b32 s4, s2, 7
    s_lshr_b32 s5, s2, 3
    s_and_b32 s6, s4, 1
    s_lshr_b32 s4, s4, 1
    s_lshl_b32 s4, s4, 2
    s_mul_i32 s7, s5, 37
    s_lshr_b32 s7, s7, 8
    s_mul_i32 s31, s7, 7
    s_sub_u32 s31, s5, s31
    s_add_u32 s31, s31, 8
    s_lshr_b32 s32, s5, 3
    s_and_b32 s33, s5, 7
    s_cmp_eq_u32 s6, 0
    s_cselect_b32 s24, s33, s31
    s_cselect_b32 s7, s32, s7
    s_add_u32 s23, s4, s7
    s_lshr_b32 s22, s20, 2
    s_and_b32 s21, s20, 3
    s_mov_b32 s71, 0
    s_mov_b32 s72, 0
    s_mov_b32 s83, 0
    s_mov_b32 s85, 0
    s_mov_b32 s30, 0xffff0000
    s_cmp_ge_u32 s5, 28
    s_cselect_b32 s39, s6, 0
    s_sub_u32 s68, s5, 28
    s_add_u32 s68, s68, s4
    s_mul_i32 s25, s24, 52
    s_lshr_b32 s25, s25, 8
    v_lshrrev_b32 v3, 2, v1
    v_and_b32 v3, 7, v3
    v_lshrrev_b32 v5, 5, v1
    v_lshlrev_b32 v5, 6, v5
    v_and_b32 v4, 3, v1
    v_lshl_add_u32 v5, v4, 4, v5
    s_lshl_b32 s31, s21, 5
    v_add_u32 v6, s31, v3
    v_mul_u32_u24 v6, 1280, v6
    v_add_u32 v8, v6, v5
    v_add_u32 v9, 10240, v8
    v_add_u32 v10, 20480, v8
    v_add_u32 v11, 30720, v8
    v_lshrrev_b32 v4, 4, v1
    v_lshlrev_b32 v5, 2, v4
    v_and_b32 v6, 15, v1
    v_xor_b32 v5, v5, v6
    v_lshlrev_b32 v5, 4, v5
    s_lshl_b32 s31, s21, 4
    v_add_u32 v6, s31, v4
    v_mul_u32_u24 v6, 3840, v6
    v_add_u32 v12, v6, v5
    v_add_u32 v13, 15360, v12
    v_add_u32 v14, 30720, v12
    v_add_u32 v15, 46080, v12
    s_mul_i32 s26, s23, 163840
    s_lshl_b32 s27, s24, 8
    s_lshl_b32 s37, s21, 12
    s_mul_i32 s38, s21, 4160
    s_waitcnt lgkmcnt(0)
    s_mov_b32 s8, s40
    s_and_b32 s9, s41, 0xffff
    s_mov_b32 s10, 2621440
    s_mov_b32 s11, 0x00020000
    s_mov_b32 s12, s42
    s_and_b32 s13, s43, 0xffff
    s_mov_b32 s14, 2457600
    s_mov_b32 s15, 0x00020000
    s_mov_b32 s16, s56
    s_and_b32 s17, s57, 0xffff
    s_mov_b32 s18, 24473600
    s_mov_b32 s19, 0x00020000
    s_cmp_eq_u32 s39, 1
    s_cbranch_scc1 L_p1_rowstats
    s_cmp_eq_u32 s22, 0
    s_cbranch_scc1 L_p1_compute
    s_cmp_lg_u32 s21, 0
    s_cbranch_scc1 L_p1_noctl
    v_mov_b32 v3, 163648
    v_mov_b32 v4, 0
    v_mov_b32 v5, 0
    ds_write_b64 v3, v[4:5] offset:0
    ds_write_b64 v3, v[4:5] offset:8
    ds_write_b64 v3, v[4:5] offset:16
    ds_write_b64 v3, v[4:5] offset:24
    ds_write_b64 v3, v[4:5] offset:32
L_p1_noctl:
    s_add_u32 m0, s38, 0
    s_nop 0
    buffer_load_dwordx4 v8, s[8:11], s26 offen lds
    s_add_u32 m0, s38, 1040
    s_nop 0
    buffer_load_dwordx4 v9, s[8:11], s26 offen lds
    s_add_u32 m0, s38, 2080
    s_nop 0
    buffer_load_dwordx4 v10, s[8:11], s26 offen lds
    s_add_u32 m0, s38, 3120
    s_nop 0
    buffer_load_dwordx4 v11, s[8:11], s26 offen lds
    s_add_u32 m0, s37, 16640
    s_nop 0
    buffer_load_dwordx4 v12, s[12:15], s27 offen lds
    s_add_u32 m0, s37, 17664
    s_nop 0
    buffer_load_dwordx4 v13, s[12:15], s27 offen lds
    s_add_u32 m0, s37, 18688
    s_nop 0
    buffer_load_dwordx4 v14, s[12:15], s27 offen lds
    s_add_u32 m0, s37, 19712
    s_nop 0
    buffer_load_dwordx4 v15, s[12:15], s27 offen lds
    s_add_u32 s26, s26, 128
    s_add_u32 s27, s27, 245760
    s_add_u32 m0, s38, 33024
    s_nop 0
    buffer_load_dwordx4 v8, s[8:11], s26 offen lds
    s_add_u32 m0, s38, 34064
    s_nop 0
    buffer_load_dwordx4 v9, s[8:11], s26 offen lds
    s_add_u32 m0, s38, 35104
    s_nop 0
    buffer_load_dwordx4 v10, s[8:11], s26 offen lds
    s_add_u32 m0, s38, 36144
    s_nop 0
    buffer_load_dwordx4 v11, s[8:11], s26 offen lds
    v_mov_b32 v16, 0
    v_mov_b32 v17, 0
    v_mov_b32 v18, 0
    v_mov_b32 v19, 0
    v_mov_b32 v20, 0
    v_mov_b32 v21, 0
    v_mov_b32 v22, 0
    v_mov_b32 v23, 0
    v_add_u32 v42, s37, v2
    v_add_u32 v43, 66048, v42
    s_lshl_b32 s31, s23, 2
    s_add_u32 s31, s31, 0
    v_mov_b32 v46, s31
    v_mov_b32 v3, 64
    v_cmp_eq_u32 vcc, 1, v1
    s_nop 1
    v_cndmask_b32 v46, v46, v3, vcc
    v_and_b32 v3, 31, v1
    s_lshl_b32 s31, s23, 7
    s_lshl_b32 s32, s21, 5
    s_add_u32 s31, s31, s32
    v_add_u32 v47, s31, v3
    v_lshlrev_b32 v47, 3, v47
    s_mov_b32 s69, 24457216
    s_mul_i32 s71, s23, 15
    s_add_u32 s71, s71, s24
    s_lshl_b32 s71, s71, 2
    s_add_u32 s71, s71, s21
    s_lshl_b32 s72, s21, 12
    s_add_u32 s72, s72, 141824
    s_mov_b32 s60, s48
    s_and_b32 s61, s49, 0xffff
    s_mov_b32 s62, 1966080
    s_mov_b32 s63, 0x00020000
    s_mov_b32 s64, s50
    s_and_b32 s65, s51, 0xffff
    s_mov_b32 s66, 1966080
    s_mov_b32 s67, 0x00020000
    s_waitcnt vmcnt(4) lgkmcnt(0)
    s_barrier
    s_add_u32 m0, s37, 49664
    s_nop 0
    buffer_load_dwordx4 v12, s[12:15], s27 offen lds
    s_add_u32 m0, s37, 50688
    s_nop 0
    buffer_load_dwordx4 v13, s[12:15], s27 offen lds
    s_add_u32 m0, s37, 51712
    s_nop 0
    buffer_load_dwordx4 v14, s[12:15], s27 offen lds
    s_add_u32 m0, s37, 52736
    s_nop 0
    buffer_load_dwordx4 v15, s[12:15], s27 offen lds
    s_add_u32 s26, s26, 128
    s_add_u32 s27, s27, 245760
    s_add_u32 m0, s38, 66048
    s_nop 0
    buffer_load_dwordx4 v8, s[8:11], s26 offen lds
    ds_read_b128 v[24:27], v42 offset:16640
    ds_read_b128 v[28:31], v42 offset:17664
    ds_read_b128 v[32:35], v42 offset:18688
    ds_read_b128 v[36:39], v42 offset:19712
    s_waitcnt lgkmcnt(0)
    v_lshlrev_b32 v40, 16, v24
    v_and_b32 v41, s30, v24
    v_add_f32 v16, v16, v40
    v_add_f32 v17, v17, v41
    s_add_u32 m0, s38, 67088
    s_nop 0
    buffer_load_dwordx4 v9, s[8:11], s26 offen lds
    v_lshlrev_b32 v40, 16, v25
    v_and_b32 v41, s30, v25
    v_add_f32 v18, v18, v40
    v_add_f32 v19, v19, v41
    v_lshlrev_b32 v40, 16, v26
    v_and_b32 v41, s30, v26
    v_add_f32 v20, v20, v40
    v_add_f32 v21, v21, v41
    v_lshlrev_b32 v40, 16, v27
    s_add_u32 m0, s38, 68128
    s_nop 0
    buffer_load_dwordx4 v10, s[8:11], s26 offen lds
    v_and_b32 v41, s30, v27
    v_add_f32 v22, v22, v40
    v_add_f32 v23, v23, v41
    v_lshlrev_b32 v40, 16, v28
    v_and_b32 v41, s30, v28
    v_add_f32 v16, v16, v40
    v_add_f32 v17, v17, v41
    v_lshlrev_b32 v40, 16, v29
    v_and_b32 v41, s30, v29
    s_add_u32 m0, s38, 69168
    s_nop 0
    buffer_load_dwordx4 v11, s[8:11], s26 offen lds
    v_add_f32 v18, v18, v40
    v_add_f32 v19, v19, v41
    v_lshlrev_b32 v40, 16, v30
    v_and_b32 v41, s30, v30
    v_add_f32 v20, v20, v40
    v_add_f32 v21, v21, v41
    v_lshlrev_b32 v40, 16, v31
    v_and_b32 v41, s30, v31
    v_add_f32 v22, v22, v40
    s_add_u32 m0, s37, 82688
    s_nop 0
    buffer_load_dwordx4 v12, s[12:15], s27 offen lds
    v_add_f32 v23, v23, v41
    v_lshlrev_b32 v40, 16, v32
    v_and_b32 v41, s30, v32
    v_add_f32 v16, v16, v40
    v_add_f32 v17, v17, v41
    v_lshlrev_b32 v40, 16, v33
    v_and_b32 v41, s30, v33
    v_add_f32 v18, v18, v40
    v_add_f32 v19, v19, v41
    s_add_u32 m0, s37, 83712
    s_nop 0
    buffer_load_dwordx4 v13, s[12:15], s27 offen lds
    v_lshlrev_b32 v40, 16, v34
    v_and_b32 v41, s30, v34
    v_add_f32 v20, v20, v40
    v_add_f32 v21, v21, v41
    v_lshlrev_b32 v40, 16, v35
    v_and_b32 v41, s30, v35
    v_add_f32 v22, v22, v40
    v_add_f32 v23, v23, v41
    s_add_u32 m0, s37, 84736
    s_nop 0
    buffer_load_dwordx4 v14, s[12:15], s27 offen lds
    v_lshlrev_b32 v40, 16, v36
    v_and_b32 v41, s30, v36
    v_add_f32 v16, v16, v40
    v_add_f32 v17, v17, v41
    v_lshlrev_b32 v40, 16, v37
    v_and_b32 v41, s30, v37
    v_add_f32 v18, v18, v40
    v_add_f32 v19, v19, v41
    s_add_u32 m0, s37, 85760
    s_nop 0
    buffer_load_dwordx4 v15, s[12:15], s27 offen lds
    s_add_u32 s26, s26, 128
    s_add_u32 s27, s27, 245760
    v_lshlrev_b32 v40, 16, v38
    v_and_b32 v41, s30, v38
    v_add_f32 v20, v20, v40
    v_add_f32 v21, v21, v41
    v_lshlrev_b32 v40, 16, v39
    v_and_b32 v41, s30, v39
    v_add_f32 v22, v22, v40
    v_add_f32 v23, v23, v41
    s_add_u32 m0, s38, 99072
    s_nop 0
    buffer_load_dwordx4 v8, s[8:11], s26 offen lds
    s_add_u32 m0, s38, 100112
    s_nop 0
    buffer_load_dwordx4 v9, s[8:11], s26 offen lds
    s_add_u32 m0, s38, 101152
    s_nop 0
    buffer_load_dwordx4 v10, s[8:11], s26 offen lds
    s_add_u32 m0, s38, 102192
    s_nop 0
    buffer_load_dwordx4 v11, s[8:11], s26 offen lds
    s_add_u32 m0, s37, 115712
    s_nop 0
    buffer_load_dwordx4 v12, s[12:15], s27 offen lds
    s_add_u32 m0, s37, 116736
    s_nop 0
    buffer_load_dwordx4 v13, s[12:15], s27 offen lds
    s_add_u32 m0, s37, 117760
    s_nop 0
    buffer_load_dwordx4 v14, s[12:15], s27 offen lds
    s_add_u32 m0, s37, 118784
    s_nop 0
    buffer_load_dwordx4 v15, s[12:15], s27 offen lds
    s_add_u32 s26, s26, 128
    s_add_u32 s27, s27, 245760
    s_waitcnt vmcnt(16)
    s_barrier
    s_add_u32 m0, s38, 0
    s_nop 0
    buffer_load_dwordx4 v8, s[8:11], s26 offen lds
    ds_read_b128 v[24:27], v42 offset:49664
    ds_read_b128 v[28:31], v42 offset:50688
    ds_read_b128 v[32:35], v42 offset:51712
    ds_read_b128 v[36:39], v42 offset:52736
    s_waitcnt lgkmcnt(0)
    v_lshlrev_b32 v40, 16, v24
    v_and_b32 v41, s30, v24
    v_add_f32 v16, v16, v40
    v_add_f32 v17, v17, v41
    s_add_u32 m0, s38, 1040
    s_nop 0
    buffer_load_dwordx4 v9, s[8:11], s26 offen lds
    v_lshlrev_b32 v40, 16, v25
    v_and_b32 v41, s30, v25
    v_add_f32 v18, v18, v40
    v_add_f32 v19, v19, v41
    v_lshlrev_b32 v40, 16, v26
    v_and_b32 v41, s30, v26
    v_add_f32 v20, v20, v40
    v_add_f32 v21, v21, v41
    v_lshlrev_b32 v40, 16, v27
    s_add_u32 m0, s38, 2080
    s_nop 0
    buffer_load_dwordx4 v10, s[8:11], s26 offen lds
    v_and_b32 v41, s30, v27
    v_add_f32 v22, v22, v40
    v_add_f32 v23, v23, v41
    v_lshlrev_b32 v40, 16, v28
    v_and_b32 v41, s30, v28
    v_add_f32 v16, v16, v40
    v_add_f32 v17, v17, v41
    v_lshlrev_b32 v40, 16, v29
    v_and_b32 v41, s30, v29
    s_add_u32 m0, s38, 3120
    s_nop 0
    buffer_load_dwordx4 v11, s[8:11], s26 offen lds
    v_add_f32 v18, v18, v40
    v_add_f32 v19, v19, v41
    v_lshlrev_b32 v40, 16, v30
    v_and_b32 v41, s30, v30
    v_add_f32 v20, v20, v40
    v_add_f32 v21, v21, v41
    v_lshlrev_b32 v40, 16, v31
    v_and_b32 v41, s30, v31
    v_add_f32 v22, v22, v40
    s_add_u32 m0, s37, 16640
    s_nop 0
    buffer_load_dwordx4 v12, s[12:15], s27 offen lds
    v_add_f32 v23, v23, v41
    v_lshlrev_b32 v40, 16, v32
    v_and_b32 v41, s30, v32
    v_add_f32 v16, v16, v40
    v_add_f32 v17, v17, v41
    v_lshlrev_b32 v40, 16, v33
    v_and_b32 v41, s30, v33
    v_add_f32 v18, v18, v40
    v_add_f32 v19, v19, v41
    s_add_u32 m0, s37, 17664
    s_nop 0
    buffer_load_dwordx4 v13, s[12:15], s27 offen lds
    v_lshlrev_b32 v40, 16, v34
    v_and_b32 v41, s30, v34
    v_add_f32 v20, v20, v40
    v_add_f32 v21, v21, v41
    v_lshlrev_b32 v40, 16, v35
    v_and_b32 v41, s30, v35
    v_add_f32 v22, v22, v40
    v_add_f32 v23, v23, v41
    s_add_u32 m0, s37, 18688
    s_nop 0
    buffer_load_dwordx4 v14, s[12:15], s27 offen lds
    v_lshlrev_b32 v40, 16, v36
    v_and_b32 v41, s30, v36
    v_add_f32 v16, v16, v40
    v_add_f32 v17, v17, v41
    v_lshlrev_b32 v40, 16, v37
    v_and_b32 v41, s30, v37
    v_add_f32 v18, v18, v40
    v_add_f32 v19, v19, v41
    s_add_u32 m0, s37, 19712
    s_nop 0
    buffer_load_dwordx4 v15, s[12:15], s27 offen lds
    s_add_u32 s26, s26, 128
    s_add_u32 s27, s27, 245760
    v_lshlrev_b32 v40, 16, v38
    v_and_b32 v41, s30, v38
    v_add_f32 v20, v20, v40
    v_add_f32 v21, v21, v41
    v_lshlrev_b32 v40, 16, v39
    v_and_b32 v41, s30, v39
    v_add_f32 v22, v22, v40
    v_add_f32 v23, v23, v41
    s_waitcnt vmcnt(16)
    s_barrier
    s_add_u32 m0, s38, 33024
    s_nop 0
    buffer_load_dwordx4 v8, s[8:11], s26 offen lds
    ds_read_b128 v[24:27], v43 offset:16640
    ds_read_b128 v[28:31], v43 offset:17664
    ds_read_b128 v[32:35], v43 offset:18688
    ds_read_b128 v[36:39], v43 offset:19712
    s_waitcnt lgkmcnt(0)
    v_lshlrev_b32 v40, 16, v24
    v_and_b32 v41, s30, v24
    v_add_f32 v16, v16, v40
    v_add_f32 v17, v17, v41
    s_add_u32 m0, s38, 34064
    s_nop 0
    buffer_load_dwordx4 v9, s[8:11], s26 offen lds
    v_lshlrev_b32 v40, 16, v25
    v_and_b32 v41, s30, v25
    v_add_f32 v18, v18, v40
    v_add_f32 v19, v19, v41
    v_lshlrev_b32 v40, 16, v26
    v_and_b32 v41, s30, v26
    v_add_f32 v20, v20, v40
    v_add_f32 v21, v21, v41
    v_lshlrev_b32 v40, 16, v27
    s_add_u32 m0, s38, 35104
    s_nop 0
    buffer_load_dwordx4 v10, s[8:11], s26 offen lds
    v_and_b32 v41, s30, v27
    v_add_f32 v22, v22, v40
    v_add_f32 v23, v23, v41
    v_lshlrev_b32 v40, 16, v28
    v_and_b32 v41, s30, v28
    v_add_f32 v16, v16, v40
    v_add_f32 v17, v17, v41
    v_lshlrev_b32 v40, 16, v29
    v_and_b32 v41, s30, v29
    s_add_u32 m0, s38, 36144
    s_nop 0
    buffer_load_dwordx4 v11, s[8:11], s26 offen lds
    v_add_f32 v18, v18, v40
    v_add_f32 v19, v19, v41
    v_lshlrev_b32 v40, 16, v30
    v_and_b32 v41, s30, v30
    v_add_f32 v20, v20, v40
    v_add_f32 v21, v21, v41
    v_lshlrev_b32 v40, 16, v31
    v_and_b32 v41, s30, v31
    v_add_f32 v22, v22, v40
    s_add_u32 m0, s37, 49664
    s_nop 0
    buffer_load_dwordx4 v12, s[12:15], s27 offen lds
    v_add_f32 v23, v23, v41
    v_lshlrev_b32 v40, 16, v32
    v_and_b32 v41, s30, v32
    v_add_f32 v16, v16, v40
    v_add_f32 v17, v17, v41
    v_lshlrev_b32 v40, 16, v33
    v_and_b32 v41, s30, v33
    v_add_f32 v18, v18, v40
    v_add_f32 v19, v19, v41
    s_add_u32 m0, s37, 50688
    s_nop 0
    buffer_load_dwordx4 v13, s[12:15], s27 offen lds
    v_lshlrev_b32 v40, 16, v34
    v_and_b32 v41, s30, v34
    v_add_f32 v20, v20, v40
    v_add_f32 v21, v21, v41
    v_lshlrev_b32 v40, 16, v35
    v_and_b32 v41, s30, v35
    v_add_f32 v22, v22, v40
    v_add_f32 v23, v23, v41
    s_add_u32 m0, s37, 51712
    s_nop 0
    buffer_load_dwordx4 v14, s[12:15], s27 offen lds
    v_lshlrev_b32 v40, 16, v36
    v_and_b32 v41, s30, v36
    v_add_f32 v16, v16, v40
    v_add_f32 v17, v17, v41
    v_lshlrev_b32 v40, 16, v37
    v_and_b32 v41, s30, v37
    v_add_f32 v18, v18, v40
    v_add_f32 v19, v19, v41
    s_add_u32 m0, s37, 52736
    s_nop 0
    buffer_load_dwordx4 v15, s[12:15], s27 offen lds
    s_add_u32 s26, s26, 128
    s_add_u32 s27, s27, 245760
    v_lshlrev_b32 v40, 16, v38
    v_and_b32 v41, s30, v38
    v_add_f32 v20, v20, v40
    v_add_f32 v21, v21, v41
    v_lshlrev_b32 v40, 16, v39
    v_and_b32 v41, s30, v39
    v_add_f32 v22, v22, v40
    v_add_f32 v23, v23, v41
    s_waitcnt vmcnt(16)
    s_barrier
    s_add_u32 m0, s38, 66048
    s_nop 0
    buffer_load_dwordx4 v8, s[8:11], s26 offen lds
    ds_read_b128 v[24:27], v43 offset:49664
    ds_read_b128 v[28:31], v43 offset:50688
    ds_read_b128 v[32:35], v43 offset:51712
    ds_read_b128 v[36:39], v43 offset:52736
    s_waitcnt lgkmcnt(0)
    v_lshlrev_b32 v40, 16, v24
    v_and_b32 v41, s30, v24
    v_add_f32 v16, v16, v40
    v_add_f32 v17, v17, v41
    s_add_u32 m0, s38, 67088
    s_nop 0
    buffer_load_dwordx4 v9, s[8:11], s26 offen lds
    v_lshlrev_b32 v40, 16, v25
    v_and_b32 v41, s30, v25
    v_add_f32 v18, v18, v40
    v_add_f32 v19, v19, v41
    v_lshlrev_b32 v40, 16, v26
    v_and_b32 v41, s30, v26
    v_add_f32 v20, v20, v40
    v_add_f32 v21, v21, v41
    v_lshlrev_b32 v40, 16, v27
    s_add_u32 m0, s38, 68128
    s_nop 0
    buffer_load_dwordx4 v10, s[8:11], s26 offen lds
    v_and_b32 v41, s30, v27
    v_add_f32 v22, v22, v40
    v_add_f32 v23, v23, v41
    v_lshlrev_b32 v40, 16, v28
    v_and_b32 v41, s30, v28
    v_add_f32 v16, v16, v40
    v_add_f32 v17, v17, v41
    v_lshlrev_b32 v40, 16, v29
    v_and_b32 v41, s30, v29
    s_add_u32 m0, s38, 69168
    s_nop 0
    buffer_load_dwordx4 v11, s[8:11], s26 offen lds
    v_add_f32 v18, v18, v40
    v_add_f32 v19, v19, v41
    v_lshlrev_b32 v40, 16, v30
    v_and_b32 v41, s30, v30
    v_add_f32 v20, v20, v40
    v_add_f32 v21, v21, v41
    v_lshlrev_b32 v40, 16, v31
    v_and_b32 v41, s30, v31
    v_add_f32 v22, v22, v40
    s_add_u32 m0, s37, 82688
    s_nop 0
    buffer_load_dwordx4 v12, s[12:15], s27 offen lds
    v_add_f32 v23, v23, v41
    v_lshlrev_b32 v40, 16, v32
    v_and_b32 v41, s30, v32
    v_add_f32 v16, v16, v40
    v_add_f32 v17, v17, v41
    v_lshlrev_b32 v40, 16, v33
    v_and_b32 v41, s30, v33
    v_add_f32 v18, v18, v40
    v_add_f32 v19, v19, v41
    s_add_u32 m0, s37, 83712
    s_nop 0
    buffer_load_dwordx4 v13, s[12:15], s27 offen lds
    v_lshlrev_b32 v40, 16, v34
    v_and_b32 v41, s30, v34
    v_add_f32 v20, v20, v40
    v_add_f32 v21, v21, v41
    v_lshlrev_b32 v40, 16, v35
    v_and_b32 v41, s30, v35
    v_add_f32 v22, v22, v40
    v_add_f32 v23, v23, v41
    s_add_u32 m0, s37, 84736
    s_nop 0
    buffer_load_dwordx4 v14, s[12:15], s27 offen lds
    v_lshlrev_b32 v40, 16, v36
    v_and_b32 v41, s30, v36
    v_add_f32 v16, v16, v40
    v_add_f32 v17, v17, v41
    v_lshlrev_b32 v40, 16, v37
    v_and_b32 v41, s30, v37
    v_add_f32 v18, v18, v40
    v_add_f32 v19, v19, v41
    s_add_u32 m0, s37, 85760
    s_nop 0
    buffer_load_dwordx4 v15, s[12:15], s27 offen lds
    s_add_u32 s26, s26, 128
    s_add_u32 s27, s27, 245760
    v_lshlrev_b32 v40, 16, v38
    v_and_b32 v41, s30, v38
    v_add_f32 v20, v20, v40
    v_add_f32 v21, v21, v41
    v_lshlrev_b32 v40, 16, v39
    v_and_b32 v41, s30, v39
    v_add_f32 v22, v22, v40
    v_add_f32 v23, v23, v41
    s_waitcnt vmcnt(16)
    s_barrier
    s_add_u32 m0, s38, 99072
    s_nop 0
    buffer_load_dwordx4 v8, s[8:11], s26 offen lds
    ds_read_b128 v[24:27], v42 offset:16640
    ds_read_b128 v[28:31], v42 offset:17664
    ds_read_b128 v[32:35], v42 offset:18688
    ds_read_b128 v[36:39], v42 offset:19712
    s_waitcnt lgkmcnt(0)
    v_lshlrev_b32 v40, 16, v24
    v_and_b32 v41, s30, v24
    v_add_f32 v16, v16, v40
    v_add_f32 v17, v17, v41
    s_add_u32 m0, s38, 100112
    s_nop 0
    buffer_load_dwordx4 v9, s[8:11], s26 offen lds
    v_lshlrev_b32 v40, 16, v25
    v_and_b32 v41, s30, v25
    v_add_f32 v18, v18, v40
    v_add_f32 v19, v19, v41
    v_lshlrev_b32 v40, 16, v26
    v_and_b32 v41, s30, v26
    v_add_f32 v20, v20, v40
    v_add_f32 v21, v21, v41
    v_lshlrev_b32 v40, 16, v27
    s_add_u32 m0, s38, 101152
    s_nop 0
    buffer_load_dwordx4 v10, s[8:11], s26 offen lds
    v_and_b32 v41, s30, v27
    v_add_f32 v22, v22, v40
    v_add_f32 v23, v23, v41
    v_lshlrev_b32 v40, 16, v28
    v_and_b32 v41, s30, v28
    v_add_f32 v16, v16, v40
    v_add_f32 v17, v17, v41
    v_lshlrev_b32 v40, 16, v29
    v_and_b32 v41, s30, v29
    s_add_u32 m0, s38, 102192
    s_nop 0
    buffer_load_dwordx4 v11, s[8:11], s26 offen lds
    v_add_f32 v18, v18, v40
    v_add_f32 v19, v19, v41
    v_lshlrev_b32 v40, 16, v30
    v_and_b32 v41, s30, v30
    v_add_f32 v20, v20, v40
    v_add_f32 v21, v21, v41
    v_lshlrev_b32 v40, 16, v31
    v_and_b32 v41, s30, v31
    v_add_f32 v22, v22, v40
    s_add_u32 m0, s37, 115712
    s_nop 0
    buffer_load_dwordx4 v12, s[12:15], s27 offen lds
    v_add_f32 v23, v23, v41
    v_lshlrev_b32 v40, 16, v32
    v_and_b32 v41, s30, v32
    v_add_f32 v16, v16, v40
    v_add_f32 v17, v17, v41
    v_lshlrev_b32 v40, 16, v33
    v_and_b32 v41, s30, v33
    v_add_f32 v18, v18, v40
    v_add_f32 v19, v19, v41
    s_add_u32 m0, s37, 116736
    s_nop 0
    buffer_load_dwordx4 v13, s[12:15], s27 offen lds
    v_lshlrev_b32 v40, 16, v34
    v_and_b32 v41, s30, v34
    v_add_f32 v20, v20, v40
    v_add_f32 v21, v21, v41
    v_lshlrev_b32 v40, 16, v35
    v_and_b32 v41, s30, v35
    v_add_f32 v22, v22, v40
    v_add_f32 v23, v23, v41
    s_add_u32 m0, s37, 117760
    s_nop 0
    buffer_load_dwordx4 v14, s[12:15], s27 offen lds
    v_lshlrev_b32 v40, 16, v36
    v_and_b32 v41, s30, v36
    v_add_f32 v16, v16, v40
    v_add_f32 v17, v17, v41
    v_lshlrev_b32 v40, 16, v37
    v_and_b32 v41, s30, v37
    v_add_f32 v18, v18, v40
    v_add_f32 v19, v19, v41
    s_add_u32 m0, s37, 118784
    s_nop 0
    buffer_load_dwordx4 v15, s[12:15], s27 offen lds
    s_add_u32 s26, s26, 128
    s_add_u32 s27, s27, 245760
    v_lshlrev_b32 v40, 16, v38
    v_and_b32 v41, s30, v38
    v_add_f32 v20, v20, v40
    v_add_f32 v21, v21, v41
    v_lshlrev_b32 v40, 16, v39
    v_and_b32 v41, s30, v39
    v_add_f32 v22, v22, v40
    v_add_f32 v23, v23, v41
    s_waitcnt vmcnt(16)
    s_barrier
    s_add_u32 m0, s38, 0
    s_nop 0
    buffer_load_dwordx4 v8, s[8:11], s26 offen lds
    ds_read_b128 v[24:27], v42 offset:49664
    ds_read_b128 v[28:31], v42 offset:50688
    ds_read_b128 v[32:35], v42 offset:51712
    ds_read_b128 v[36:39], v42 offset:52736
    s_waitcnt lgkmcnt(0)
    v_lshlrev_b32 v40, 16, v24
    v_and_b32 v41, s30, v24
    v_add_f32 v16, v16, v40
    v_add_f32 v17, v17, v41
    s_add_u32 m0, s38, 1040
    s_nop 0
    buffer_load_dwordx4 v9, s[8:11], s26 offen lds
    v_lshlrev_b32 v40, 16, v25
    v_and_b32 v41, s30, v25
    v_add_f32 v18, v18, v40
    v_add_f32 v19, v19, v41
    v_lshlrev_b32 v40, 16, v26
    v_and_b32 v41, s30, v26
    v_add_f32 v20, v20, v40
    v_add_f32 v21, v21, v41
    v_lshlrev_b32 v40, 16, v27
    s_add_u32 m0, s38, 2080
    s_nop 0
    buffer_load_dwordx4 v10, s[8:11], s26 offen lds
    v_and_b32 v41, s30, v27
    v_add_f32 v22, v22, v40
    v_add_f32 v23, v23, v41
    v_lshlrev_b32 v40, 16, v28
    v_and_b32 v41, s30, v28
    v_add_f32 v16, v16, v40
    v_add_f32 v17, v17, v41
    v_lshlrev_b32 v40, 16, v29
    v_and_b32 v41, s30, v29
    s_add_u32 m0, s38, 3120
    s_nop 0
    buffer_load_dwordx4 v11, s[8:11], s26 offen lds
    v_add_f32 v18, v18, v40
    v_add_f32 v19, v19, v41
    v_lshlrev_b32 v40, 16, v30
    v_and_b32 v41, s30, v30
    v_add_f32 v20, v20, v40
    v_add_f32 v21, v21, v41
    v_lshlrev_b32 v40, 16, v31
    v_and_b32 v41, s30, v31
    v_add_f32 v22, v22, v40
    s_add_u32 m0, s37, 16640
    s_nop 0
    buffer_load_dwordx4 v12, s[12:15], s27 offen lds
    v_add_f32 v23, v23, v41
    v_lshlrev_b32 v40, 16, v32
    v_and_b32 v41, s30, v32
    v_add_f32 v16, v16, v40
    v_add_f32 v17, v17, v41
    v_lshlrev_b32 v40, 16, v33
    v_and_b32 v41, s30, v33
    v_add_f32 v18, v18, v40
    v_add_f32 v19, v19, v41
    s_add_u32 m0, s37, 17664
    s_nop 0
    buffer_load_dwordx4 v13, s[12:15], s27 offen lds
    v_lshlrev_b32 v40, 16, v34
    v_and_b32 v41, s30, v34
    v_add_f32 v20, v20, v40
    v_add_f32 v21, v21, v41
    v_lshlrev_b32 v40, 16, v35
    v_and_b32 v41, s30, v35
    v_add_f32 v22, v22, v40
    v_add_f32 v23, v23, v41
    s_add_u32 m0, s37, 18688
    s_nop 0
    buffer_load_dwordx4 v14, s[12:15], s27 offen lds
    v_lshlrev_b32 v40, 16, v36
    v_and_b32 v41, s30, v36
    v_add_f32 v16, v16, v40
    v_add_f32 v17, v17, v41
    v_lshlrev_b32 v40, 16, v37
    v_and_b32 v41, s30, v37
    v_add_f32 v18, v18, v40
    v_add_f32 v19, v19, v41
    s_add_u32 m0, s37, 19712
    s_nop 0
    buffer_load_dwordx4 v15, s[12:15], s27 offen lds
    s_add_u32 s26, s26, 128
    s_add_u32 s27, s27, 245760
    v_lshlrev_b32 v40, 16, v38
    v_and_b32 v41, s30, v38
    v_add_f32 v20, v20, v40
    v_add_f32 v21, v21, v41
    v_lshlrev_b32 v40, 16, v39
    v_and_b32 v41, s30, v39
    v_add_f32 v22, v22, v40
    v_add_f32 v23, v23, v41
    s_waitcnt vmcnt(16)
    s_barrier
    global_load_dword v48, v46, s[54:55] sc1
    s_add_u32 m0, s38, 33024
    s_nop 0
    buffer_load_dwordx4 v8, s[8:11], s26 offen lds
    ds_read_b128 v[24:27], v43 offset:16640
    ds_read_b128 v[28:31], v43 offset:17664
    ds_read_b128 v[32:35], v43 offset:18688
    ds_read_b128 v[36:39], v43 offset:19712
    s_waitcnt lgkmcnt(0)
    v_lshlrev_b32 v40, 16, v24
    v_and_b32 v41, s30, v24
    v_add_f32 v16, v16, v40
    v_add_f32 v17, v17, v41
    s_add_u32 m0, s38, 34064
    s_nop 0
    buffer_load_dwordx4 v9, s[8:11], s26 offen lds
    v_lshlrev_b32 v40, 16, v25
    v_and_b32 v41, s30, v25
    v_add_f32 v18, v18, v40
    v_add_f32 v19, v19, v41
    v_lshlrev_b32 v40, 16, v26
    v_and_b32 v41, s30, v26
    v_add_f32 v20, v20, v40
    v_add_f32 v21, v21, v41
    v_lshlrev_b32 v40, 16, v27
    s_add_u32 m0, s38, 35104
    s_nop 0
    buffer_load_dwordx4 v10, s[8:11], s26 offen lds
    v_and_b32 v41, s30, v27
    v_add_f32 v22, v22, v40
    v_add_f32 v23, v23, v41
    v_lshlrev_b32 v40, 16, v28
    v_and_b32 v41, s30, v28
    v_add_f32 v16, v16, v40
    v_add_f32 v17, v17, v41
    v_lshlrev_b32 v40, 16, v29
    v_and_b32 v41, s30, v29
    s_add_u32 m0, s38, 36144
    s_nop 0
    buffer_load_dwordx4 v11, s[8:11], s26 offen lds
    v_add_f32 v18, v18, v40
    v_add_f32 v19, v19, v41
    v_lshlrev_b32 v40, 16, v30
    v_and_b32 v41, s30, v30
    v_add_f32 v20, v20, v40
    v_add_f32 v21, v21, v41
    v_lshlrev_b32 v40, 16, v31
    v_and_b32 v41, s30, v31
    v_add_f32 v22, v22, v40
    s_add_u32 m0, s37, 49664
    s_nop 0
    buffer_load_dwordx4 v12, s[12:15], s27 offen lds
    v_add_f32 v23, v23, v41
    v_lshlrev_b32 v40, 16, v32
    v_and_b32 v41, s30, v32
    v_add_f32 v16, v16, v40
    v_add_f32 v17, v17, v41
    v_lshlrev_b32 v40, 16, v33
    v_and_b32 v41, s30, v33
    v_add_f32 v18, v18, v40
    v_add_f32 v19, v19, v41
    s_add_u32 m0, s37, 50688
    s_nop 0
    buffer_load_dwordx4 v13, s[12:15], s27 offen lds
    v_lshlrev_b32 v40, 16, v34
    v_and_b32 v41, s30, v34
    v_add_f32 v20, v20, v40
    v_add_f32 v21, v21, v41
    v_lshlrev_b32 v40, 16, v35
    v_and_b32 v41, s30, v35
    v_add_f32 v22, v22, v40
    v_add_f32 v23, v23, v41
    s_add_u32 m0, s37, 51712
    s_nop 0
    buffer_load_dwordx4 v14, s[12:15], s27 offen lds
    v_lshlrev_b32 v40, 16, v36
    v_and_b32 v41, s30, v36
    v_add_f32 v16, v16, v40
    v_add_f32 v17, v17, v41
    v_lshlrev_b32 v40, 16, v37
    v_and_b32 v41, s30, v37
    v_add_f32 v18, v18, v40
    v_add_f32 v19, v19, v41
    s_add_u32 m0, s37, 52736
    s_nop 0
    buffer_load_dwordx4 v15, s[12:15], s27 offen lds
    s_add_u32 s26, s26, 128
    s_add_u32 s27, s27, 245760
    v_lshlrev_b32 v40, 16, v38
    v_and_b32 v41, s30, v38
    v_add_f32 v20, v20, v40
    v_add_f32 v21, v21, v41
    v_lshlrev_b32 v40, 16, v39
    v_and_b32 v41, s30, v39
    v_add_f32 v22, v22, v40
    v_add_f32 v23, v23, v41
    s_waitcnt vmcnt(17)
    s_barrier
    ds_read_b128 v[24:27], v43 offset:49664
    ds_read_b128 v[28:31], v43 offset:50688
    ds_read_b128 v[32:35], v43 offset:51712
    ds_read_b128 v[36:39], v43 offset:52736
    s_waitcnt lgkmcnt(0)
    v_lshlrev_b32 v40, 16, v24
    v_and_b32 v41, s30, v24
    v_add_f32 v16, v16, v40
    v_add_f32 v17, v17, v41
    v_lshlrev_b32 v40, 16, v25
    v_and_b32 v41, s30, v25
    v_add_f32 v18, v18, v40
    v_add_f32 v19, v19, v41
    v_lshlrev_b32 v40, 16, v26
    v_and_b32 v41, s30, v26
    v_add_f32 v20, v20, v40
    v_add_f32 v21, v21, v41
    v_lshlrev_b32 v40, 16, v27
    v_and_b32 v41, s30, v27
    v_add_f32 v22, v22, v40
    v_add_f32 v23, v23, v41
    v_lshlrev_b32 v40, 16, v28
    v_and_b32 v41, s30, v28
    v_add_f32 v16, v16, v40
    v_add_f32 v17, v17, v41
    v_lshlrev_b32 v40, 16, v29
    v_and_b32 v41, s30, v29
    v_add_f32 v18, v18, v40
    v_add_f32 v19, v19, v41
    v_lshlrev_b32 v40, 16, v30
    v_and_b32 v41, s30, v30
    v_add_f32 v20, v20, v40
    v_add_f32 v21, v21, v41
    v_lshlrev_b32 v40, 16, v31
    v_and_b32 v41, s30, v31
    v_add_f32 v22, v22, v40
    v_add_f32 v23, v23, v41
    v_lshlrev_b32 v40, 16, v32
    v_and_b32 v41, s30, v32
    v_add_f32 v16, v16, v40
    v_add_f32 v17, v17, v41
    v_lshlrev_b32 v40, 16, v33
    v_and_b32 v41, s30, v33
    v_add_f32 v18, v18, v40
    v_add_f32 v19, v19, v41
    v_lshlrev_b32 v40, 16, v34
    v_and_b32 v41, s30, v34
    v_add_f32 v20, v20, v40
    v_add_f32 v21, v21, v41
    v_lshlrev_b32 v40, 16, v35
    v_and_b32 v41, s30, v35
    v_add_f32 v22, v22, v40
    v_add_f32 v23, v23, v41
    v_lshlrev_b32 v40, 16, v36
    v_and_b32 v41, s30, v36
    v_add_f32 v16, v16, v40
    v_add_f32 v17, v17, v41
    v_lshlrev_b32 v40, 16, v37
    v_and_b32 v41, s30, v37
    v_add_f32 v18, v18, v40
    v_add_f32 v19, v19, v41
    v_lshlrev_b32 v40, 16, v38
    v_and_b32 v41, s30, v38
    v_add_f32 v20, v20, v40
    v_add_f32 v21, v21, v41
    v_lshlrev_b32 v40, 16, v39
    v_and_b32 v41, s30, v39
    v_add_f32 v22, v22, v40
    v_add_f32 v23, v23, v41
    s_waitcnt vmcnt(8)
    s_barrier
    v_cmp_eq_u32 vcc, 0, v48
    s_nop 3
    s_and_b32 s70, vcc_lo, 3
    buffer_load_dwordx2 v[44:45], v47, s[16:19], s69 offen sc1
    ds_read_b128 v[24:27], v42 offset:16640
    ds_read_b128 v[28:31], v42 offset:17664
    ds_read_b128 v[32:35], v42 offset:18688
    ds_read_b128 v[36:39], v42 offset:19712
    s_waitcnt lgkmcnt(0)
    v_lshlrev_b32 v40, 16, v24
    v_and_b32 v41, s30, v24
    v_add_f32 v16, v16, v40
    v_add_f32 v17, v17, v41
    v_lshlrev_b32 v40, 16, v25
    v_and_b32 v41, s30, v25
    v_add_f32 v18, v18, v40
    v_add_f32 v19, v19, v41
    v_lshlrev_b32 v40, 16, v26
    v_and_b32 v41, s30, v26
    v_add_f32 v20, v20, v40
    v_add_f32 v21, v21, v41
    v_lshlrev_b32 v40, 16, v27
    v_and_b32 v41, s30, v27
    v_add_f32 v22, v22, v40
    v_add_f32 v23, v23, v41
    v_lshlrev_b32 v40, 16, v28
    v_and_b32 v41, s30, v28
    v_add_f32 v16, v16, v40
    v_add_f32 v17, v17, v41
    v_lshlrev_b32 v40, 16, v29
    v_and_b32 v41, s30, v29
    v_add_f32 v18, v18, v40
    v_add_f32 v19, v19, v41
    v_lshlrev_b32 v40, 16, v30
    v_and_b32 v41, s30, v30
    v_add_f32 v20, v20, v40
    v_add_f32 v21, v21, v41
    v_lshlrev_b32 v40, 16, v31
    v_and_b32 v41, s30, v31
    v_add_f32 v22, v22, v40
    v_add_f32 v23, v23, v41
    v_lshlrev_b32 v40, 16, v32
    v_and_b32 v41, s30, v32
    v_add_f32 v16, v16, v40
    v_add_f32 v17, v17, v41
    v_lshlrev_b32 v40, 16, v33
    v_and_b32 v41, s30, v33
    v_add_f32 v18, v18, v40
    v_add_f32 v19, v19, v41
    v_lshlrev_b32 v40, 16, v34
    v_and_b32 v41, s30, v34
    v_add_f32 v20, v20, v40
    v_add_f32 v21, v21, v41
    v_lshlrev_b32 v40, 16, v35
    v_and_b32 v41, s30, v35
    v_add_f32 v22, v22, v40
    v_add_f32 v23, v23, v41
    v_lshlrev_b32 v40, 16, v36
    v_and_b32 v41, s30, v36
    v_add_f32 v16, v16, v40
    v_add_f32 v17, v17, v41
    v_lshlrev_b32 v40, 16, v37
    v_and_b32 v41, s30, v37
    v_add_f32 v18, v18, v40
    v_add_f32 v19, v19, v41
    v_lshlrev_b32 v40, 16, v38
    v_and_b32 v41, s30, v38
    v_add_f32 v20, v20, v40
    v_add_f32 v21, v21, v41
    v_lshlrev_b32 v40, 16, v39
    v_and_b32 v41, s30, v39
    v_add_f32 v22, v22, v40
    v_add_f32 v23, v23, v41
    s_waitcnt vmcnt(1)
    s_barrier
    ds_read_b128 v[24:27], v42 offset:49664
    ds_read_b128 v[28:31], v42 offset:50688
    ds_read_b128 v[32:35], v42 offset:51712
    ds_read_b128 v[36:39], v42 offset:52736
    s_waitcnt lgkmcnt(0)
    v_lshlrev_b32 v40, 16, v24
    v_and_b32 v41, s30, v24
    v_add_f32 v16, v16, v40
    v_add_f32 v17, v17, v41
    v_lshlrev_b32 v40, 16, v25
    v_and_b32 v41, s30, v25
    v_add_f32 v18, v18, v40
    v_add_f32 v19, v19, v41
    v_lshlrev_b32 v40, 16, v26
    v_and_b32 v41, s30, v26
    v_add_f32 v20, v20, v40
    v_add_f32 v21, v21, v41
    v_lshlrev_b32 v40, 16, v27
    v_and_b32 v41, s30, v27
    v_add_f32 v22, v22, v40
    v_add_f32 v23, v23, v41
    v_lshlrev_b32 v40, 16, v28
    v_and_b32 v41, s30, v28
    v_add_f32 v16, v16, v40
    v_add_f32 v17, v17, v41
    v_lshlrev_b32 v40, 16, v29
    v_and_b32 v41, s30, v29
    v_add_f32 v18, v18, v40
    v_add_f32 v19, v19, v41
    v_lshlrev_b32 v40, 16, v30
    v_and_b32 v41, s30, v30
    v_add_f32 v20, v20, v40
    v_add_f32 v21, v21, v41
    v_lshlrev_b32 v40, 16, v31
    v_and_b32 v41, s30, v31
    v_add_f32 v22, v22, v40
    v_add_f32 v23, v23, v41
    v_lshlrev_b32 v40, 16, v32
    v_and_b32 v41, s30, v32
    v_add_f32 v16, v16, v40
    v_add_f32 v17, v17, v41
    v_lshlrev_b32 v40, 16, v33
    v_and_b32 v41, s30, v33
    v_add_f32 v18, v18, v40
    v_add_f32 v19, v19, v41
    v_lshlrev_b32 v40, 16, v34
    v_and_b32 v41, s30, v34
    v_add_f32 v20, v20, v40
    v_add_f32 v21, v21, v41
    v_lshlrev_b32 v40, 16, v35
    v_and_b32 v41, s30, v35
    v_add_f32 v22, v22, v40
    v_add_f32 v23, v23, v41
    v_lshlrev_b32 v40, 16, v36
    v_and_b32 v41, s30, v36
    v_add_f32 v16, v16, v40
    v_add_f32 v17, v17, v41
    v_lshlrev_b32 v40, 16, v37
    v_and_b32 v41, s30, v37
    v_add_f32 v18, v18, v40
    v_add_f32 v19, v19, v41
    v_lshlrev_b32 v40, 16, v38
    v_and_b32 v41, s30, v38
    v_add_f32 v20, v20, v40
    v_add_f32 v21, v21, v41
    v_lshlrev_b32 v40, 16, v39
    v_and_b32 v41, s30, v39
    v_add_f32 v22, v22, v40
    v_add_f32 v23, v23, v41
    v_lshrrev_b32 v5, 4, v1
    v_lshlrev_b32 v6, 2, v5
    v_and_b32 v4, 15, v1
    v_xor_b32 v6, v6, v4
    v_lshlrev_b32 v6, 5, v6
    v_lshl_add_u32 v6, v5, 9, v6
    s_lshl_b32 s32, s21, 11
    s_add_u32 s32, s32, 133632
    v_add_u32 v6, s32, v6
    ds_write_b128 v6, v[16:19]
    ds_write_b128 v6, v[20:23] offset:16
    s_waitcnt lgkmcnt(0)
    s_barrier
    v_and_b32 v3, 31, v1
    s_lshl_b32 s32, s21, 7
    v_lshl_add_u32 v3, v3, 2, s32
    v_add_u32 v4, 133632, v3
    ds_read_b32 v24, v4 offset:0
    ds_read_b32 v25, v4 offset:512
    ds_read_b32 v26, v4 offset:1024
    ds_read_b32 v27, v4 offset:1536
    ds_read_b32 v28, v4 offset:2048
    ds_read_b32 v29, v4 offset:2560
    ds_read_b32 v30, v4 offset:3072
    ds_read_b32 v31, v4 offset:3584
    ds_read_b32 v32, v4 offset:4096
    ds_read_b32 v33, v4 offset:4608
    ds_read_b32 v34, v4 offset:5120
    ds_read_b32 v35, v4 offset:5632
    ds_read_b32 v36, v4 offset:6144
    ds_read_b32 v37, v4 offset:6656
    ds_read_b32 v38, v4 offset:7168
    ds_read_b32 v39, v4 offset:7680
    s_cmp_eq_u32 s70, 0
    s_cbranch_scc1 L_p1_polled
    s_mov_b32 s32, 0
L_p1_poll:
    global_load_dword v48, v46, s[54:55] sc1
    s_add_u32 s32, s32, 1
    s_waitcnt vmcnt(0)
    v_cmp_eq_u32 vcc, 0, v48
    s_nop 3
    s_and_b32 s70, vcc_lo, 3
    s_cmp_gt_u32 s32, 40000
    s_cbranch_scc1 L_p1_pollx
    s_cmp_lg_u32 s70, 0
    s_cbranch_scc1 L_p1_poll
L_p1_pollx:
    buffer_load_dwordx2 v[44:45], v47, s[16:19], s69 offen sc1
L_p1_polled:
    s_waitcnt lgkmcnt(0)
    v_add_f32 v24, v24, v32
    v_add_f32 v25, v25, v33
    v_add_f32 v26, v26, v34
    v_add_f32 v27, v27, v35
    v_add_f32 v28, v28, v36
    v_add_f32 v29, v29, v37
    v_add_f32 v30, v30, v38
    v_add_f32 v31, v31, v39
    v_add_f32 v24, v24, v28
    v_add_f32 v25, v25, v29
    v_add_f32 v26, v26, v30
    v_add_f32 v27, v27, v31
    v_add_f32 v24, v24, v26
    v_add_f32 v25, v25, v27
    v_add_f32 v24, v24, v25
    v_add_u32 v4, 133120, v3
    ds_write_b32 v4, v24
    s_cmp_eq_u32 s25, 0
    s_mov_b32 s34, 0x3f800000
    s_cmov_b32 s34, 0x3ea52b5c
    v_add_u32 v3, 132096, v3
    s_waitcnt vmcnt(0)
    v_mul_f32 v44, s34, v44
    v_mul_f32 v45, s34, v45
    ds_write_b32 v3, v44
    ds_write_b32 v3, v45 offset:512
    s_waitcnt lgkmcnt(0)
    s_barrier
    s_mov_b32 s70, 1
    s_mov_b32 s85, 1
    s_branch L_p1_wait
L_p1_rowstats:
    s_mul_i32 s70, s22, 3
    s_mov_b32 s23, s68
    v_mov_b32 v3, 163648
    v_mov_b32 v4, 0
    v_mov_b32 v5, 4
    ds_write_b32 v3, v5
    ds_write_b32 v3, v4 offset:8
    ds_write_b32 v3, v4 offset:12
    ds_write_b32 v3, v4 offset:16
    ds_write_b32 v3, v4 offset:24
    ds_write_b32 v3, v4 offset:28
    ds_write_b32 v3, v4 offset:32
    s_cmp_lg_u32 s23, 0
    s_cbranch_scc1 L_p1_nozero
    s_cmp_lg_u32 s20, 7
    s_cbranch_scc1 L_p1_nozero
    v_lshlrev_b32 v3, 7, v1
    v_mov_b32 v4, 0
    s_mov_b32 s31, 24408064
    buffer_store_dword v4, v3, s[16:19], s31 offen sc1
    s_mov_b32 s31, 24416256
    buffer_store_dword v4, v3, s[16:19], s31 offen sc1
    s_mov_b32 s31, 24424448
    buffer_store_dword v4, v3, s[16:19], s31 offen sc1
    s_mov_b32 s31, 24432640
    buffer_store_dword v4, v3, s[16:19], s31 offen sc1
    s_mov_b32 s31, 24440832
    buffer_store_dword v4, v3, s[16:19], s31 offen sc1
    v_mov_b32 v16, 0
    v_mov_b32 v17, 0
    v_mov_b32 v18, 0
    v_mov_b32 v19, 0
    s_mov_b32 s31, 24440832
    buffer_store_dwordx4 v[16:19], v2, s[16:19], s31 offen sc1
    s_mov_b32 s31, 24441856
    buffer_store_dwordx4 v[16:19], v2, s[16:19], s31 offen sc1
    s_mov_b32 s31, 24442880
    buffer_store_dwordx4 v[16:19], v2, s[16:19], s31 offen sc1
    s_mov_b32 s31, 24443904
    buffer_store_dwordx4 v[16:19], v2, s[16:19], s31 offen sc1
    s_mov_b32 s31, 24444928
    buffer_store_dwordx4 v[16:19], v2, s[16:19], s31 offen sc1
    s_mov_b32 s31, 24445952
    buffer_store_dwordx4 v[16:19], v2, s[16:19], s31 offen sc1
    s_waitcnt vmcnt(0)
    v_mov_b32 v3, 64
    v_mov_b32 v4, 1
    s_mov_b64 exec, 1
    global_store_dword v3, v4, s[54:55] sc1
    s_mov_b64 exec, -1
L_p1_nozero:
    v_lshrrev_b32 v3, 4, v1
    v_and_b32 v4, 15, v1
    s_lshl_b32 s31, s23, 7
    s_lshl_b32 s32, s20, 4
    s_add_u32 s31, s31, s32
    v_add_u32 v3, s31, v3
    v_mul_u32_u24 v106, 1280, v3
    v_lshl_add_u32 v106, v4, 4, v106
    s_mov_b32 s33, 0
    buffer_load_dwordx4 v[20:23], v106, s[8:11], s33 offen offset:0
    buffer_load_dwordx4 v[24:27], v106, s[8:11], s33 offen offset:256
    buffer_load_dwordx4 v[28:31], v106, s[8:11], s33 offen offset:512
    buffer_load_dwordx4 v[32:35], v106, s[8:11], s33 offen offset:768
    buffer_load_dwordx4 v[36:39], v106, s[8:11], s33 offen offset:1024
    s_mov_b32 s33, 5120
    buffer_load_dwordx4 v[40:43], v106, s[8:11], s33 offen offset:0
    buffer_load_dwordx4 v[44:47], v106, s[8:11], s33 offen offset:256
    buffer_load_dwordx4 v[48:51], v106, s[8:11], s33 offen offset:512
    buffer_load_dwordx4 v[52:55], v106, s[8:11], s33 offen offset:768
    buffer_load_dwordx4 v[56:59], v106, s[8:11], s33 offen offset:1024
    s_mov_b32 s33, 10240
    buffer_load_dwordx4 v[60:63], v106, s[8:11], s33 offen offset:0
    buffer_load_dwordx4 v[64:67], v106, s[8:11], s33 offen offset:256
    buffer_load_dwordx4 v[68:71], v106, s[8:11], s33 offen offset:512
    buffer_load_dwordx4 v[72:75], v106, s[8:11], s33 offen offset:768
    buffer_load_dwordx4 v[76:79], v106, s[8:11], s33 offen offset:1024
    s_mov_b32 s33, 15360
    buffer_load_dwordx4 v[80:83], v106, s[8:11], s33 offen offset:0
    buffer_load_dwordx4 v[84:87], v106, s[8:11], s33 offen offset:256
    buffer_load_dwordx4 v[88:91], v106, s[8:11], s33 offen offset:512
    buffer_load_dwordx4 v[92:95], v106, s[8:11], s33 offen offset:768
    buffer_load_dwordx4 v[96:99], v106, s[8:11], s33 offen offset:1024
    v_lshlrev_b32 v3, 3, v3
    v_cmp_eq_u32 s[4:5], 0, v4
    s_waitcnt vmcnt(15)
    v_mov_b32 v100, 0
    v_mov_b32 v102, 0
    v_mov_b32 v101, 0
    v_mov_b32 v103, 0
    v_lshlrev_b32 v104, 16, v20
    v_and_b32 v105, s30, v20
    v_pk_add_f32 v[100:101], v[100:101], v[104:105]
    v_pk_fma_f32 v[102:103], v[104:105], v[104:105], v[102:103]
    v_lshlrev_b32 v104, 16, v21
    v_and_b32 v105, s30, v21
    v_pk_add_f32 v[100:101], v[100:101], v[104:105]
    v_pk_fma_f32 v[102:103], v[104:105], v[104:105], v[102:103]
    v_lshlrev_b32 v104, 16, v22
    v_and_b32 v105, s30, v22
    v_pk_add_f32 v[100:101], v[100:101], v[104:105]
    v_pk_fma_f32 v[102:103], v[104:105], v[104:105], v[102:103]
    v_lshlrev_b32 v104, 16, v23
    v_and_b32 v105, s30, v23
    v_pk_add_f32 v[100:101], v[100:101], v[104:105]
    v_pk_fma_f32 v[102:103], v[104:105], v[104:105], v[102:103]
    v_lshlrev_b32 v104, 16, v24
    v_and_b32 v105, s30, v24
    v_pk_add_f32 v[100:101], v[100:101], v[104:105]
    v_pk_fma_f32 v[102:103], v[104:105], v[104:105], v[102:103]
    v_lshlrev_b32 v104, 16, v25
    v_and_b32 v105, s30, v25
    v_pk_add_f32 v[100:101], v[100:101], v[104:105]
    v_pk_fma_f32 v[102:103], v[104:105], v[104:105], v[102:103]
    v_lshlrev_b32 v104, 16, v26
    v_and_b32 v105, s30, v26
    v_pk_add_f32 v[100:101], v[100:101], v[104:105]
    v_pk_fma_f32 v[102:103], v[104:105], v[104:105], v[102:103]
    v_lshlrev_b32 v104, 16, v27
    v_and_b32 v105, s30, v27
    v_pk_add_f32 v[100:101], v[100:101], v[104:105]
    v_pk_fma_f32 v[102:103], v[104:105], v[104:105], v[102:103]
    v_lshlrev_b32 v104, 16, v28
    v_and_b32 v105, s30, v28
    v_pk_add_f32 v[100:101], v[100:101], v[104:105]
    v_pk_fma_f32 v[102:103], v[104:105], v[104:105], v[102:103]
    v_lshlrev_b32 v104, 16, v29
    v_and_b32 v105, s30, v29
    v_pk_add_f32 v[100:101], v[100:101], v[104:105]
    v_pk_fma_f32 v[102:103], v[104:105], v[104:105], v[102:103]
    v_lshlrev_b32 v104, 16, v30
    v_and_b32 v105, s30, v30
    v_pk_add_f32 v[100:101], v[100:101], v[104:105]
    v_pk_fma_f32 v[102:103], v[104:105], v[104:105], v[102:103]
    v_lshlrev_b32 v104, 16, v31
    v_and_b32 v105, s30, v31
    v_pk_add_f32 v[100:101], v[100:101], v[104:105]
    v_pk_fma_f32 v[102:103], v[104:105], v[104:105], v[102:103]
    v_lshlrev_b32 v104, 16, v32
    v_and_b32 v105, s30, v32
    v_pk_add_f32 v[100:101], v[100:101], v[104:105]
    v_pk_fma_f32 v[102:103], v[104:105], v[104:105], v[102:103]
    v_lshlrev_b32 v104, 16, v33
    v_and_b32 v105, s30, v33
    v_pk_add_f32 v[100:101], v[100:101], v[104:105]
    v_pk_fma_f32 v[102:103], v[104:105], v[104:105], v[102:103]
    v_lshlrev_b32 v104, 16, v34
    v_and_b32 v105, s30, v34
    v_pk_add_f32 v[100:101], v[100:101], v[104:105]
    v_pk_fma_f32 v[102:103], v[104:105], v[104:105], v[102:103]
    v_lshlrev_b32 v104, 16, v35
    v_and_b32 v105, s30, v35
    v_pk_add_f32 v[100:101], v[100:101], v[104:105]
    v_pk_fma_f32 v[102:103], v[104:105], v[104:105], v[102:103]
    v_lshlrev_b32 v104, 16, v36
    v_and_b32 v105, s30, v36
    v_pk_add_f32 v[100:101], v[100:101], v[104:105]
    v_pk_fma_f32 v[102:103], v[104:105], v[104:105], v[102:103]
    v_lshlrev_b32 v104, 16, v37
    v_and_b32 v105, s30, v37
    v_pk_add_f32 v[100:101], v[100:101], v[104:105]
    v_pk_fma_f32 v[102:103], v[104:105], v[104:105], v[102:103]
    v_lshlrev_b32 v104, 16, v38
    v_and_b32 v105, s30, v38
    v_pk_add_f32 v[100:101], v[100:101], v[104:105]
    v_pk_fma_f32 v[102:103], v[104:105], v[104:105], v[102:103]
    v_lshlrev_b32 v104, 16, v39
    v_and_b32 v105, s30, v39
    v_pk_add_f32 v[100:101], v[100:101], v[104:105]
    v_pk_fma_f32 v[102:103], v[104:105], v[104:105], v[102:103]
    v_add_f32 v100, v100, v101
    v_add_f32 v102, v102, v103
    s_nop 0
    v_add_f32_dpp v100, v100, v100 row_ror:8 row_mask:0xf bank_mask:0xf
    v_add_f32_dpp v102, v102, v102 row_ror:8 row_mask:0xf bank_mask:0xf
    s_nop 0
    v_add_f32_dpp v100, v100, v100 row_ror:4 row_mask:0xf bank_mask:0xf
    v_add_f32_dpp v102, v102, v102 row_ror:4 row_mask:0xf bank_mask:0xf
    s_nop 0
    v_add_f32_dpp v100, v100, v100 row_ror:2 row_mask:0xf bank_mask:0xf
    v_add_f32_dpp v102, v102, v102 row_ror:2 row_mask:0xf bank_mask:0xf
    s_nop 0
    v_add_f32_dpp v100, v100, v100 row_ror:1 row_mask:0xf bank_mask:0xf
    v_add_f32_dpp v102, v102, v102 row_ror:1 row_mask:0xf bank_mask:0xf
    v_mul_f32 v100, 0x3acccccd, v100
    v_mul_f32 v102, 0x3acccccd, v102
    v_fma_f32 v102, -v100, v100, v102
    v_max_f32 v102, 0, v102
    v_add_f32 v102, 0x3727c5ac, v102
    v_rsq_f32 v20, v102
    s_nop 0
    v_mul_f32 v21, v100, v20
    s_waitcnt vmcnt(10)
    v_mov_b32 v100, 0
    v_mov_b32 v102, 0
    v_mov_b32 v101, 0
    v_mov_b32 v103, 0
    v_lshlrev_b32 v104, 16, v40
    v_and_b32 v105, s30, v40
    v_pk_add_f32 v[100:101], v[100:101], v[104:105]
    v_pk_fma_f32 v[102:103], v[104:105], v[104:105], v[102:103]
    v_lshlrev_b32 v104, 16, v41
    v_and_b32 v105, s30, v41
    v_pk_add_f32 v[100:101], v[100:101], v[104:105]
    v_pk_fma_f32 v[102:103], v[104:105], v[104:105], v[102:103]
    v_lshlrev_b32 v104, 16, v42
    v_and_b32 v105, s30, v42
    v_pk_add_f32 v[100:101], v[100:101], v[104:105]
    v_pk_fma_f32 v[102:103], v[104:105], v[104:105], v[102:103]
    v_lshlrev_b32 v104, 16, v43
    v_and_b32 v105, s30, v43
    v_pk_add_f32 v[100:101], v[100:101], v[104:105]
    v_pk_fma_f32 v[102:103], v[104:105], v[104:105], v[102:103]
    v_lshlrev_b32 v104, 16, v44
    v_and_b32 v105, s30, v44
    v_pk_add_f32 v[100:101], v[100:101], v[104:105]
    v_pk_fma_f32 v[102:103], v[104:105], v[104:105], v[102:103]
    v_lshlrev_b32 v104, 16, v45
    v_and_b32 v105, s30, v45
    v_pk_add_f32 v[100:101], v[100:101], v[104:105]
    v_pk_fma_f32 v[102:103], v[104:105], v[104:105], v[102:103]
    v_lshlrev_b32 v104, 16, v46
    v_and_b32 v105, s30, v46
    v_pk_add_f32 v[100:101], v[100:101], v[104:105]
    v_pk_fma_f32 v[102:103], v[104:105], v[104:105], v[102:103]
    v_lshlrev_b32 v104, 16, v47
    v_and_b32 v105, s30, v47
    v_pk_add_f32 v[100:101], v[100:101], v[104:105]
    v_pk_fma_f32 v[102:103], v[104:105], v[104:105], v[102:103]
    v_lshlrev_b32 v104, 16, v48
    v_and_b32 v105, s30, v48
    v_pk_add_f32 v[100:101], v[100:101], v[104:105]
    v_pk_fma_f32 v[102:103], v[104:105], v[104:105], v[102:103]
    v_lshlrev_b32 v104, 16, v49
    v_and_b32 v105, s30, v49
    v_pk_add_f32 v[100:101], v[100:101], v[104:105]
    v_pk_fma_f32 v[102:103], v[104:105], v[104:105], v[102:103]
    v_lshlrev_b32 v104, 16, v50
    v_and_b32 v105, s30, v50
    v_pk_add_f32 v[100:101], v[100:101], v[104:105]
    v_pk_fma_f32 v[102:103], v[104:105], v[104:105], v[102:103]
    v_lshlrev_b32 v104, 16, v51
    v_and_b32 v105, s30, v51
    v_pk_add_f32 v[100:101], v[100:101], v[104:105]
    v_pk_fma_f32 v[102:103], v[104:105], v[104:105], v[102:103]
    v_lshlrev_b32 v104, 16, v52
    v_and_b32 v105, s30, v52
    v_pk_add_f32 v[100:101], v[100:101], v[104:105]
    v_pk_fma_f32 v[102:103], v[104:105], v[104:105], v[102:103]
    v_lshlrev_b32 v104, 16, v53
    v_and_b32 v105, s30, v53
    v_pk_add_f32 v[100:101], v[100:101], v[104:105]
    v_pk_fma_f32 v[102:103], v[104:105], v[104:105], v[102:103]
    v_lshlrev_b32 v104, 16, v54
    v_and_b32 v105, s30, v54
    v_pk_add_f32 v[100:101], v[100:101], v[104:105]
    v_pk_fma_f32 v[102:103], v[104:105], v[104:105], v[102:103]
    v_lshlrev_b32 v104, 16, v55
    v_and_b32 v105, s30, v55
    v_pk_add_f32 v[100:101], v[100:101], v[104:105]
    v_pk_fma_f32 v[102:103], v[104:105], v[104:105], v[102:103]
    v_lshlrev_b32 v104, 16, v56
    v_and_b32 v105, s30, v56
    v_pk_add_f32 v[100:101], v[100:101], v[104:105]
    v_pk_fma_f32 v[102:103], v[104:105], v[104:105], v[102:103]
    v_lshlrev_b32 v104, 16, v57
    v_and_b32 v105, s30, v57
    v_pk_add_f32 v[100:101], v[100:101], v[104:105]
    v_pk_fma_f32 v[102:103], v[104:105], v[104:105], v[102:103]
    v_lshlrev_b32 v104, 16, v58
    v_and_b32 v105, s30, v58
    v_pk_add_f32 v[100:101], v[100:101], v[104:105]
    v_pk_fma_f32 v[102:103], v[104:105], v[104:105], v[102:103]
    v_lshlrev_b32 v104, 16, v59
    v_and_b32 v105, s30, v59
    v_pk_add_f32 v[100:101], v[100:101], v[104:105]
    v_pk_fma_f32 v[102:103], v[104:105], v[104:105], v[102:103]
    v_add_f32 v100, v100, v101
    v_add_f32 v102, v102, v103
    s_nop 0
    v_add_f32_dpp v100, v100, v100 row_ror:8 row_mask:0xf bank_mask:0xf
    v_add_f32_dpp v102, v102, v102 row_ror:8 row_mask:0xf bank_mask:0xf
    s_nop 0
    v_add_f32_dpp v100, v100, v100 row_ror:4 row_mask:0xf bank_mask:0xf
    v_add_f32_dpp v102, v102, v102 row_ror:4 row_mask:0xf bank_mask:0xf
    s_nop 0
    v_add_f32_dpp v100, v100, v100 row_ror:2 row_mask:0xf bank_mask:0xf
    v_add_f32_dpp v102, v102, v102 row_ror:2 row_mask:0xf bank_mask:0xf
    s_nop 0
    v_add_f32_dpp v100, v100, v100 row_ror:1 row_mask:0xf bank_mask:0xf
    v_add_f32_dpp v102, v102, v102 row_ror:1 row_mask:0xf bank_mask:0xf
    v_mul_f32 v100, 0x3acccccd, v100
    v_mul_f32 v102, 0x3acccccd, v102
    v_fma_f32 v102, -v100, v100, v102
    v_max_f32 v102, 0, v102
    v_add_f32 v102, 0x3727c5ac, v102
    v_rsq_f32 v40, v102
    s_nop 0
    v_mul_f32 v41, v100, v40
    s_waitcnt vmcnt(5)
    v_mov_b32 v100, 0
    v_mov_b32 v102, 0
    v_mov_b32 v101, 0
    v_mov_b32 v103, 0
    v_lshlrev_b32 v104, 16, v60
    v_and_b32 v105, s30, v60
    v_pk_add_f32 v[100:101], v[100:101], v[104:105]
    v_pk_fma_f32 v[102:103], v[104:105], v[104:105], v[102:103]
    v_lshlrev_b32 v104, 16, v61
    v_and_b32 v105, s30, v61
    v_pk_add_f32 v[100:101], v[100:101], v[104:105]
    v_pk_fma_f32 v[102:103], v[104:105], v[104:105], v[102:103]
    v_lshlrev_b32 v104, 16, v62
    v_and_b32 v105, s30, v62
    v_pk_add_f32 v[100:101], v[100:101], v[104:105]
    v_pk_fma_f32 v[102:103], v[104:105], v[104:105], v[102:103]
    v_lshlrev_b32 v104, 16, v63
    v_and_b32 v105, s30, v63
    v_pk_add_f32 v[100:101], v[100:101], v[104:105]
    v_pk_fma_f32 v[102:103], v[104:105], v[104:105], v[102:103]
    v_lshlrev_b32 v104, 16, v64
    v_and_b32 v105, s30, v64
    v_pk_add_f32 v[100:101], v[100:101], v[104:105]
    v_pk_fma_f32 v[102:103], v[104:105], v[104:105], v[102:103]
    v_lshlrev_b32 v104, 16, v65
    v_and_b32 v105, s30, v65
    v_pk_add_f32 v[100:101], v[100:101], v[104:105]
    v_pk_fma_f32 v[102:103], v[104:105], v[104:105], v[102:103]
    v_lshlrev_b32 v104, 16, v66
    v_and_b32 v105, s30, v66
    v_pk_add_f32 v[100:101], v[100:101], v[104:105]
    v_pk_fma_f32 v[102:103], v[104:105], v[104:105], v[102:103]
    v_lshlrev_b32 v104, 16, v67
    v_and_b32 v105, s30, v67
    v_pk_add_f32 v[100:101], v[100:101], v[104:105]
    v_pk_fma_f32 v[102:103], v[104:105], v[104:105], v[102:103]
    v_lshlrev_b32 v104, 16, v68
    v_and_b32 v105, s30, v68
    v_pk_add_f32 v[100:101], v[100:101], v[104:105]
    v_pk_fma_f32 v[102:103], v[104:105], v[104:105], v[102:103]
    v_lshlrev_b32 v104, 16, v69
    v_and_b32 v105, s30, v69
    v_pk_add_f32 v[100:101], v[100:101], v[104:105]
    v_pk_fma_f32 v[102:103], v[104:105], v[104:105], v[102:103]
    v_lshlrev_b32 v104, 16, v70
    v_and_b32 v105, s30, v70
    v_pk_add_f32 v[100:101], v[100:101], v[104:105]
    v_pk_fma_f32 v[102:103], v[104:105], v[104:105], v[102:103]
    v_lshlrev_b32 v104, 16, v71
    v_and_b32 v105, s30, v71
    v_pk_add_f32 v[100:101], v[100:101], v[104:105]
    v_pk_fma_f32 v[102:103], v[104:105], v[104:105], v[102:103]
    v_lshlrev_b32 v104, 16, v72
    v_and_b32 v105, s30, v72
    v_pk_add_f32 v[100:101], v[100:101], v[104:105]
    v_pk_fma_f32 v[102:103], v[104:105], v[104:105], v[102:103]
    v_lshlrev_b32 v104, 16, v73
    v_and_b32 v105, s30, v73
    v_pk_add_f32 v[100:101], v[100:101], v[104:105]
    v_pk_fma_f32 v[102:103], v[104:105], v[104:105], v[102:103]
    v_lshlrev_b32 v104, 16, v74
    v_and_b32 v105, s30, v74
    v_pk_add_f32 v[100:101], v[100:101], v[104:105]
    v_pk_fma_f32 v[102:103], v[104:105], v[104:105], v[102:103]
    v_lshlrev_b32 v104, 16, v75
    v_and_b32 v105, s30, v75
    v_pk_add_f32 v[100:101], v[100:101], v[104:105]
    v_pk_fma_f32 v[102:103], v[104:105], v[104:105], v[102:103]
    v_lshlrev_b32 v104, 16, v76
    v_and_b32 v105, s30, v76
    v_pk_add_f32 v[100:101], v[100:101], v[104:105]
    v_pk_fma_f32 v[102:103], v[104:105], v[104:105], v[102:103]
    v_lshlrev_b32 v104, 16, v77
    v_and_b32 v105, s30, v77
    v_pk_add_f32 v[100:101], v[100:101], v[104:105]
    v_pk_fma_f32 v[102:103], v[104:105], v[104:105], v[102:103]
    v_lshlrev_b32 v104, 16, v78
    v_and_b32 v105, s30, v78
    v_pk_add_f32 v[100:101], v[100:101], v[104:105]
    v_pk_fma_f32 v[102:103], v[104:105], v[104:105], v[102:103]
    v_lshlrev_b32 v104, 16, v79
    v_and_b32 v105, s30, v79
    v_pk_add_f32 v[100:101], v[100:101], v[104:105]
    v_pk_fma_f32 v[102:103], v[104:105], v[104:105], v[102:103]
    v_add_f32 v100, v100, v101
    v_add_f32 v102, v102, v103
    s_nop 0
    v_add_f32_dpp v100, v100, v100 row_ror:8 row_mask:0xf bank_mask:0xf
    v_add_f32_dpp v102, v102, v102 row_ror:8 row_mask:0xf bank_mask:0xf
    s_nop 0
    v_add_f32_dpp v100, v100, v100 row_ror:4 row_mask:0xf bank_mask:0xf
    v_add_f32_dpp v102, v102, v102 row_ror:4 row_mask:0xf bank_mask:0xf
    s_nop 0
    v_add_f32_dpp v100, v100, v100 row_ror:2 row_mask:0xf bank_mask:0xf
    v_add_f32_dpp v102, v102, v102 row_ror:2 row_mask:0xf bank_mask:0xf
    s_nop 0
    v_add_f32_dpp v100, v100, v100 row_ror:1 row_mask:0xf bank_mask:0xf
    v_add_f32_dpp v102, v102, v102 row_ror:1 row_mask:0xf bank_mask:0xf
    v_mul_f32 v100, 0x3acccccd, v100
    v_mul_f32 v102, 0x3acccccd, v102
    v_fma_f32 v102, -v100, v100, v102
    v_max_f32 v102, 0, v102
    v_add_f32 v102, 0x3727c5ac, v102
    v_rsq_f32 v60, v102
    s_nop 0
    v_mul_f32 v61, v100, v60
    s_waitcnt vmcnt(0)
    v_mov_b32 v100, 0
    v_mov_b32 v102, 0
    v_mov_b32 v101, 0
    v_mov_b32 v103, 0
    v_lshlrev_b32 v104, 16, v80
    v_and_b32 v105, s30, v80
    v_pk_add_f32 v[100:101], v[100:101], v[104:105]
    v_pk_fma_f32 v[102:103], v[104:105], v[104:105], v[102:103]
    v_lshlrev_b32 v104, 16, v81
    v_and_b32 v105, s30, v81
    v_pk_add_f32 v[100:101], v[100:101], v[104:105]
    v_pk_fma_f32 v[102:103], v[104:105], v[104:105], v[102:103]
    v_lshlrev_b32 v104, 16, v82
    v_and_b32 v105, s30, v82
    v_pk_add_f32 v[100:101], v[100:101], v[104:105]
    v_pk_fma_f32 v[102:103], v[104:105], v[104:105], v[102:103]
    v_lshlrev_b32 v104, 16, v83
    v_and_b32 v105, s30, v83
    v_pk_add_f32 v[100:101], v[100:101], v[104:105]
    v_pk_fma_f32 v[102:103], v[104:105], v[104:105], v[102:103]
    v_lshlrev_b32 v104, 16, v84
    v_and_b32 v105, s30, v84
    v_pk_add_f32 v[100:101], v[100:101], v[104:105]
    v_pk_fma_f32 v[102:103], v[104:105], v[104:105], v[102:103]
    v_lshlrev_b32 v104, 16, v85
    v_and_b32 v105, s30, v85
    v_pk_add_f32 v[100:101], v[100:101], v[104:105]
    v_pk_fma_f32 v[102:103], v[104:105], v[104:105], v[102:103]
    v_lshlrev_b32 v104, 16, v86
    v_and_b32 v105, s30, v86
    v_pk_add_f32 v[100:101], v[100:101], v[104:105]
    v_pk_fma_f32 v[102:103], v[104:105], v[104:105], v[102:103]
    v_lshlrev_b32 v104, 16, v87
    v_and_b32 v105, s30, v87
    v_pk_add_f32 v[100:101], v[100:101], v[104:105]
    v_pk_fma_f32 v[102:103], v[104:105], v[104:105], v[102:103]
    v_lshlrev_b32 v104, 16, v88
    v_and_b32 v105, s30, v88
    v_pk_add_f32 v[100:101], v[100:101], v[104:105]
    v_pk_fma_f32 v[102:103], v[104:105], v[104:105], v[102:103]
    v_lshlrev_b32 v104, 16, v89
    v_and_b32 v105, s30, v89
    v_pk_add_f32 v[100:101], v[100:101], v[104:105]
    v_pk_fma_f32 v[102:103], v[104:105], v[104:105], v[102:103]
    v_lshlrev_b32 v104, 16, v90
    v_and_b32 v105, s30, v90
    v_pk_add_f32 v[100:101], v[100:101], v[104:105]
    v_pk_fma_f32 v[102:103], v[104:105], v[104:105], v[102:103]
    v_lshlrev_b32 v104, 16, v91
    v_and_b32 v105, s30, v91
    v_pk_add_f32 v[100:101], v[100:101], v[104:105]
    v_pk_fma_f32 v[102:103], v[104:105], v[104:105], v[102:103]
    v_lshlrev_b32 v104, 16, v92
    v_and_b32 v105, s30, v92
    v_pk_add_f32 v[100:101], v[100:101], v[104:105]
    v_pk_fma_f32 v[102:103], v[104:105], v[104:105], v[102:103]
    v_lshlrev_b32 v104, 16, v93
    v_and_b32 v105, s30, v93
    v_pk_add_f32 v[100:101], v[100:101], v[104:105]
    v_pk_fma_f32 v[102:103], v[104:105], v[104:105], v[102:103]
    v_lshlrev_b32 v104, 16, v94
    v_and_b32 v105, s30, v94
    v_pk_add_f32 v[100:101], v[100:101], v[104:105]
    v_pk_fma_f32 v[102:103], v[104:105], v[104:105], v[102:103]
    v_lshlrev_b32 v104, 16, v95
    v_and_b32 v105, s30, v95
    v_pk_add_f32 v[100:101], v[100:101], v[104:105]
    v_pk_fma_f32 v[102:103], v[104:105], v[104:105], v[102:103]
    v_lshlrev_b32 v104, 16, v96
    v_and_b32 v105, s30, v96
    v_pk_add_f32 v[100:101], v[100:101], v[104:105]
    v_pk_fma_f32 v[102:103], v[104:105], v[104:105], v[102:103]
    v_lshlrev_b32 v104, 16, v97
    v_and_b32 v105, s30, v97
    v_pk_add_f32 v[100:101], v[100:101], v[104:105]
    v_pk_fma_f32 v[102:103], v[104:105], v[104:105], v[102:103]
    v_lshlrev_b32 v104, 16, v98
    v_and_b32 v105, s30, v98
    v_pk_add_f32 v[100:101], v[100:101], v[104:105]
    v_pk_fma_f32 v[102:103], v[104:105], v[104:105], v[102:103]
    v_lshlrev_b32 v104, 16, v99
    v_and_b32 v105, s30, v99
    v_pk_add_f32 v[100:101], v[100:101], v[104:105]
    v_pk_fma_f32 v[102:103], v[104:105], v[104:105], v[102:103]
    v_add_f32 v100, v100, v101
    v_add_f32 v102, v102, v103
    s_nop 0
    v_add_f32_dpp v100, v100, v100 row_ror:8 row_mask:0xf bank_mask:0xf
    v_add_f32_dpp v102, v102, v102 row_ror:8 row_mask:0xf bank_mask:0xf
    s_nop 0
    v_add_f32_dpp v100, v100, v100 row_ror:4 row_mask:0xf bank_mask:0xf
    v_add_f32_dpp v102, v102, v102 row_ror:4 row_mask:0xf bank_mask:0xf
    s_nop 0
    v_add_f32_dpp v100, v100, v100 row_ror:2 row_mask:0xf bank_mask:0xf
    v_add_f32_dpp v102, v102, v102 row_ror:2 row_mask:0xf bank_mask:0xf
    s_nop 0
    v_add_f32_dpp v100, v100, v100 row_ror:1 row_mask:0xf bank_mask:0xf
    v_add_f32_dpp v102, v102, v102 row_ror:1 row_mask:0xf bank_mask:0xf
    v_mul_f32 v100, 0x3acccccd, v100
    v_mul_f32 v102, 0x3acccccd, v102
    v_fma_f32 v102, -v100, v100, v102
    v_max_f32 v102, 0, v102
    v_add_f32 v102, 0x3727c5ac, v102
    v_rsq_f32 v80, v102
    s_nop 0
    v_mul_f32 v81, v100, v80
    s_mov_b64 exec, s[4:5]
    s_mov_b32 s33, 24457216
    buffer_store_dwordx2 v[20:21], v3, s[16:19], s33 offen sc1
    s_mov_b32 s33, 24457248
    buffer_store_dwordx2 v[40:41], v3, s[16:19], s33 offen sc1
    s_mov_b32 s33, 24457280
    buffer_store_dwordx2 v[60:61], v3, s[16:19], s33 offen sc1
    s_mov_b32 s33, 24457312
    buffer_store_dwordx2 v[80:81], v3, s[16:19], s33 offen sc1
    s_mov_b64 exec, -1
    s_waitcnt vmcnt(0) lgkmcnt(0)
    s_barrier
    s_cmp_lg_u32 s20, 0
    s_cbranch_scc1 L_p1_noflag
    s_lshl_b32 s31, s23, 2
    s_add_u32 s31, s31, 0
    v_mov_b32 v3, s31
    v_mov_b32 v4, 1
    s_mov_b64 exec, 1
    global_store_dword v3, v4, s[54:55] sc1
    s_mov_b64 exec, -1
L_p1_noflag:
    s_lshl_b32 s71, s23, 3
    s_add_u32 s71, s71, s20
    s_add_u32 s71, s71, 960
    s_lshl_b32 s72, s20, 12
    s_mov_b32 s12, s44
    s_and_b32 s13, s45, 0xffff
    s_mov_b32 s14, 819200
    s_mov_b32 s15, 0x00020000
L_p1_rtloop:
    s_cmp_ge_u32 s71, 960
    s_cbranch_scc1 L_rti_wos
    s_cmp_ge_u32 s71, 480
    s_cbranch_scc1 L_rti_w2s
    s_mul_i32 s74, s71, 1366
    s_lshr_b32 s74, s74, 16
    s_mul_i32 s75, s74, 48
    s_sub_u32 s75, s71, s75
    v_lshrrev_b32 v3, 2, v1
    v_mul_u32_u24 v3, 3072, v3
    v_and_b32 v4, 3, v1
    v_lshl_add_u32 v3, v4, 4, v3
    s_mul_i32 s76, s74, 196608
    s_lshl_b32 s77, s75, 6
    s_add_u32 s76, s76, s77
    s_add_u32 m0, s72, 0
    s_add_u32 s77, s76, 0
    buffer_load_dwordx4 v3, s[12:15], s77 offen lds
    s_add_u32 m0, s72, 1024
    s_add_u32 s77, s76, 49152
    buffer_load_dwordx4 v3, s[12:15], s77 offen lds
    s_add_u32 m0, s72, 2048
    s_add_u32 s77, s76, 98304
    buffer_load_dwordx4 v3, s[12:15], s77 offen lds
    s_add_u32 m0, s72, 3072
    s_add_u32 s77, s76, 147456
    buffer_load_dwordx4 v3, s[12:15], s77 offen lds
    s_branch L_rti_dones
L_rti_w2s:
    s_sub_u32 s75, s71, 480
    s_mul_i32 s74, s75, 6554
    s_lshr_b32 s74, s74, 16
    s_mul_i32 s76, s74, 10
    s_sub_u32 s75, s75, s76
    v_lshrrev_b32 v4, 3, v1
    v_lshrrev_b32 v5, 2, v4
    v_lshlrev_b32 v5, 3, v5
    v_and_b32 v4, 3, v4
    v_add_u32 v4, v4, v5
    v_mul_u32_u24 v3, 1280, v4
    v_and_b32 v4, 7, v1
    v_lshl_add_u32 v3, v4, 4, v3
    s_mul_i32 s76, s74, 40960
    s_lshl_b32 s77, s75, 7
    s_add_u32 s76, s76, s77
    s_add_u32 m0, s72, 0
    s_add_u32 s77, s76, 0
    buffer_load_dwordx4 v3, s[12:15], s77 offen lds
    s_add_u32 m0, s72, 1024
    s_add_u32 s77, s76, 5120
    buffer_load_dwordx4 v3, s[12:15], s77 offen lds
    s_add_u32 m0, s72, 2048
    s_add_u32 s77, s76, 20480
    buffer_load_dwordx4 v3, s[12:15], s77 offen lds
    s_add_u32 m0, s72, 3072
    s_add_u32 s77, s76, 25600
    buffer_load_dwordx4 v3, s[12:15], s77 offen lds
    s_branch L_rti_dones
L_rti_wos:
    s_sub_u32 s75, s71, 960
    s_mul_i32 s74, s75, 6554
    s_lshr_b32 s74, s74, 16
    s_mul_i32 s76, s74, 10
    s_sub_u32 s75, s75, s76
    v_lshrrev_b32 v4, 3, v1
    v_lshrrev_b32 v5, 2, v4
    v_and_b32 v4, 3, v4
    v_and_b32 v6, 7, v1
    v_lshlrev_b32 v6, 4, v6
    s_lshl_b32 s77, s75, 7
    s_lshl_b32 s76, s74, 1
    s_add_u32 s76, s76, 0
    s_mul_i32 s78, s76, 52
    s_lshr_b32 s78, s78, 8
    s_mul_i32 s79, s78, 5
    s_sub_u32 s76, s76, s79
    s_mul_i32 s78, s78, 80
    s_mul_i32 s76, s76, 20
    s_add_u32 s76, s76, 0
    s_cmp_eq_u32 s76, 80
    s_cselect_b32 s79, 20, 8
    s_cmov_b32 s76, 16
    s_add_u32 s76, s76, s78
    v_mul_u32_u24 v3, s79, v5
    v_add_u32 v3, v3, v4
    v_add_u32 v3, s76, v3
    v_mul_u32_u24 v3, 1280, v3
    v_add_u32 v3, v3, v6
    s_add_u32 m0, s72, 0
    s_nop 0
    buffer_load_dwordx4 v3, s[12:15], s77 offen lds
    s_lshl_b32 s76, s74, 1
    s_add_u32 s76, s76, 0
    s_mul_i32 s78, s76, 52
    s_lshr_b32 s78, s78, 8
    s_mul_i32 s79, s78, 5
    s_sub_u32 s76, s76, s79
    s_mul_i32 s78, s78, 80
    s_mul_i32 s76, s76, 20
    s_add_u32 s76, s76, 4
    s_cmp_eq_u32 s76, 84
    s_cselect_b32 s79, 20, 8
    s_cmov_b32 s76, 56
    s_add_u32 s76, s76, s78
    v_mul_u32_u24 v3, s79, v5
    v_add_u32 v3, v3, v4
    v_add_u32 v3, s76, v3
    v_mul_u32_u24 v3, 1280, v3
    v_add_u32 v3, v3, v6
    s_add_u32 m0, s72, 1024
    s_nop 0
    buffer_load_dwordx4 v3, s[12:15], s77 offen lds
    s_lshl_b32 s76, s74, 1
    s_add_u32 s76, s76, 1
    s_mul_i32 s78, s76, 52
    s_lshr_b32 s78, s78, 8
    s_mul_i32 s79, s78, 5
    s_sub_u32 s76, s76, s79
    s_mul_i32 s78, s78, 80
    s_mul_i32 s76, s76, 20
    s_add_u32 s76, s76, 0
    s_cmp_eq_u32 s76, 80
    s_cselect_b32 s79, 20, 8
    s_cmov_b32 s76, 16
    s_add_u32 s76, s76, s78
    v_mul_u32_u24 v3, s79, v5
    v_add_u32 v3, v3, v4
    v_add_u32 v3, s76, v3
    v_mul_u32_u24 v3, 1280, v3
    v_add_u32 v3, v3, v6
    s_add_u32 m0, s72, 2048
    s_nop 0
    buffer_load_dwordx4 v3, s[12:15], s77 offen lds
    s_lshl_b32 s76, s74, 1
    s_add_u32 s76, s76, 1
    s_mul_i32 s78, s76, 52
    s_lshr_b32 s78, s78, 8
    s_mul_i32 s79, s78, 5
    s_sub_u32 s76, s76, s79
    s_mul_i32 s78, s78, 80
    s_mul_i32 s76, s76, 20
    s_add_u32 s76, s76, 4
    s_cmp_eq_u32 s76, 84
    s_cselect_b32 s79, 20, 8
    s_cmov_b32 s76, 56
    s_add_u32 s76, s76, s78
    v_mul_u32_u24 v3, s79, v5
    v_add_u32 v3, v3, v4
    v_add_u32 v3, s76, v3
    v_mul_u32_u24 v3, 1280, v3
    v_add_u32 v3, v3, v6
    s_add_u32 m0, s72, 3072
    s_nop 0
    buffer_load_dwordx4 v3, s[12:15], s77 offen lds
L_rti_dones:
    s_waitcnt vmcnt(0)
    s_cmp_ge_u32 s71, 480
    s_cbranch_scc1 L_rtf_16s
    s_mul_i32 s74, s71, 1366
    s_lshr_b32 s74, s74, 16
    s_mul_i32 s75, s74, 48
    s_sub_u32 s75, s71, s75
    v_lshrrev_b32 v4, 5, v1
    v_lshlrev_b32 v4, 2, v4
    v_and_b32 v5, 15, v1
    v_lshrrev_b32 v5, 2, v5
    v_add_u32 v4, v4, v5
    v_lshlrev_b32 v4, 6, v4
    v_lshrrev_b32 v5, 4, v1
    v_and_b32 v5, 1, v5
    v_lshl_add_u32 v4, v5, 5, v4
    v_and_b32 v5, 3, v1
    v_lshl_add_u32 v4, v5, 3, v4
    v_add_u32 v4, s72, v4
    ds_read_b64_tr_b16 v[16:17], v4 offset:0
    ds_read_b64_tr_b16 v[18:19], v4 offset:512
    ds_read_b64_tr_b16 v[20:21], v4 offset:1024
    ds_read_b64_tr_b16 v[22:23], v4 offset:1536
    ds_read_b64_tr_b16 v[24:25], v4 offset:2048
    ds_read_b64_tr_b16 v[26:27], v4 offset:2560
    ds_read_b64_tr_b16 v[28:29], v4 offset:3072
    ds_read_b64_tr_b16 v[30:31], v4 offset:3584
    s_mul_i32 s76, s75, 86
    s_lshr_b32 s76, s76, 8
    s_mul_i32 s77, s76, 3
    s_sub_u32 s77, s75, s77
    s_mul_i32 s76, s76, 40
    s_lshl_b32 s78, s74, 2
    s_add_u32 s76, s76, s78
    s_mul_i32 s76, s76, 3
    s_add_u32 s76, s76, s77
    s_lshl_b32 s76, s76, 10
    s_add_u32 s76, s76, 20283392
    v_lshlrev_b32 v3, 4, v1
    s_waitcnt lgkmcnt(0)
    s_add_u32 s77, s76, 0
    buffer_store_dwordx4 v[16:19], v3, s[16:19], s77 offen sc1
    s_add_u32 s77, s76, 3072
    buffer_store_dwordx4 v[20:23], v3, s[16:19], s77 offen sc1
    s_add_u32 s77, s76, 6144
    buffer_store_dwordx4 v[24:27], v3, s[16:19], s77 offen sc1
    s_add_u32 s77, s76, 9216
    buffer_store_dwordx4 v[28:31], v3, s[16:19], s77 offen sc1
    v_mov_b32 v4, 0
    v_mov_b32 v5, 0
    v_lshlrev_b32 v6, 16, v16
    v_add_f32 v4, v4, v6
    v_and_b32 v6, 0xffff0000, v16
    v_add_f32 v5, v5, v6
    v_lshlrev_b32 v6, 16, v17
    v_add_f32 v4, v4, v6
    v_and_b32 v6, 0xffff0000, v17
    v_add_f32 v5, v5, v6
    v_lshlrev_b32 v6, 16, v18
    v_add_f32 v4, v4, v6
    v_and_b32 v6, 0xffff0000, v18
    v_add_f32 v5, v5, v6
    v_lshlrev_b32 v6, 16, v19
    v_add_f32 v4, v4, v6
    v_and_b32 v6, 0xffff0000, v19
    v_add_f32 v5, v5, v6
    v_lshlrev_b32 v6, 16, v20
    v_add_f32 v4, v4, v6
    v_and_b32 v6, 0xffff0000, v20
    v_add_f32 v5, v5, v6
    v_lshlrev_b32 v6, 16, v21
    v_add_f32 v4, v4, v6
    v_and_b32 v6, 0xffff0000, v21
    v_add_f32 v5, v5, v6
    v_lshlrev_b32 v6, 16, v22
    v_add_f32 v4, v4, v6
    v_and_b32 v6, 0xffff0000, v22
    v_add_f32 v5, v5, v6
    v_lshlrev_b32 v6, 16, v23
    v_add_f32 v4, v4, v6
    v_and_b32 v6, 0xffff0000, v23
    v_add_f32 v5, v5, v6
    v_lshlrev_b32 v6, 16, v24
    v_add_f32 v4, v4, v6
    v_and_b32 v6, 0xffff0000, v24
    v_add_f32 v5, v5, v6
    v_lshlrev_b32 v6, 16, v25
    v_add_f32 v4, v4, v6
    v_and_b32 v6, 0xffff0000, v25
    v_add_f32 v5, v5, v6
    v_lshlrev_b32 v6, 16, v26
    v_add_f32 v4, v4, v6
    v_and_b32 v6, 0xffff0000, v26
    v_add_f32 v5, v5, v6
    v_lshlrev_b32 v6, 16, v27
    v_add_f32 v4, v4, v6
    v_and_b32 v6, 0xffff0000, v27
    v_add_f32 v5, v5, v6
    v_lshlrev_b32 v6, 16, v28
    v_add_f32 v4, v4, v6
    v_and_b32 v6, 0xffff0000, v28
    v_add_f32 v5, v5, v6
    v_lshlrev_b32 v6, 16, v29
    v_add_f32 v4, v4, v6
    v_and_b32 v6, 0xffff0000, v29
    v_add_f32 v5, v5, v6
    v_lshlrev_b32 v6, 16, v30
    v_add_f32 v4, v4, v6
    v_and_b32 v6, 0xffff0000, v30
    v_add_f32 v5, v5, v6
    v_lshlrev_b32 v6, 16, v31
    v_add_f32 v4, v4, v6
    v_and_b32 v6, 0xffff0000, v31
    v_add_f32 v5, v5, v6
    v_add_f32 v4, v4, v5
    v_mov_b32 v5, v4
    s_nop 1
    v_permlane32_swap_b32 v4, v5
    v_add_f32 v4, v4, v5
    v_and_b32 v5, 31, v1
    v_lshlrev_b32 v5, 2, v5
    s_mul_i32 s76, s74, 6144
    s_lshl_b32 s77, s75, 7
    s_add_u32 s76, s76, s77
    s_add_u32 s76, s76, 24215552
    buffer_store_dword v4, v5, s[16:19], s76 offen sc1
    s_branch L_rtf_dones
L_rtf_16s:
    s_cmp_ge_u32 s71, 960
    s_mov_b32 s75, 480
    s_cmov_b32 s75, 960
    s_mov_b32 s76, 22249472
    s_cmov_b32 s76, 19464192
    s_mov_b32 s78, 245760
    s_cmov_b32 s78, 102400
    s_sub_u32 s75, s71, s75
    s_mul_i32 s74, s75, 6554
    s_lshr_b32 s74, s74, 16
    s_mul_i32 s77, s74, 10
    s_sub_u32 s75, s75, s77
    s_mul_i32 s74, s74, 5120
    s_add_u32 s76, s76, s74
    s_lshl_b32 s77, s75, 2
    v_lshrrev_b32 v4, 4, v1
    v_lshlrev_b32 v4, 3, v4
    v_and_b32 v5, 15, v1
    v_lshrrev_b32 v5, 2, v5
    v_add_u32 v4, v4, v5
    v_lshlrev_b32 v4, 7, v4
    v_and_b32 v5, 3, v1
    v_lshl_add_u32 v4, v5, 3, v4
    v_add_u32 v4, s72, v4
    ds_read_b64_tr_b16 v[16:17], v4 offset:0
    ds_read_b64_tr_b16 v[18:19], v4 offset:512
    ds_read_b64_tr_b16 v[20:21], v4 offset:32
    ds_read_b64_tr_b16 v[22:23], v4 offset:544
    ds_read_b64_tr_b16 v[24:25], v4 offset:64
    ds_read_b64_tr_b16 v[26:27], v4 offset:576
    ds_read_b64_tr_b16 v[28:29], v4 offset:96
    ds_read_b64_tr_b16 v[30:31], v4 offset:608
    v_lshlrev_b32 v3, 4, v1
    s_waitcnt lgkmcnt(0)
    s_add_u32 s79, s77, 0
    s_mul_i32 s74, s79, 52
    s_lshr_b32 s74, s74, 8
    s_mul_i32 s75, s74, 5
    s_sub_u32 s75, s79, s75
    s_mul_i32 s74, s74, s78
    s_lshl_b32 s75, s75, 10
    s_add_u32 s74, s74, s75
    s_add_u32 s74, s74, s76
    buffer_store_dwordx4 v[16:19], v3, s[16:19], s74 offen sc1
    s_add_u32 s79, s77, 1
    s_mul_i32 s74, s79, 52
    s_lshr_b32 s74, s74, 8
    s_mul_i32 s75, s74, 5
    s_sub_u32 s75, s79, s75
    s_mul_i32 s74, s74, s78
    s_lshl_b32 s75, s75, 10
    s_add_u32 s74, s74, s75
    s_add_u32 s74, s74, s76
    buffer_store_dwordx4 v[20:23], v3, s[16:19], s74 offen sc1
    s_add_u32 s79, s77, 2
    s_mul_i32 s74, s79, 52
    s_lshr_b32 s74, s74, 8
    s_mul_i32 s75, s74, 5
    s_sub_u32 s75, s79, s75
    s_mul_i32 s74, s74, s78
    s_lshl_b32 s75, s75, 10
    s_add_u32 s74, s74, s75
    s_add_u32 s74, s74, s76
    buffer_store_dwordx4 v[24:27], v3, s[16:19], s74 offen sc1
    s_add_u32 s79, s77, 3
    s_mul_i32 s74, s79, 52
    s_lshr_b32 s74, s74, 8
    s_mul_i32 s75, s74, 5
    s_sub_u32 s75, s79, s75
    s_mul_i32 s74, s74, s78
    s_lshl_b32 s75, s75, 10
    s_add_u32 s74, s74, s75
    s_add_u32 s74, s74, s76
    buffer_store_dwordx4 v[28:31], v3, s[16:19], s74 offen sc1
L_rtf_dones:
    s_add_u32 s71, s71, 128
    s_waitcnt lgkmcnt(0)
    s_cmp_lt_u32 s71, 1160
    s_cbranch_scc1 L_p1_rtloop
    v_mov_b32 v3, 64
    s_mov_b32 s32, 0
L_p1_zpoll:
    global_load_dword v4, v3, s[54:55] sc1
    s_add_u32 s32, s32, 1
    s_waitcnt vmcnt(0)
    v_readfirstlane_b32 s33, v4
    s_cmp_gt_u32 s32, 40000
    s_cbranch_scc1 L_p1_zok
    s_nop 1
    s_cmp_eq_u32 s33, 0
    s_cbranch_scc1 L_p1_zpoll
L_p1_zok:
    s_barrier
    s_cmp_lg_u32 s20, 0
    s_cbranch_scc1 L_p1_wait
    s_mov_b32 s31, 24438912
    v_mov_b32 v3, 0
    v_mov_b32 v4, 1
    s_mov_b64 exec, 1
    buffer_atomic_add v4, v3, s[16:19], s31 offen sc1
    s_mov_b64 exec, -1
    s_branch L_p1_wait
L_p1_compute:
    s_lshr_b32 s35, s21, 1
    s_and_b32 s36, s21, 1
    v_and_b32 v20, 31, v1
    v_lshrrev_b32 v21, 5, v1
    s_mov_b32 s70, 0
    s_lshl_b32 s68, s35, 1
    s_add_u32 s69, s68, 1
    s_lshl_b32 s82, s36, 1
    s_add_u32 s83, s82, 1
    v_lshrrev_b32 v3, 3, v20
    v_mul_u32_u24 v3, 1040, v3
    v_and_b32 v4, 7, v20
    v_lshl_add_u32 v3, v4, 6, v3
    v_lshl_add_u32 v3, v21, 4, v3
    s_mul_i32 s32, s68, 4160
    v_add_u32 v16, s32, v3
    v_add_u32 v17, 4160, v16
    v_and_b32 v3, 15, v1
    v_lshrrev_b32 v4, 2, v3
    v_lshlrev_b32 v5, 3, v21
    v_add_u32 v5, v5, v4
    v_lshlrev_b32 v5, 8, v5
    v_lshrrev_b32 v6, 4, v1
    v_and_b32 v6, 1, v6
    v_lshlrev_b32 v6, 5, v6
    v_add_u32 v5, v5, v6
    v_and_b32 v6, 3, v1
    v_lshl_add_u32 v5, v6, 3, v5
    v_add_u32 v5, 16640, v5
    v_xor_b32 v6, s82, v4
    v_lshl_add_u32 v18, v6, 6, v5
    v_xor_b32 v19, 64, v18
    v_mov_b32 v24, 0
    v_mov_b32 v25, 0
    v_mov_b32 v26, 0
    v_mov_b32 v27, 0
    v_mov_b32 v28, 0
    v_mov_b32 v29, 0
    v_mov_b32 v30, 0
    v_mov_b32 v31, 0
    v_mov_b32 v32, 0
    v_mov_b32 v33, 0
    v_mov_b32 v34, 0
    v_mov_b32 v35, 0
    v_mov_b32 v36, 0
    v_mov_b32 v37, 0
    v_mov_b32 v38, 0
    v_mov_b32 v39, 0
    v_mov_b32 v40, 0
    v_mov_b32 v41, 0
    v_mov_b32 v42, 0
    v_mov_b32 v43, 0
    v_mov_b32 v44, 0
    v_mov_b32 v45, 0
    v_mov_b32 v46, 0
    v_mov_b32 v47, 0
    v_mov_b32 v48, 0
    v_mov_b32 v49, 0
    v_mov_b32 v50, 0
    v_mov_b32 v51, 0
    v_mov_b32 v52, 0
    v_mov_b32 v53, 0
    v_mov_b32 v54, 0
    v_mov_b32 v55, 0
    v_mov_b32 v56, 0
    v_mov_b32 v57, 0
    v_mov_b32 v58, 0
    v_mov_b32 v59, 0
    v_mov_b32 v60, 0
    v_mov_b32 v61, 0
    v_mov_b32 v62, 0
    v_mov_b32 v63, 0
    v_mov_b32 v64, 0
    v_mov_b32 v65, 0
    v_mov_b32 v66, 0
    v_mov_b32 v67, 0
    v_mov_b32 v68, 0
    v_mov_b32 v69, 0
    v_mov_b32 v70, 0
    v_mov_b32 v71, 0
    v_mov_b32 v72, 0
    v_mov_b32 v73, 0
    v_mov_b32 v74, 0
    v_mov_b32 v75, 0
    v_mov_b32 v76, 0
    v_mov_b32 v77, 0
    v_mov_b32 v78, 0
    v_mov_b32 v79, 0
    v_mov_b32 v80, 0
    v_mov_b32 v81, 0
    v_mov_b32 v82, 0
    v_mov_b32 v83, 0
    v_mov_b32 v84, 0
    v_mov_b32 v85, 0
    v_mov_b32 v86, 0
    v_mov_b32 v87, 0
    v_mov_b32 v120, 0
    v_mov_b32 v121, 0
    v_mov_b32 v122, 0
    v_mov_b32 v123, 0
    s_cmp_eq_u32 s25, 2
    s_cbranch_scc1 L_p1_vaddr
    s_cmp_eq_u32 s25, 0
    s_mov_b32 s72, 327680
    s_cmov_b32 s72, 163840
    s_mov_b32 s73, 5120
    s_cmov_b32 s73, 2560
    s_mov_b32 s74, 2621440
    s_cmov_b32 s74, 0
    s_mul_i32 s32, s25, 5
    s_sub_u32 s32, s24, s32
    s_lshl_b32 s77, s32, 4
    s_lshl_b32 s32, s23, 2
    s_add_u32 s32, s32, s68
    s_mul_i32 s32, s32, s73
    s_add_u32 s75, s32, s74
    s_lshl_b32 s32, s23, 2
    s_add_u32 s32, s32, s69
    s_mul_i32 s32, s32, s73
    s_add_u32 s76, s32, s74
    v_lshlrev_b32 v6, 4, v20
    s_lshl_b32 s32, s82, 2
    s_add_u32 s32, s32, s77
    s_add_u32 s32, s32, 0
    v_add_u32 v4, s32, v21
    v_mul_u32_u24 v5, 205, v4
    v_lshrrev_b32 v5, 10, v5
    v_mul_u32_u24 v120, 5, v5
    v_sub_u32 v4, v4, v120
    v_mul_lo_u32 v120, v5, s72
    v_add_u32 v120, v120, v6
    v_lshl_add_u32 v120, v4, 9, v120
    s_lshl_b32 s32, s82, 2
    s_add_u32 s32, s32, s77
    s_add_u32 s32, s32, 2
    v_add_u32 v4, s32, v21
    v_mul_u32_u24 v5, 205, v4
    v_lshrrev_b32 v5, 10, v5
    v_mul_u32_u24 v121, 5, v5
    v_sub_u32 v4, v4, v121
    v_mul_lo_u32 v121, v5, s72
    v_add_u32 v121, v121, v6
    v_lshl_add_u32 v121, v4, 9, v121
    s_lshl_b32 s32, s83, 2
    s_add_u32 s32, s32, s77
    s_add_u32 s32, s32, 0
    v_add_u32 v4, s32, v21
    v_mul_u32_u24 v5, 205, v4
    v_lshrrev_b32 v5, 10, v5
    v_mul_u32_u24 v122, 5, v5
    v_sub_u32 v4, v4, v122
    v_mul_lo_u32 v122, v5, s72
    v_add_u32 v122, v122, v6
    v_lshl_add_u32 v122, v4, 9, v122
    s_lshl_b32 s32, s83, 2
    s_add_u32 s32, s32, s77
    s_add_u32 s32, s32, 2
    v_add_u32 v4, s32, v21
    v_mul_u32_u24 v5, 205, v4
    v_lshrrev_b32 v5, 10, v5
    v_mul_u32_u24 v123, 5, v5
    v_sub_u32 v4, v4, v123
    v_mul_lo_u32 v123, v5, s72
    v_add_u32 v123, v123, v6
    v_lshl_add_u32 v123, v4, 9, v123
    s_branch L_p1_addrdone
L_p1_vaddr:
    s_sub_u32 s32, s24, 10
    s_lshl_b32 s77, s32, 7
    s_lshl_b32 s32, s82, 5
    s_add_u32 s32, s32, s77
    v_add_u32 v4, s32, v20
    v_mul_u32_u24 v5, 3277, v4
    v_lshrrev_b32 v5, 16, v5
    v_mul_u32_u24 v6, 20, v5
    v_sub_u32 v4, v4, v6
    v_lshrrev_b32 v6, 1, v5
    v_mul_u32_u24 v120, 327680, v6
    v_and_b32 v6, 1, v5
    v_mul_u32_u24 v6, 1280, v6
    v_add_u32 v120, v120, v6
    v_lshl_add_u32 v120, v4, 4, v120
    v_mul_u32_u24 v6, 320, v21
    v_add_u32 v120, v120, v6
    s_lshl_b32 s32, s83, 5
    s_add_u32 s32, s32, s77
    v_add_u32 v4, s32, v20
    v_mul_u32_u24 v5, 3277, v4
    v_lshrrev_b32 v5, 16, v5
    v_mul_u32_u24 v6, 20, v5
    v_sub_u32 v4, v4, v6
    v_lshrrev_b32 v6, 1, v5
    v_mul_u32_u24 v121, 327680, v6
    v_and_b32 v6, 1, v5
    v_mul_u32_u24 v6, 1280, v6
    v_add_u32 v121, v121, v6
    v_lshl_add_u32 v121, v4, 4, v121
    v_mul_u32_u24 v6, 320, v21
    v_add_u32 v121, v121, v6
    s_lshl_b32 s32, s23, 2
    s_add_u32 s32, s32, s68
    s_mul_i32 s32, s32, 5120
    s_add_u32 s75, s32, 2624000
    s_lshl_b32 s32, s23, 2
    s_add_u32 s32, s32, s69
    s_mul_i32 s32, s32, 5120
    s_add_u32 s76, s32, 2624000
L_p1_addrdone:
    s_cmp_eq_u32 s25, 2
    s_cbranch_scc1 L_p1_vmain
    s_barrier
    ds_read_b128 v[88:91], v16 offset:0
    ds_read_b64_tr_b16 v[104:105], v18 offset:0
    ds_read_b64_tr_b16 v[106:107], v18 offset:1024
    ds_read_b128 v[92:95], v17 offset:0
    ds_read_b64_tr_b16 v[108:109], v19 offset:0
    ds_read_b64_tr_b16 v[110:111], v19 offset:1024
    s_mov_b32 s28, 0
.p2align 3
L_p1_loopq:
    s_and_b32 s31, s28, 3
    s_cmp_eq_u32 s31, 3
    s_mov_b32 s29, 33024
    s_cmov_b32 s29, 4294868224
    s_add_u32 s28, s28, 1
    s_cmp_lt_u32 s28, 10
    s_waitcnt lgkmcnt(0)
    v_mfma_f32_32x32x16_bf16 v[24:39], v[104:107], v[88:91], v[24:39]
    ds_read_b128 v[96:99], v16 offset:32
    ds_read_b64_tr_b16 v[112:113], v18 offset:4096
    ds_read_b64_tr_b16 v[114:115], v18 offset:5120
    v_mfma_f32_32x32x16_bf16 v[40:55], v[104:107], v[92:95], v[40:55]
    ds_read_b128 v[100:103], v17 offset:32
    ds_read_b64_tr_b16 v[116:117], v19 offset:4096
    ds_read_b64_tr_b16 v[118:119], v19 offset:5120
    v_mfma_f32_32x32x16_bf16 v[56:71], v[108:111], v[88:91], v[56:71]
    v_mfma_f32_32x32x16_bf16 v[72:87], v[108:111], v[92:95], v[72:87]
    s_waitcnt lgkmcnt(0)
    v_mfma_f32_32x32x16_bf16 v[24:39], v[112:115], v[96:99], v[24:39]
    ds_read_b128 v[88:91], v16 offset:512
    ds_read_b64_tr_b16 v[104:105], v18 offset:8192
    ds_read_b64_tr_b16 v[106:107], v18 offset:9216
    v_mfma_f32_32x32x16_bf16 v[40:55], v[112:115], v[100:103], v[40:55]
    ds_read_b128 v[92:95], v17 offset:512
    ds_read_b64_tr_b16 v[108:109], v19 offset:8192
    ds_read_b64_tr_b16 v[110:111], v19 offset:9216
    v_mfma_f32_32x32x16_bf16 v[56:71], v[116:119], v[96:99], v[56:71]
    v_mfma_f32_32x32x16_bf16 v[72:87], v[116:119], v[100:103], v[72:87]
    s_waitcnt lgkmcnt(0)
    v_mfma_f32_32x32x16_bf16 v[24:39], v[104:107], v[88:91], v[24:39]
    ds_read_b128 v[96:99], v16 offset:544
    ds_read_b64_tr_b16 v[112:113], v18 offset:12288
    ds_read_b64_tr_b16 v[114:115], v18 offset:13312
    v_mfma_f32_32x32x16_bf16 v[40:55], v[104:107], v[92:95], v[40:55]
    ds_read_b128 v[100:103], v17 offset:544
    ds_read_b64_tr_b16 v[116:117], v19 offset:12288
    ds_read_b64_tr_b16 v[118:119], v19 offset:13312
    v_mfma_f32_32x32x16_bf16 v[56:71], v[108:111], v[88:91], v[56:71]
    v_mfma_f32_32x32x16_bf16 v[72:87], v[108:111], v[92:95], v[72:87]
    s_waitcnt lgkmcnt(0)
    s_barrier
    v_add_u32 v16, s29, v16
    v_add_u32 v17, s29, v17
    v_add_u32 v18, s29, v18
    v_add_u32 v19, s29, v19
    v_mfma_f32_32x32x16_bf16 v[24:39], v[112:115], v[96:99], v[24:39]
    ds_read_b128 v[88:91], v16 offset:0
    ds_read_b64_tr_b16 v[104:105], v18 offset:0
    ds_read_b64_tr_b16 v[106:107], v18 offset:1024
    v_mfma_f32_32x32x16_bf16 v[40:55], v[112:115], v[100:103], v[40:55]
    ds_read_b128 v[92:95], v17 offset:0
    ds_read_b64_tr_b16 v[108:109], v19 offset:0
    ds_read_b64_tr_b16 v[110:111], v19 offset:1024
    v_mfma_f32_32x32x16_bf16 v[56:71], v[116:119], v[96:99], v[56:71]
    v_mfma_f32_32x32x16_bf16 v[72:87], v[116:119], v[100:103], v[72:87]
    s_cbranch_scc1 L_p1_loopq
    s_waitcnt lgkmcnt(0)
    s_barrier
    v_lshlrev_b32 v3, 2, v20
    s_lshl_b32 s32, s68, 7
    s_add_u32 s32, s32, 132096
    v_add_u32 v4, s32, v3
    ds_read_b32 v126, v4
    ds_read_b32 v127, v4 offset:512
    s_lshl_b32 s32, s69, 7
    s_add_u32 s32, s32, 132096
    v_add_u32 v4, s32, v3
    ds_read_b32 v128, v4
    ds_read_b32 v129, v4 offset:512
    s_lshl_b32 s32, s82, 7
    s_add_u32 s32, s32, 133120
    v_lshlrev_b32 v4, 4, v21
    v_add_u32 v4, s32, v4
    ds_read_b128 v[132:135], v4 offset:0
    ds_read_b128 v[136:139], v4 offset:32
    ds_read_b128 v[140:143], v4 offset:64
    ds_read_b128 v[144:147], v4 offset:96
    s_waitcnt lgkmcnt(0)
    v_pk_mul_f32 v[152:153], v[132:133], v[126:127] op_sel:[0,1] op_sel_hi:[1,1]
    v_pk_fma_f32 v[24:25], v[24:25], v[126:127], v[152:153] op_sel_hi:[1,0,1] neg_lo:[0,0,1] neg_hi:[0,0,1]
    v_pk_mul_f32 v[152:153], v[134:135], v[126:127] op_sel:[0,1] op_sel_hi:[1,1]
    v_pk_fma_f32 v[26:27], v[26:27], v[126:127], v[152:153] op_sel_hi:[1,0,1] neg_lo:[0,0,1] neg_hi:[0,0,1]
    v_cvt_pk_bf16_f32 v172, v24, v25
    v_cvt_pk_bf16_f32 v173, v26, v27
    v_pk_mul_f32 v[152:153], v[136:137], v[126:127] op_sel:[0,1] op_sel_hi:[1,1]
    v_pk_fma_f32 v[28:29], v[28:29], v[126:127], v[152:153] op_sel_hi:[1,0,1] neg_lo:[0,0,1] neg_hi:[0,0,1]
    v_pk_mul_f32 v[152:153], v[138:139], v[126:127] op_sel:[0,1] op_sel_hi:[1,1]
    v_pk_fma_f32 v[30:31], v[30:31], v[126:127], v[152:153] op_sel_hi:[1,0,1] neg_lo:[0,0,1] neg_hi:[0,0,1]
    v_cvt_pk_bf16_f32 v174, v28, v29
    v_cvt_pk_bf16_f32 v175, v30, v31
    s_nop 0
    v_permlane32_swap_b32 v172, v174
    v_permlane32_swap_b32 v173, v175
    buffer_store_dwordx4 v[172:175], v120, s[16:19], s75 offen sc1
    v_pk_mul_f32 v[152:153], v[132:133], v[128:129] op_sel:[0,1] op_sel_hi:[1,1]
    v_pk_fma_f32 v[40:41], v[40:41], v[128:129], v[152:153] op_sel_hi:[1,0,1] neg_lo:[0,0,1] neg_hi:[0,0,1]
    v_pk_mul_f32 v[152:153], v[134:135], v[128:129] op_sel:[0,1] op_sel_hi:[1,1]
    v_pk_fma_f32 v[42:43], v[42:43], v[128:129], v[152:153] op_sel_hi:[1,0,1] neg_lo:[0,0,1] neg_hi:[0,0,1]
    v_cvt_pk_bf16_f32 v176, v40, v41
    v_cvt_pk_bf16_f32 v177, v42, v43
    v_pk_mul_f32 v[152:153], v[136:137], v[128:129] op_sel:[0,1] op_sel_hi:[1,1]
    v_pk_fma_f32 v[44:45], v[44:45], v[128:129], v[152:153] op_sel_hi:[1,0,1] neg_lo:[0,0,1] neg_hi:[0,0,1]
    v_pk_mul_f32 v[152:153], v[138:139], v[128:129] op_sel:[0,1] op_sel_hi:[1,1]
    v_pk_fma_f32 v[46:47], v[46:47], v[128:129], v[152:153] op_sel_hi:[1,0,1] neg_lo:[0,0,1] neg_hi:[0,0,1]
    v_cvt_pk_bf16_f32 v178, v44, v45
    v_cvt_pk_bf16_f32 v179, v46, v47
    s_nop 0
    v_permlane32_swap_b32 v176, v178
    v_permlane32_swap_b32 v177, v179
    buffer_store_dwordx4 v[176:179], v120, s[16:19], s76 offen sc1
    v_pk_mul_f32 v[152:153], v[140:141], v[126:127] op_sel:[0,1] op_sel_hi:[1,1]
    v_pk_fma_f32 v[32:33], v[32:33], v[126:127], v[152:153] op_sel_hi:[1,0,1] neg_lo:[0,0,1] neg_hi:[0,0,1]
    v_pk_mul_f32 v[152:153], v[142:143], v[126:127] op_sel:[0,1] op_sel_hi:[1,1]
    v_pk_fma_f32 v[34:35], v[34:35], v[126:127], v[152:153] op_sel_hi:[1,0,1] neg_lo:[0,0,1] neg_hi:[0,0,1]
    v_cvt_pk_bf16_f32 v172, v32, v33
    v_cvt_pk_bf16_f32 v173, v34, v35
    v_pk_mul_f32 v[152:153], v[144:145], v[126:127] op_sel:[0,1] op_sel_hi:[1,1]
    v_pk_fma_f32 v[36:37], v[36:37], v[126:127], v[152:153] op_sel_hi:[1,0,1] neg_lo:[0,0,1] neg_hi:[0,0,1]
    v_pk_mul_f32 v[152:153], v[146:147], v[126:127] op_sel:[0,1] op_sel_hi:[1,1]
    v_pk_fma_f32 v[38:39], v[38:39], v[126:127], v[152:153] op_sel_hi:[1,0,1] neg_lo:[0,0,1] neg_hi:[0,0,1]
    v_cvt_pk_bf16_f32 v174, v36, v37
    v_cvt_pk_bf16_f32 v175, v38, v39
    s_nop 0
    v_permlane32_swap_b32 v172, v174
    v_permlane32_swap_b32 v173, v175
    buffer_store_dwordx4 v[172:175], v121, s[16:19], s75 offen sc1
    v_pk_mul_f32 v[152:153], v[140:141], v[128:129] op_sel:[0,1] op_sel_hi:[1,1]
    v_pk_fma_f32 v[48:49], v[48:49], v[128:129], v[152:153] op_sel_hi:[1,0,1] neg_lo:[0,0,1] neg_hi:[0,0,1]
    v_pk_mul_f32 v[152:153], v[142:143], v[128:129] op_sel:[0,1] op_sel_hi:[1,1]
    v_pk_fma_f32 v[50:51], v[50:51], v[128:129], v[152:153] op_sel_hi:[1,0,1] neg_lo:[0,0,1] neg_hi:[0,0,1]
    v_cvt_pk_bf16_f32 v176, v48, v49
    v_cvt_pk_bf16_f32 v177, v50, v51
    v_pk_mul_f32 v[152:153], v[144:145], v[128:129] op_sel:[0,1] op_sel_hi:[1,1]
    v_pk_fma_f32 v[52:53], v[52:53], v[128:129], v[152:153] op_sel_hi:[1,0,1] neg_lo:[0,0,1] neg_hi:[0,0,1]
    v_pk_mul_f32 v[152:153], v[146:147], v[128:129] op_sel:[0,1] op_sel_hi:[1,1]
    v_pk_fma_f32 v[54:55], v[54:55], v[128:129], v[152:153] op_sel_hi:[1,0,1] neg_lo:[0,0,1] neg_hi:[0,0,1]
    v_cvt_pk_bf16_f32 v178, v52, v53
    v_cvt_pk_bf16_f32 v179, v54, v55
    s_nop 0
    v_permlane32_swap_b32 v176, v178
    v_permlane32_swap_b32 v177, v179
    buffer_store_dwordx4 v[176:179], v121, s[16:19], s76 offen sc1
    s_lshl_b32 s32, s83, 7
    s_add_u32 s32, s32, 133120
    v_lshlrev_b32 v4, 4, v21
    v_add_u32 v4, s32, v4
    ds_read_b128 v[132:135], v4 offset:0
    ds_read_b128 v[136:139], v4 offset:32
    ds_read_b128 v[140:143], v4 offset:64
    ds_read_b128 v[144:147], v4 offset:96
    s_waitcnt lgkmcnt(0)
    v_pk_mul_f32 v[152:153], v[132:133], v[126:127] op_sel:[0,1] op_sel_hi:[1,1]
    v_pk_fma_f32 v[56:57], v[56:57], v[126:127], v[152:153] op_sel_hi:[1,0,1] neg_lo:[0,0,1] neg_hi:[0,0,1]
    v_pk_mul_f32 v[152:153], v[134:135], v[126:127] op_sel:[0,1] op_sel_hi:[1,1]
    v_pk_fma_f32 v[58:59], v[58:59], v[126:127], v[152:153] op_sel_hi:[1,0,1] neg_lo:[0,0,1] neg_hi:[0,0,1]
    v_cvt_pk_bf16_f32 v172, v56, v57
    v_cvt_pk_bf16_f32 v173, v58, v59
    v_pk_mul_f32 v[152:153], v[136:137], v[126:127] op_sel:[0,1] op_sel_hi:[1,1]
    v_pk_fma_f32 v[60:61], v[60:61], v[126:127], v[152:153] op_sel_hi:[1,0,1] neg_lo:[0,0,1] neg_hi:[0,0,1]
    v_pk_mul_f32 v[152:153], v[138:139], v[126:127] op_sel:[0,1] op_sel_hi:[1,1]
    v_pk_fma_f32 v[62:63], v[62:63], v[126:127], v[152:153] op_sel_hi:[1,0,1] neg_lo:[0,0,1] neg_hi:[0,0,1]
    v_cvt_pk_bf16_f32 v174, v60, v61
    v_cvt_pk_bf16_f32 v175, v62, v63
    s_nop 0
    v_permlane32_swap_b32 v172, v174
    v_permlane32_swap_b32 v173, v175
    buffer_store_dwordx4 v[172:175], v122, s[16:19], s75 offen sc1
    v_pk_mul_f32 v[152:153], v[132:133], v[128:129] op_sel:[0,1] op_sel_hi:[1,1]
    v_pk_fma_f32 v[72:73], v[72:73], v[128:129], v[152:153] op_sel_hi:[1,0,1] neg_lo:[0,0,1] neg_hi:[0,0,1]
    v_pk_mul_f32 v[152:153], v[134:135], v[128:129] op_sel:[0,1] op_sel_hi:[1,1]
    v_pk_fma_f32 v[74:75], v[74:75], v[128:129], v[152:153] op_sel_hi:[1,0,1] neg_lo:[0,0,1] neg_hi:[0,0,1]
    v_cvt_pk_bf16_f32 v176, v72, v73
    v_cvt_pk_bf16_f32 v177, v74, v75
    v_pk_mul_f32 v[152:153], v[136:137], v[128:129] op_sel:[0,1] op_sel_hi:[1,1]
    v_pk_fma_f32 v[76:77], v[76:77], v[128:129], v[152:153] op_sel_hi:[1,0,1] neg_lo:[0,0,1] neg_hi:[0,0,1]
    v_pk_mul_f32 v[152:153], v[138:139], v[128:129] op_sel:[0,1] op_sel_hi:[1,1]
    v_pk_fma_f32 v[78:79], v[78:79], v[128:129], v[152:153] op_sel_hi:[1,0,1] neg_lo:[0,0,1] neg_hi:[0,0,1]
    v_cvt_pk_bf16_f32 v178, v76, v77
    v_cvt_pk_bf16_f32 v179, v78, v79
    s_nop 0
    v_permlane32_swap_b32 v176, v178
    v_permlane32_swap_b32 v177, v179
    buffer_store_dwordx4 v[176:179], v122, s[16:19], s76 offen sc1
    v_pk_mul_f32 v[152:153], v[140:141], v[126:127] op_sel:[0,1] op_sel_hi:[1,1]
    v_pk_fma_f32 v[64:65], v[64:65], v[126:127], v[152:153] op_sel_hi:[1,0,1] neg_lo:[0,0,1] neg_hi:[0,0,1]
    v_pk_mul_f32 v[152:153], v[142:143], v[126:127] op_sel:[0,1] op_sel_hi:[1,1]
    v_pk_fma_f32 v[66:67], v[66:67], v[126:127], v[152:153] op_sel_hi:[1,0,1] neg_lo:[0,0,1] neg_hi:[0,0,1]
    v_cvt_pk_bf16_f32 v172, v64, v65
    v_cvt_pk_bf16_f32 v173, v66, v67
    v_pk_mul_f32 v[152:153], v[144:145], v[126:127] op_sel:[0,1] op_sel_hi:[1,1]
    v_pk_fma_f32 v[68:69], v[68:69], v[126:127], v[152:153] op_sel_hi:[1,0,1] neg_lo:[0,0,1] neg_hi:[0,0,1]
    v_pk_mul_f32 v[152:153], v[146:147], v[126:127] op_sel:[0,1] op_sel_hi:[1,1]
    v_pk_fma_f32 v[70:71], v[70:71], v[126:127], v[152:153] op_sel_hi:[1,0,1] neg_lo:[0,0,1] neg_hi:[0,0,1]
    v_cvt_pk_bf16_f32 v174, v68, v69
    v_cvt_pk_bf16_f32 v175, v70, v71
    s_nop 0
    v_permlane32_swap_b32 v172, v174
    v_permlane32_swap_b32 v173, v175
    buffer_store_dwordx4 v[172:175], v123, s[16:19], s75 offen sc1
    v_pk_mul_f32 v[152:153], v[140:141], v[128:129] op_sel:[0,1] op_sel_hi:[1,1]
    v_pk_fma_f32 v[80:81], v[80:81], v[128:129], v[152:153] op_sel_hi:[1,0,1] neg_lo:[0,0,1] neg_hi:[0,0,1]
    v_pk_mul_f32 v[152:153], v[142:143], v[128:129] op_sel:[0,1] op_sel_hi:[1,1]
    v_pk_fma_f32 v[82:83], v[82:83], v[128:129], v[152:153] op_sel_hi:[1,0,1] neg_lo:[0,0,1] neg_hi:[0,0,1]
    v_cvt_pk_bf16_f32 v176, v80, v81
    v_cvt_pk_bf16_f32 v177, v82, v83
    v_pk_mul_f32 v[152:153], v[144:145], v[128:129] op_sel:[0,1] op_sel_hi:[1,1]
    v_pk_fma_f32 v[84:85], v[84:85], v[128:129], v[152:153] op_sel_hi:[1,0,1] neg_lo:[0,0,1] neg_hi:[0,0,1]
    v_pk_mul_f32 v[152:153], v[146:147], v[128:129] op_sel:[0,1] op_sel_hi:[1,1]
    v_pk_fma_f32 v[86:87], v[86:87], v[128:129], v[152:153] op_sel_hi:[1,0,1] neg_lo:[0,0,1] neg_hi:[0,0,1]
    v_cvt_pk_bf16_f32 v178, v84, v85
    v_cvt_pk_bf16_f32 v179, v86, v87
    s_nop 0
    v_permlane32_swap_b32 v176, v178
    v_permlane32_swap_b32 v177, v179
    buffer_store_dwordx4 v[176:179], v123, s[16:19], s76 offen sc1
    s_branch L_p1_arrive
L_p1_vmain:
    s_barrier
    ds_read_b128 v[88:91], v16 offset:0
    ds_read_b64_tr_b16 v[104:105], v18 offset:0
    ds_read_b64_tr_b16 v[106:107], v18 offset:1024
    ds_read_b128 v[92:95], v17 offset:0
    ds_read_b64_tr_b16 v[108:109], v19 offset:0
    ds_read_b64_tr_b16 v[110:111], v19 offset:1024
    s_mov_b32 s28, 0
.p2align 3
L_p1_loopv:
    s_and_b32 s31, s28, 3
    s_cmp_eq_u32 s31, 3
    s_mov_b32 s29, 33024
    s_cmov_b32 s29, 4294868224
    s_add_u32 s28, s28, 1
    s_cmp_lt_u32 s28, 10
    s_waitcnt lgkmcnt(0)
    v_mfma_f32_32x32x16_bf16 v[24:39], v[88:91], v[104:107], v[24:39]
    ds_read_b128 v[96:99], v16 offset:32
    ds_read_b64_tr_b16 v[112:113], v18 offset:4096
    ds_read_b64_tr_b16 v[114:115], v18 offset:5120
    v_mfma_f32_32x32x16_bf16 v[40:55], v[92:95], v[104:107], v[40:55]
    ds_read_b128 v[100:103], v17 offset:32
    ds_read_b64_tr_b16 v[116:117], v19 offset:4096
    ds_read_b64_tr_b16 v[118:119], v19 offset:5120
    v_mfma_f32_32x32x16_bf16 v[56:71], v[88:91], v[108:111], v[56:71]
    v_mfma_f32_32x32x16_bf16 v[72:87], v[92:95], v[108:111], v[72:87]
    s_waitcnt lgkmcnt(0)
    v_mfma_f32_32x32x16_bf16 v[24:39], v[96:99], v[112:115], v[24:39]
    ds_read_b128 v[88:91], v16 offset:512
    ds_read_b64_tr_b16 v[104:105], v18 offset:8192
    ds_read_b64_tr_b16 v[106:107], v18 offset:9216
    v_mfma_f32_32x32x16_bf16 v[40:55], v[100:103], v[112:115], v[40:55]
    ds_read_b128 v[92:95], v17 offset:512
    ds_read_b64_tr_b16 v[108:109], v19 offset:8192
    ds_read_b64_tr_b16 v[110:111], v19 offset:9216
    v_mfma_f32_32x32x16_bf16 v[56:71], v[96:99], v[116:119], v[56:71]
    v_mfma_f32_32x32x16_bf16 v[72:87], v[100:103], v[116:119], v[72:87]
    s_waitcnt lgkmcnt(0)
    v_mfma_f32_32x32x16_bf16 v[24:39], v[88:91], v[104:107], v[24:39]
    ds_read_b128 v[96:99], v16 offset:544
    ds_read_b64_tr_b16 v[112:113], v18 offset:12288
    ds_read_b64_tr_b16 v[114:115], v18 offset:13312
    v_mfma_f32_32x32x16_bf16 v[40:55], v[92:95], v[104:107], v[40:55]
    ds_read_b128 v[100:103], v17 offset:544
    ds_read_b64_tr_b16 v[116:117], v19 offset:12288
    ds_read_b64_tr_b16 v[118:119], v19 offset:13312
    v_mfma_f32_32x32x16_bf16 v[56:71], v[88:91], v[108:111], v[56:71]
    v_mfma_f32_32x32x16_bf16 v[72:87], v[92:95], v[108:111], v[72:87]
    s_waitcnt lgkmcnt(0)
    s_barrier
    v_add_u32 v16, s29, v16
    v_add_u32 v17, s29, v17
    v_add_u32 v18, s29, v18
    v_add_u32 v19, s29, v19
    v_mfma_f32_32x32x16_bf16 v[24:39], v[96:99], v[112:115], v[24:39]
    ds_read_b128 v[88:91], v16 offset:0
    ds_read_b64_tr_b16 v[104:105], v18 offset:0
    ds_read_b64_tr_b16 v[106:107], v18 offset:1024
    v_mfma_f32_32x32x16_bf16 v[40:55], v[100:103], v[112:115], v[40:55]
    ds_read_b128 v[92:95], v17 offset:0
    ds_read_b64_tr_b16 v[108:109], v19 offset:0
    ds_read_b64_tr_b16 v[110:111], v19 offset:1024
    v_mfma_f32_32x32x16_bf16 v[56:71], v[96:99], v[116:119], v[56:71]
    v_mfma_f32_32x32x16_bf16 v[72:87], v[100:103], v[116:119], v[72:87]
    s_cbranch_scc1 L_p1_loopv
    s_waitcnt lgkmcnt(0)
    s_barrier
    v_lshlrev_b32 v3, 2, v20
    s_lshl_b32 s32, s82, 7
    s_add_u32 s32, s32, 133120
    v_add_u32 v4, s32, v3
    ds_read_b32 v180, v4
    s_lshl_b32 s32, s83, 7
    s_add_u32 s32, s32, 133120
    v_add_u32 v4, s32, v3
    ds_read_b32 v182, v4
    s_lshl_b32 s32, s68, 7
    s_add_u32 s32, s32, 132096
    v_lshlrev_b32 v4, 4, v21
    v_add_u32 v4, s32, v4
    ds_read_b128 v[132:135], v4 offset:0
    ds_read_b128 v[156:159], v4 offset:512
    ds_read_b128 v[136:139], v4 offset:32
    ds_read_b128 v[160:163], v4 offset:544
    ds_read_b128 v[140:143], v4 offset:64
    ds_read_b128 v[164:167], v4 offset:576
    ds_read_b128 v[144:147], v4 offset:96
    ds_read_b128 v[168:171], v4 offset:608
    s_waitcnt lgkmcnt(0)
    v_pk_mul_f32 v[152:153], v[156:157], v[180:181] op_sel_hi:[1,0]
    v_pk_fma_f32 v[24:25], v[24:25], v[132:133], v[152:153] neg_lo:[0,0,1] neg_hi:[0,0,1]
    v_pk_mul_f32 v[152:153], v[158:159], v[180:181] op_sel_hi:[1,0]
    v_pk_fma_f32 v[26:27], v[26:27], v[134:135], v[152:153] neg_lo:[0,0,1] neg_hi:[0,0,1]
    v_pk_mul_f32 v[152:153], v[160:161], v[180:181] op_sel_hi:[1,0]
    v_pk_fma_f32 v[28:29], v[28:29], v[136:137], v[152:153] neg_lo:[0,0,1] neg_hi:[0,0,1]
    v_pk_mul_f32 v[152:153], v[162:163], v[180:181] op_sel_hi:[1,0]
    v_pk_fma_f32 v[30:31], v[30:31], v[138:139], v[152:153] neg_lo:[0,0,1] neg_hi:[0,0,1]
    v_cvt_pk_bf16_f32 v172, v24, v25
    v_cvt_pk_bf16_f32 v173, v26, v27
    v_cvt_pk_bf16_f32 v174, v28, v29
    v_cvt_pk_bf16_f32 v175, v30, v31
    buffer_store_dwordx4 v[172:175], v120, s[16:19], s75 offen offset:0 sc1
    v_pk_mul_f32 v[152:153], v[164:165], v[180:181] op_sel_hi:[1,0]
    v_pk_fma_f32 v[32:33], v[32:33], v[140:141], v[152:153] neg_lo:[0,0,1] neg_hi:[0,0,1]
    v_pk_mul_f32 v[152:153], v[166:167], v[180:181] op_sel_hi:[1,0]
    v_pk_fma_f32 v[34:35], v[34:35], v[142:143], v[152:153] neg_lo:[0,0,1] neg_hi:[0,0,1]
    v_pk_mul_f32 v[152:153], v[168:169], v[180:181] op_sel_hi:[1,0]
    v_pk_fma_f32 v[36:37], v[36:37], v[144:145], v[152:153] neg_lo:[0,0,1] neg_hi:[0,0,1]
    v_pk_mul_f32 v[152:153], v[170:171], v[180:181] op_sel_hi:[1,0]
    v_pk_fma_f32 v[38:39], v[38:39], v[146:147], v[152:153] neg_lo:[0,0,1] neg_hi:[0,0,1]
    v_cvt_pk_bf16_f32 v176, v32, v33
    v_cvt_pk_bf16_f32 v177, v34, v35
    v_cvt_pk_bf16_f32 v178, v36, v37
    v_cvt_pk_bf16_f32 v179, v38, v39
    buffer_store_dwordx4 v[176:179], v120, s[16:19], s75 offen offset:640 sc1
    v_pk_mul_f32 v[152:153], v[156:157], v[182:183] op_sel_hi:[1,0]
    v_pk_fma_f32 v[56:57], v[56:57], v[132:133], v[152:153] neg_lo:[0,0,1] neg_hi:[0,0,1]
    v_pk_mul_f32 v[152:153], v[158:159], v[182:183] op_sel_hi:[1,0]
    v_pk_fma_f32 v[58:59], v[58:59], v[134:135], v[152:153] neg_lo:[0,0,1] neg_hi:[0,0,1]
    v_pk_mul_f32 v[152:153], v[160:161], v[182:183] op_sel_hi:[1,0]
    v_pk_fma_f32 v[60:61], v[60:61], v[136:137], v[152:153] neg_lo:[0,0,1] neg_hi:[0,0,1]
    v_pk_mul_f32 v[152:153], v[162:163], v[182:183] op_sel_hi:[1,0]
    v_pk_fma_f32 v[62:63], v[62:63], v[138:139], v[152:153] neg_lo:[0,0,1] neg_hi:[0,0,1]
    v_cvt_pk_bf16_f32 v172, v56, v57
    v_cvt_pk_bf16_f32 v173, v58, v59
    v_cvt_pk_bf16_f32 v174, v60, v61
    v_cvt_pk_bf16_f32 v175, v62, v63
    buffer_store_dwordx4 v[172:175], v121, s[16:19], s75 offen offset:0 sc1
    v_pk_mul_f32 v[152:153], v[164:165], v[182:183] op_sel_hi:[1,0]
    v_pk_fma_f32 v[64:65], v[64:65], v[140:141], v[152:153] neg_lo:[0,0,1] neg_hi:[0,0,1]
    v_pk_mul_f32 v[152:153], v[166:167], v[182:183] op_sel_hi:[1,0]
    v_pk_fma_f32 v[66:67], v[66:67], v[142:143], v[152:153] neg_lo:[0,0,1] neg_hi:[0,0,1]
    v_pk_mul_f32 v[152:153], v[168:169], v[182:183] op_sel_hi:[1,0]
    v_pk_fma_f32 v[68:69], v[68:69], v[144:145], v[152:153] neg_lo:[0,0,1] neg_hi:[0,0,1]
    v_pk_mul_f32 v[152:153], v[170:171], v[182:183] op_sel_hi:[1,0]
    v_pk_fma_f32 v[70:71], v[70:71], v[146:147], v[152:153] neg_lo:[0,0,1] neg_hi:[0,0,1]
    v_cvt_pk_bf16_f32 v176, v64, v65
    v_cvt_pk_bf16_f32 v177, v66, v67
    v_cvt_pk_bf16_f32 v178, v68, v69
    v_cvt_pk_bf16_f32 v179, v70, v71
    buffer_store_dwordx4 v[176:179], v121, s[16:19], s75 offen offset:640 sc1
    s_lshl_b32 s32, s69, 7
    s_add_u32 s32, s32, 132096
    v_lshlrev_b32 v4, 4, v21
    v_add_u32 v4, s32, v4
    ds_read_b128 v[132:135], v4 offset:0
    ds_read_b128 v[156:159], v4 offset:512
    ds_read_b128 v[136:139], v4 offset:32
    ds_read_b128 v[160:163], v4 offset:544
    ds_read_b128 v[140:143], v4 offset:64
    ds_read_b128 v[164:167], v4 offset:576
    ds_read_b128 v[144:147], v4 offset:96
    ds_read_b128 v[168:171], v4 offset:608
    s_waitcnt lgkmcnt(0)
    v_pk_mul_f32 v[152:153], v[156:157], v[180:181] op_sel_hi:[1,0]
    v_pk_fma_f32 v[40:41], v[40:41], v[132:133], v[152:153] neg_lo:[0,0,1] neg_hi:[0,0,1]
    v_pk_mul_f32 v[152:153], v[158:159], v[180:181] op_sel_hi:[1,0]
    v_pk_fma_f32 v[42:43], v[42:43], v[134:135], v[152:153] neg_lo:[0,0,1] neg_hi:[0,0,1]
    v_pk_mul_f32 v[152:153], v[160:161], v[180:181] op_sel_hi:[1,0]
    v_pk_fma_f32 v[44:45], v[44:45], v[136:137], v[152:153] neg_lo:[0,0,1] neg_hi:[0,0,1]
    v_pk_mul_f32 v[152:153], v[162:163], v[180:181] op_sel_hi:[1,0]
    v_pk_fma_f32 v[46:47], v[46:47], v[138:139], v[152:153] neg_lo:[0,0,1] neg_hi:[0,0,1]
    v_cvt_pk_bf16_f32 v172, v40, v41
    v_cvt_pk_bf16_f32 v173, v42, v43
    v_cvt_pk_bf16_f32 v174, v44, v45
    v_cvt_pk_bf16_f32 v175, v46, v47
    buffer_store_dwordx4 v[172:175], v120, s[16:19], s76 offen offset:0 sc1
    v_pk_mul_f32 v[152:153], v[164:165], v[180:181] op_sel_hi:[1,0]
    v_pk_fma_f32 v[48:49], v[48:49], v[140:141], v[152:153] neg_lo:[0,0,1] neg_hi:[0,0,1]
    v_pk_mul_f32 v[152:153], v[166:167], v[180:181] op_sel_hi:[1,0]
    v_pk_fma_f32 v[50:51], v[50:51], v[142:143], v[152:153] neg_lo:[0,0,1] neg_hi:[0,0,1]
    v_pk_mul_f32 v[152:153], v[168:169], v[180:181] op_sel_hi:[1,0]
    v_pk_fma_f32 v[52:53], v[52:53], v[144:145], v[152:153] neg_lo:[0,0,1] neg_hi:[0,0,1]
    v_pk_mul_f32 v[152:153], v[170:171], v[180:181] op_sel_hi:[1,0]
    v_pk_fma_f32 v[54:55], v[54:55], v[146:147], v[152:153] neg_lo:[0,0,1] neg_hi:[0,0,1]
    v_cvt_pk_bf16_f32 v176, v48, v49
    v_cvt_pk_bf16_f32 v177, v50, v51
    v_cvt_pk_bf16_f32 v178, v52, v53
    v_cvt_pk_bf16_f32 v179, v54, v55
    buffer_store_dwordx4 v[176:179], v120, s[16:19], s76 offen offset:640 sc1
    v_pk_mul_f32 v[152:153], v[156:157], v[182:183] op_sel_hi:[1,0]
    v_pk_fma_f32 v[72:73], v[72:73], v[132:133], v[152:153] neg_lo:[0,0,1] neg_hi:[0,0,1]
    v_pk_mul_f32 v[152:153], v[158:159], v[182:183] op_sel_hi:[1,0]
    v_pk_fma_f32 v[74:75], v[74:75], v[134:135], v[152:153] neg_lo:[0,0,1] neg_hi:[0,0,1]
    v_pk_mul_f32 v[152:153], v[160:161], v[182:183] op_sel_hi:[1,0]
    v_pk_fma_f32 v[76:77], v[76:77], v[136:137], v[152:153] neg_lo:[0,0,1] neg_hi:[0,0,1]
    v_pk_mul_f32 v[152:153], v[162:163], v[182:183] op_sel_hi:[1,0]
    v_pk_fma_f32 v[78:79], v[78:79], v[138:139], v[152:153] neg_lo:[0,0,1] neg_hi:[0,0,1]
    v_cvt_pk_bf16_f32 v172, v72, v73
    v_cvt_pk_bf16_f32 v173, v74, v75
    v_cvt_pk_bf16_f32 v174, v76, v77
    v_cvt_pk_bf16_f32 v175, v78, v79
    buffer_store_dwordx4 v[172:175], v121, s[16:19], s76 offen offset:0 sc1
    v_pk_mul_f32 v[152:153], v[164:165], v[182:183] op_sel_hi:[1,0]
    v_pk_fma_f32 v[80:81], v[80:81], v[140:141], v[152:153] neg_lo:[0,0,1] neg_hi:[0,0,1]
    v_pk_mul_f32 v[152:153], v[166:167], v[182:183] op_sel_hi:[1,0]
    v_pk_fma_f32 v[82:83], v[82:83], v[142:143], v[152:153] neg_lo:[0,0,1] neg_hi:[0,0,1]
    v_pk_mul_f32 v[152:153], v[168:169], v[182:183] op_sel_hi:[1,0]
    v_pk_fma_f32 v[84:85], v[84:85], v[144:145], v[152:153] neg_lo:[0,0,1] neg_hi:[0,0,1]
    v_pk_mul_f32 v[152:153], v[170:171], v[182:183] op_sel_hi:[1,0]
    v_pk_fma_f32 v[86:87], v[86:87], v[146:147], v[152:153] neg_lo:[0,0,1] neg_hi:[0,0,1]
    v_cvt_pk_bf16_f32 v176, v80, v81
    v_cvt_pk_bf16_f32 v177, v82, v83
    v_cvt_pk_bf16_f32 v178, v84, v85
    v_cvt_pk_bf16_f32 v179, v86, v87
    buffer_store_dwordx4 v[176:179], v121, s[16:19], s76 offen offset:640 sc1
L_p1_arrive:
    s_waitcnt vmcnt(0)
    v_mov_b32 v3, 163648
    v_mov_b32 v4, 1
    s_mov_b64 exec, 1
    ds_add_rtn_u32 v4, v3, v4
    s_waitcnt lgkmcnt(0)
    v_readfirstlane_b32 s31, v4
    s_mov_b64 exec, -1
    s_nop 2
    s_cmp_eq_u32 s31, 3
    s_cbranch_scc0 L_p1_wait
    s_lshl_b32 s31, s24, 11
    s_add_u32 s31, s31, 24408064
    v_lshlrev_b32 v3, 7, v1
    v_mov_b32 v4, 1
    s_mov_b64 exec, 255
    buffer_atomic_add v4, v3, s[16:19], s31 offen sc1
    s_mov_b64 exec, -1
L_p1_wait:
    s_and_b32 s4, s2, 7
    s_lshl_b32 s4, s4, 1
    s_lshr_b32 s6, s2, 7
    s_add_u32 s24, s4, s6
    s_lshr_b32 s5, s2, 3
    s_and_b32 s4, s5, 15
    s_lshl_b32 s4, s4, 1
    s_add_u32 s23, s4, s22
    s_mov_b32 s25, s21
    s_mov_b32 s36, 0x000fffff
    s_mov_b32 s37, 0x000fffff
    s_mov_b32 s38, -1
    s_mov_b32 s39, 0
    v_and_b32 v8, 31, v1
    v_lshrrev_b32 v9, 5, v1
    v_lshlrev_b32 v13, 4, v8
    s_mul_i32 s29, s22, 1536
    v_add_u32 v10, s29, v2
    s_lshl_b32 s29, s22, 3
    s_add_u32 s29, s29, 1024
    v_add_u32 v11, s29, v13
    s_mul_i32 s29, s22, 1280
    s_add_u32 s29, s29, 2560
    v_mul_u32_u24 v12, 320, v9
    v_add_u32 v12, v12, v13
    v_add_u32 v12, s29, v12
    s_lshr_b32 s31, s23, 1
    s_mul_i32 s84, s31, 163840
    s_mul_i32 s30, s24, 10240
    s_add_u32 s84, s84, s30
    s_add_u32 s84, s84, 0
    s_mul_i32 s33, s31, 327680
    s_mul_i32 s30, s25, 81920
    s_add_u32 s33, s33, s30
    s_add_u32 s33, s33, 2621440
    v_cmp_eq_u32 vcc, 20, v8
    v_mov_b32 v3, 0x3f803f80
    v_mov_b32 v152, 0x3f803f80
    v_mov_b32 v153, 0
    v_cndmask_b32 v156, 0, v3, vcc
    v_cndmask_b32 v164, 0, v3, vcc
    v_cndmask_b32 v157, 0, v3, vcc
    v_cndmask_b32 v165, 0, v3, vcc
    v_cndmask_b32 v158, 0, v3, vcc
    v_cndmask_b32 v166, 0, v3, vcc
    v_cndmask_b32 v159, 0, v3, vcc
    v_cndmask_b32 v167, 0, v3, vcc
    v_mov_b32 v154, 0x3f803f80
    v_mov_b32 v155, 0
    v_cndmask_b32 v160, 0, v3, vcc
    v_cndmask_b32 v168, 0, v3, vcc
    v_cndmask_b32 v161, 0, v3, vcc
    v_cndmask_b32 v169, 0, v3, vcc
    v_cndmask_b32 v162, 0, v3, vcc
    v_cndmask_b32 v170, 0, v3, vcc
    v_cndmask_b32 v163, 0, v3, vcc
    v_cndmask_b32 v171, 0, v3, vcc
    v_mov_b32 v172, 0
    v_mov_b32 v173, 0
    v_mov_b32 v174, 0
    v_mov_b32 v175, 0
    s_mov_b32 s32, 0
    s_mov_b32 s89, 0x7ff00000
    s_mov_b32 s87, 24438784
    s_mul_i32 s29, s20, 9216
    s_add_u32 s29, s29, 88064
    v_add_u32 v195, s29, v2
    s_add_u32 s29, s25, 1
    s_and_b32 s29, s29, 3
    s_and_b32 s30, s20, 4
    s_add_u32 s30, s30, s29
    s_mul_i32 s30, s30, 9216
    s_add_u32 s30, s30, 94208
    v_add_u32 v196, s30, v2
    s_add_u32 s29, s25, 2
    s_and_b32 s29, s29, 3
    s_and_b32 s30, s20, 4
    s_add_u32 s30, s30, s29
    s_mul_i32 s30, s30, 9216
    s_add_u32 s30, s30, 91136
    v_add_u32 v197, s30, v2
    s_add_u32 s29, s25, 3
    s_and_b32 s29, s29, 3
    s_and_b32 s30, s20, 4
    s_add_u32 s30, s30, s29
    s_mul_i32 s30, s30, 9216
    s_add_u32 s30, s30, 88064
    v_add_u32 v198, s30, v2
    s_lshl_b32 s29, s24, 2
    s_add_u32 s29, s29, s25
    s_mul_i32 s29, s29, 40960
    s_add_u32 s29, s29, 7929856
    s_lshr_b32 s30, s23, 2
    s_mul_i32 s30, s30, 5120
    s_add_u32 s29, s29, s30
    s_and_b32 s30, s23, 3
    s_lshl_b32 s31, s30, 10
    s_add_u32 s80, s31, s29
    s_lshr_b32 s31, s30, 1
    s_lshl_b32 s31, s31, 9
    s_and_b32 s30, s30, 1
    s_lshl_b32 s30, s30, 3
    s_add_u32 s31, s31, s30
    s_add_u32 s31, s31, s29
    s_add_u32 s81, s31, 4096
    s_and_b32 s4, s2, 7
    s_lshl_b32 s4, s4, 1
    s_lshr_b32 s5, s2, 7
    s_add_u32 s91, s4, s5
    s_lshr_b32 s5, s2, 3
    s_and_b32 s92, s5, 15
    s_lshl_b32 s82, s91, 7
    s_add_u32 s82, s82, 24446976
L_p2_pass:
    v_mfma_f32_32x32x16_bf16 v[40:55], v[172:175], v[172:175], 0
    v_mfma_f32_32x32x16_bf16 v[56:71], v[172:175], v[172:175], 0
    v_mfma_f32_32x32x16_bf16 v[72:87], v[172:175], v[172:175], 0
    v_mfma_f32_32x32x16_bf16 v[88:103], v[172:175], v[172:175], 0
    v_mov_b32 v136, 0
    v_mov_b32 v137, 0
    v_mov_b32 v138, 0
    v_mov_b32 v139, 0
    v_mov_b32 v140, 0
    v_mov_b32 v141, 0
    v_mov_b32 v142, 0
    v_mov_b32 v143, 0
    s_mov_b64 exec, s[36:37]
    v_mov_b32 v168, 0
    v_mov_b32 v169, 0
    v_mov_b32 v170, 0
    v_mov_b32 v171, 0
    s_mov_b64 exec, -1
    v_mov_b32 v134, 0
    v_mov_b32 v135, 0
    s_cmp_ge_u32 s20, 4
    s_cbranch_scc1 L_p2_pB
    s_setprio 1
    s_branch L_p2_pD
L_p2_pB:
    s_setprio 2
L_p2_pD:
    s_mul_i32 s34, s22, 7
    s_cmp_lg_u32 s32, 0
    s_cbranch_scc1 L_p2_loads
    s_cmp_lg_u32 s20, 4
    s_cbranch_scc1 L_p1_wait2
    v_mov_b32 v3, 163648
    s_mov_b32 s30, 0
L_spin_own:
    ds_read_b32 v4, v3
    s_add_u32 s30, s30, 1
    s_waitcnt lgkmcnt(0)
    v_readfirstlane_b32 s29, v4
    s_cmp_gt_u32 s30, 1600000
    s_cbranch_scc1 L_spinx_own
    s_nop 1
    s_cmp_ge_u32 s29, 4
    s_cbranch_scc0 L_spin_own
L_spinx_own:
    s_getreg_b32 s4, hwreg(HW_REG_XCC_ID, 0, 4)
    s_mul_i32 s5, s4, s4
    s_lshl_b32 s4, s4, 10
    s_or_b32 s4, s4, s5
    s_or_b32 s4, s4, 0x20000
    s_and_b32 s5, s2, 7
    s_lshl_b32 s5, s5, 1
    s_lshr_b32 s6, s2, 7
    s_add_u32 s5, s5, s6
    s_lshl_b32 s5, s5, 7
    s_add_u32 s5, s5, 24446976
    v_mov_b32 v3, 0
    v_mov_b32 v4, s4
    s_mov_b64 exec, 1
    buffer_atomic_add v4, v3, s[16:19], s5 offen sc1
    s_mov_b64 exec, -1
    s_lshr_b32 s5, s2, 3
    s_and_b32 s4, s5, 15
    s_mul_i32 s4, s4, 40
    v_and_b32 v3, 1, v1
    v_mul_u32_u24 v3, 39, v3
    v_add_u32 v3, s4, v3
    v_lshrrev_b32 v3, 7, v3
    v_lshrrev_b32 v4, 1, v1
    v_mul_u32_u24 v4, 5, v4
    v_add_u32 v3, v3, v4
    v_lshlrev_b32 v3, 11, v3
    s_and_b32 s30, s2, 7
    s_lshl_b32 s30, s30, 7
    s_add_u32 s30, s30, 24408064
    s_mov_b32 s31, 0
    s_mov_b64 exec, 0x3f
L_poll_s0:
    buffer_load_dword v4, v3, s[16:19], s30 offen sc1
    s_add_u32 s31, s31, 1
    s_waitcnt vmcnt(0)
    v_cmp_gt_u32 vcc, 16, v4
    s_cmp_gt_u32 s31, 40000
    s_cbranch_scc1 L_pollx_s0
    s_nop 1
    s_cbranch_vccz L_pollx_s0
    s_sleep 1
    s_branch L_poll_s0
L_pollx_s0:
    s_mov_b64 exec, -1
    v_mov_b32 v3, 163656
    v_mov_b32 v4, 1
    ds_write_b32 v3, v4
    s_branch L_p1_go
L_p1_wait2:
    v_mov_b32 v3, 163656
    s_mov_b32 s30, 0
L_p1_gowait:
    ds_read_b32 v4, v3
    s_add_u32 s30, s30, 1
    s_waitcnt lgkmcnt(0)
    v_readfirstlane_b32 s29, v4
    s_cmp_gt_u32 s30, 1600000
    s_cbranch_scc1 L_p1_go
    s_nop 1
    s_cmp_eq_u32 s29, 0
    s_cbranch_scc0 L_p1_go
    s_sleep 1
    s_branch L_p1_gowait
L_p1_go:
    s_add_u32 s30, s84, 0
    buffer_load_dwordx4 v[16:19], v10, s[16:19], s30 offen sc1
    buffer_load_dwordx2 v[32:33], v11, s[16:19], s30 offen sc1
    s_add_u32 s30, s84, 2560
    buffer_load_dwordx4 v[20:23], v10, s[16:19], s30 offen sc1
    buffer_load_dwordx2 v[34:35], v11, s[16:19], s30 offen sc1
    s_add_u32 s30, s84, 5120
    buffer_load_dwordx4 v[24:27], v10, s[16:19], s30 offen sc1
    buffer_load_dwordx2 v[36:37], v11, s[16:19], s30 offen sc1
    s_add_u32 s30, s84, 7680
    buffer_load_dwordx4 v[28:31], v10, s[16:19], s30 offen sc1
    buffer_load_dwordx2 v[38:39], v11, s[16:19], s30 offen sc1
L_p2_loads:
    s_mov_b32 s26, s33
    s_add_u32 s27, s33, 5120
    buffer_load_dwordx4 v[144:147], v10, s[16:19], s26 offen sc1
    s_mov_b64 exec, s[38:39]
    buffer_load_dwordx2 v[152:153], v11, s[16:19], s26 offen sc1
    s_mov_b64 exec, -1
    s_mov_b64 exec, s[36:37]
    buffer_load_dwordx4 v[156:159], v12, s[16:19], s26 offen sc1
    buffer_load_dwordx4 v[164:167], v12, s[16:19], s26 offen offset:640 sc1
    s_mov_b64 exec, -1
    buffer_load_dwordx4 v[148:151], v10, s[16:19], s27 offen sc1
    s_mov_b64 exec, s[38:39]
    buffer_load_dwordx2 v[154:155], v11, s[16:19], s27 offen sc1
    s_mov_b64 exec, -1
    s_waitcnt vmcnt(2)
    s_cmp_lg_u32 s32, 0
    s_cbranch_scc1 L_p2_qok
    v_cmp_gt_u32 vcc, 32, v1
    s_nop 1
    v_cndmask_b32 v32, 0, v32, vcc
    v_cndmask_b32 v33, 0, v33, vcc
    v_cndmask_b32 v34, 0, v34, vcc
    v_cndmask_b32 v35, 0, v35, vcc
    v_cndmask_b32 v36, 0, v36, vcc
    v_cndmask_b32 v37, 0, v37, vcc
    v_cndmask_b32 v38, 0, v38, vcc
    v_cndmask_b32 v39, 0, v39, vcc
L_p2_qok:
    v_mfma_f32_32x32x16_bf16 v[104:119], v[144:147], v[16:19], 0
    v_mfma_f32_32x32x8bf16_1k v[104:119], v[152:153], v[32:33], v[104:119]
    s_mov_b32 s28, 0
    s_lshr_b32 s29, s2, 3
    s_lshl_b32 s29, s29, 3
    s_add_u32 s29, s29, s20
    s_mul_i32 s29, s29, 4096
    s_add_u32 s97, s29, 19464192
    v_lshlrev_b32 v194, 7, v1
    v_mov_b32 v193, 0
    v_mov_b32 v192, 0
    s_nop 7
.p2align 3
L_p2_loop:
    s_cmp_eq_u32 s70, 0
    s_cbranch_scc0 L_p2_rt
L_p2_rtback:
    v_exp_f32 v104, v104
    v_exp_f32 v105, v105
    v_cvt_pk_bf16_f32 v143, v134, v135
    v_mfma_f32_32x32x16_bf16 v[120:135], v[144:147], v[20:23], 0
    v_exp_f32 v106, v106
    v_exp_f32 v107, v107
    v_cvt_pk_bf16_f32 v136, v104, v105
    v_exp_f32 v108, v108
    v_exp_f32 v109, v109
    v_cvt_pk_bf16_f32 v137, v106, v107
    v_mfma_f32_32x32x8bf16_1k v[120:135], v[152:153], v[34:35], v[120:135]
    v_exp_f32 v110, v110
    v_exp_f32 v111, v111
    v_cvt_pk_bf16_f32 v138, v108, v109
    v_exp_f32 v112, v112
    v_exp_f32 v113, v113
    v_cvt_pk_bf16_f32 v139, v110, v111
    v_mfma_f32_32x32x16_bf16 v[88:103], v[168:171], v[140:143], v[88:103]
    s_mov_b64 exec, s[36:37]
    buffer_load_dwordx4 v[160:163], v12, s[16:19], s27 offen sc1
    buffer_load_dwordx4 v[168:171], v12, s[16:19], s27 offen offset:640 sc1
    s_mov_b64 exec, -1
    v_exp_f32 v114, v114
    v_exp_f32 v115, v115
    v_cvt_pk_bf16_f32 v140, v112, v113
    v_exp_f32 v116, v116
    v_exp_f32 v117, v117
    v_cvt_pk_bf16_f32 v141, v114, v115
    s_waitcnt vmcnt(4)
    v_mfma_f32_32x32x16_bf16 v[40:55], v[156:159], v[136:139], v[40:55]
    v_exp_f32 v118, v118
    v_exp_f32 v119, v119
    v_cvt_pk_bf16_f32 v142, v116, v117
    v_exp_f32 v120, v120
    v_exp_f32 v121, v121
    v_cvt_pk_bf16_f32 v143, v118, v119
    v_mfma_f32_32x32x16_bf16 v[104:119], v[144:147], v[24:27], 0
    v_exp_f32 v122, v122
    v_exp_f32 v123, v123
    v_cvt_pk_bf16_f32 v136, v120, v121
    v_exp_f32 v124, v124
    v_exp_f32 v125, v125
    v_cvt_pk_bf16_f32 v137, v122, v123
    v_mfma_f32_32x32x8bf16_1k v[104:119], v[152:153], v[36:37], v[104:119]
    v_exp_f32 v126, v126
    v_exp_f32 v127, v127
    v_cvt_pk_bf16_f32 v138, v124, v125
    v_exp_f32 v128, v128
    v_exp_f32 v129, v129
    v_cvt_pk_bf16_f32 v139, v126, v127
    v_mfma_f32_32x32x16_bf16 v[40:55], v[164:167], v[140:143], v[40:55]
    v_exp_f32 v130, v130
    v_exp_f32 v131, v131
    v_cvt_pk_bf16_f32 v140, v128, v129
    v_exp_f32 v132, v132
    v_exp_f32 v133, v133
    v_cvt_pk_bf16_f32 v141, v130, v131
    v_mfma_f32_32x32x16_bf16 v[56:71], v[156:159], v[136:139], v[56:71]
    v_exp_f32 v134, v134
    v_exp_f32 v135, v135
    v_cvt_pk_bf16_f32 v142, v132, v133
    v_exp_f32 v104, v104
    v_exp_f32 v105, v105
    v_cvt_pk_bf16_f32 v143, v134, v135
    v_mfma_f32_32x32x16_bf16 v[120:135], v[144:147], v[28:31], 0
    v_exp_f32 v106, v106
    v_exp_f32 v107, v107
    v_cvt_pk_bf16_f32 v136, v104, v105
    v_exp_f32 v108, v108
    v_exp_f32 v109, v109
    v_cvt_pk_bf16_f32 v137, v106, v107
    v_mfma_f32_32x32x8bf16_1k v[120:135], v[152:153], v[38:39], v[120:135]
    v_exp_f32 v110, v110
    v_exp_f32 v111, v111
    v_cvt_pk_bf16_f32 v138, v108, v109
    v_exp_f32 v112, v112
    v_exp_f32 v113, v113
    v_cvt_pk_bf16_f32 v139, v110, v111
    v_mfma_f32_32x32x16_bf16 v[56:71], v[164:167], v[140:143], v[56:71]
    v_exp_f32 v114, v114
    v_exp_f32 v115, v115
    v_cvt_pk_bf16_f32 v140, v112, v113
    v_exp_f32 v116, v116
    v_exp_f32 v117, v117
    v_cvt_pk_bf16_f32 v141, v114, v115
    v_mfma_f32_32x32x16_bf16 v[72:87], v[156:159], v[136:139], v[72:87]
    v_exp_f32 v118, v118
    v_exp_f32 v119, v119
    v_cvt_pk_bf16_f32 v142, v116, v117
    v_exp_f32 v120, v120
    v_exp_f32 v121, v121
    v_cvt_pk_bf16_f32 v143, v118, v119
    s_waitcnt vmcnt(2)
    v_mfma_f32_32x32x16_bf16 v[104:119], v[148:151], v[16:19], 0
    v_exp_f32 v122, v122
    v_exp_f32 v123, v123
    v_cvt_pk_bf16_f32 v136, v120, v121
    v_exp_f32 v124, v124
    v_exp_f32 v125, v125
    v_cvt_pk_bf16_f32 v137, v122, v123
    v_mfma_f32_32x32x8bf16_1k v[104:119], v[154:155], v[32:33], v[104:119]
    s_add_u32 s26, s26, 10240
    buffer_load_dwordx4 v[144:147], v10, s[16:19], s26 offen sc1
    s_mov_b64 exec, s[38:39]
    buffer_load_dwordx2 v[152:153], v11, s[16:19], s26 offen sc1
    s_mov_b64 exec, -1
    v_exp_f32 v126, v126
    v_exp_f32 v127, v127
    v_cvt_pk_bf16_f32 v138, v124, v125
    v_exp_f32 v128, v128
    v_exp_f32 v129, v129
    v_cvt_pk_bf16_f32 v139, v126, v127
    v_mfma_f32_32x32x16_bf16 v[72:87], v[164:167], v[140:143], v[72:87]
    v_exp_f32 v130, v130
    v_exp_f32 v131, v131
    v_cvt_pk_bf16_f32 v140, v128, v129
    v_exp_f32 v132, v132
    v_exp_f32 v133, v133
    v_cvt_pk_bf16_f32 v141, v130, v131
    v_mfma_f32_32x32x16_bf16 v[88:103], v[156:159], v[136:139], v[88:103]
    v_exp_f32 v134, v134
    v_exp_f32 v135, v135
    v_cvt_pk_bf16_f32 v142, v132, v133
    v_exp_f32 v104, v104
    v_exp_f32 v105, v105
    v_cvt_pk_bf16_f32 v143, v134, v135
    v_mfma_f32_32x32x16_bf16 v[120:135], v[148:151], v[20:23], 0
    v_exp_f32 v106, v106
    v_exp_f32 v107, v107
    v_cvt_pk_bf16_f32 v136, v104, v105
    v_exp_f32 v108, v108
    v_exp_f32 v109, v109
    v_cvt_pk_bf16_f32 v137, v106, v107
    v_mfma_f32_32x32x8bf16_1k v[120:135], v[154:155], v[34:35], v[120:135]
    v_exp_f32 v110, v110
    v_exp_f32 v111, v111
    v_cvt_pk_bf16_f32 v138, v108, v109
    v_exp_f32 v112, v112
    v_exp_f32 v113, v113
    v_cvt_pk_bf16_f32 v139, v110, v111
    v_mfma_f32_32x32x16_bf16 v[88:103], v[164:167], v[140:143], v[88:103]
    s_mov_b64 exec, s[36:37]
    buffer_load_dwordx4 v[156:159], v12, s[16:19], s26 offen sc1
    buffer_load_dwordx4 v[164:167], v12, s[16:19], s26 offen offset:640 sc1
    s_mov_b64 exec, -1
    v_exp_f32 v114, v114
    v_exp_f32 v115, v115
    v_cvt_pk_bf16_f32 v140, v112, v113
    v_exp_f32 v116, v116
    v_exp_f32 v117, v117
    v_cvt_pk_bf16_f32 v141, v114, v115
    s_waitcnt vmcnt(4)
    v_mfma_f32_32x32x16_bf16 v[40:55], v[160:163], v[136:139], v[40:55]
    v_exp_f32 v118, v118
    v_exp_f32 v119, v119
    v_cvt_pk_bf16_f32 v142, v116, v117
    v_exp_f32 v120, v120
    v_exp_f32 v121, v121
    v_cvt_pk_bf16_f32 v143, v118, v119
    v_mfma_f32_32x32x16_bf16 v[104:119], v[148:151], v[24:27], 0
    v_exp_f32 v122, v122
    v_exp_f32 v123, v123
    v_cvt_pk_bf16_f32 v136, v120, v121
    v_exp_f32 v124, v124
    v_exp_f32 v125, v125
    v_cvt_pk_bf16_f32 v137, v122, v123
    v_mfma_f32_32x32x8bf16_1k v[104:119], v[154:155], v[36:37], v[104:119]
    v_exp_f32 v126, v126
    v_exp_f32 v127, v127
    v_cvt_pk_bf16_f32 v138, v124, v125
    v_exp_f32 v128, v128
    v_exp_f32 v129, v129
    v_cvt_pk_bf16_f32 v139, v126, v127
    v_mfma_f32_32x32x16_bf16 v[40:55], v[168:171], v[140:143], v[40:55]
    v_exp_f32 v130, v130
    v_exp_f32 v131, v131
    v_cvt_pk_bf16_f32 v140, v128, v129
    v_exp_f32 v132, v132
    v_exp_f32 v133, v133
    v_cvt_pk_bf16_f32 v141, v130, v131
    v_mfma_f32_32x32x16_bf16 v[56:71], v[160:163], v[136:139], v[56:71]
    v_exp_f32 v134, v134
    v_exp_f32 v135, v135
    v_cvt_pk_bf16_f32 v142, v132, v133
    v_exp_f32 v104, v104
    v_exp_f32 v105, v105
    v_cvt_pk_bf16_f32 v143, v134, v135
    v_mfma_f32_32x32x16_bf16 v[120:135], v[148:151], v[28:31], 0
    v_exp_f32 v106, v106
    v_exp_f32 v107, v107
    v_cvt_pk_bf16_f32 v136, v104, v105
    v_exp_f32 v108, v108
    v_exp_f32 v109, v109
    v_cvt_pk_bf16_f32 v137, v106, v107
    v_mfma_f32_32x32x8bf16_1k v[120:135], v[154:155], v[38:39], v[120:135]
    v_exp_f32 v110, v110
    v_exp_f32 v111, v111
    v_cvt_pk_bf16_f32 v138, v108, v109
    v_exp_f32 v112, v112
    v_exp_f32 v113, v113
    v_cvt_pk_bf16_f32 v139, v110, v111
    v_mfma_f32_32x32x16_bf16 v[56:71], v[168:171], v[140:143], v[56:71]
    v_exp_f32 v114, v114
    v_exp_f32 v115, v115
    v_cvt_pk_bf16_f32 v140, v112, v113
    v_exp_f32 v116, v116
    v_exp_f32 v117, v117
    v_cvt_pk_bf16_f32 v141, v114, v115
    v_mfma_f32_32x32x16_bf16 v[72:87], v[160:163], v[136:139], v[72:87]
    v_exp_f32 v118, v118
    v_exp_f32 v119, v119
    v_cvt_pk_bf16_f32 v142, v116, v117
    v_exp_f32 v120, v120
    v_exp_f32 v121, v121
    v_cvt_pk_bf16_f32 v143, v118, v119
    s_waitcnt vmcnt(2)
    v_mfma_f32_32x32x16_bf16 v[104:119], v[144:147], v[16:19], 0
    v_exp_f32 v122, v122
    v_exp_f32 v123, v123
    v_cvt_pk_bf16_f32 v136, v120, v121
    v_exp_f32 v124, v124
    v_exp_f32 v125, v125
    v_cvt_pk_bf16_f32 v137, v122, v123
    v_mfma_f32_32x32x8bf16_1k v[104:119], v[152:153], v[32:33], v[104:119]
    s_add_u32 s27, s27, 10240
    buffer_load_dwordx4 v[148:151], v10, s[16:19], s27 offen sc1
    s_mov_b64 exec, s[38:39]
    buffer_load_dwordx2 v[154:155], v11, s[16:19], s27 offen sc1
    s_mov_b64 exec, -1
    s_add_u32 s28, s28, 1
    s_cmp_lg_u32 s28, s34
    s_cbranch_scc1 L_p2_keep
    s_setprio 0
L_p2_keep:
    s_cmp_lt_u32 s28, 8
    v_exp_f32 v126, v126
    v_exp_f32 v127, v127
    v_cvt_pk_bf16_f32 v138, v124, v125
    v_exp_f32 v128, v128
    v_exp_f32 v129, v129
    v_cvt_pk_bf16_f32 v139, v126, v127
    v_mfma_f32_32x32x16_bf16 v[72:87], v[168:171], v[140:143], v[72:87]
    v_exp_f32 v130, v130
    v_exp_f32 v131, v131
    v_cvt_pk_bf16_f32 v140, v128, v129
    v_exp_f32 v132, v132
    v_exp_f32 v133, v133
    v_cvt_pk_bf16_f32 v141, v130, v131
    v_mfma_f32_32x32x16_bf16 v[88:103], v[160:163], v[136:139], v[88:103]
    v_exp_f32 v134, v134
    v_exp_f32 v135, v135
    v_cvt_pk_bf16_f32 v142, v132, v133
    s_cbranch_scc1 L_p2_loop
    s_branch L_p2_loopend
L_p2_rt:
    s_cmp_lt_u32 s28, s70
    s_cbranch_scc1 L_p2_rtback
    s_cmp_eq_u32 s70, 1
    s_cbranch_scc0 L_p2_rt2
    s_mov_b32 s60, s48
    s_and_b32 s61, s49, 0xffff
    s_mov_b32 s62, 1966080
    s_mov_b32 s63, 0x00020000
    s_mov_b32 s64, s50
    s_and_b32 s65, s51, 0xffff
    s_mov_b32 s66, 1966080
    s_mov_b32 s67, 0x00020000
    s_cmp_ge_u32 s71, 480
    s_cbranch_scc1 L_rti_w2l
    s_mul_i32 s74, s71, 1366
    s_lshr_b32 s74, s74, 16
    s_mul_i32 s75, s74, 48
    s_sub_u32 s75, s71, s75
    v_lshrrev_b32 v3, 2, v1
    v_mul_u32_u24 v3, 3072, v3
    v_and_b32 v4, 3, v1
    v_lshl_add_u32 v3, v4, 4, v3
    s_mul_i32 s76, s74, 196608
    s_lshl_b32 s77, s75, 6
    s_add_u32 s76, s76, s77
    s_add_u32 m0, s72, 0
    s_add_u32 s77, s76, 0
    buffer_load_dwordx4 v3, s[60:63], s77 offen lds
    s_add_u32 m0, s72, 1024
    s_add_u32 s77, s76, 49152
    buffer_load_dwordx4 v3, s[60:63], s77 offen lds
    s_add_u32 m0, s72, 2048
    s_add_u32 s77, s76, 98304
    buffer_load_dwordx4 v3, s[60:63], s77 offen lds
    s_add_u32 m0, s72, 3072
    s_add_u32 s77, s76, 147456
    buffer_load_dwordx4 v3, s[60:63], s77 offen lds
    s_branch L_rti_donel
L_rti_w2l:
    s_sub_u32 s75, s71, 480
    s_mul_i32 s74, s75, 6554
    s_lshr_b32 s74, s74, 16
    s_mul_i32 s76, s74, 10
    s_sub_u32 s75, s75, s76
    v_lshrrev_b32 v4, 3, v1
    v_lshrrev_b32 v5, 2, v4
    v_lshlrev_b32 v5, 3, v5
    v_and_b32 v4, 3, v4
    v_add_u32 v4, v4, v5
    v_mul_u32_u24 v3, 1280, v4
    v_and_b32 v4, 7, v1
    v_lshl_add_u32 v3, v4, 4, v3
    s_mul_i32 s76, s74, 40960
    s_lshl_b32 s77, s75, 7
    s_add_u32 s76, s76, s77
    s_add_u32 m0, s72, 0
    s_add_u32 s77, s76, 0
    buffer_load_dwordx4 v3, s[64:67], s77 offen lds
    s_add_u32 m0, s72, 1024
    s_add_u32 s77, s76, 5120
    buffer_load_dwordx4 v3, s[64:67], s77 offen lds
    s_add_u32 m0, s72, 2048
    s_add_u32 s77, s76, 20480
    buffer_load_dwordx4 v3, s[64:67], s77 offen lds
    s_add_u32 m0, s72, 3072
    s_add_u32 s77, s76, 25600
    buffer_load_dwordx4 v3, s[64:67], s77 offen lds
L_rti_donel:
    s_mov_b32 s70, 2
    s_branch L_p2_rtback
L_p2_rt2:
    s_cmp_eq_u32 s70, 2
    s_cbranch_scc0 L_p2_rt3
    s_cmp_ge_u32 s71, 480
    s_cbranch_scc1 L_rtf_16l
    s_mul_i32 s74, s71, 1366
    s_lshr_b32 s74, s74, 16
    s_mul_i32 s75, s74, 48
    s_sub_u32 s75, s71, s75
    v_lshrrev_b32 v4, 5, v1
    v_lshlrev_b32 v4, 2, v4
    v_and_b32 v5, 15, v1
    v_lshrrev_b32 v5, 2, v5
    v_add_u32 v4, v4, v5
    v_lshlrev_b32 v4, 6, v4
    v_lshrrev_b32 v5, 4, v1
    v_and_b32 v5, 1, v5
    v_lshl_add_u32 v4, v5, 5, v4
    v_and_b32 v5, 3, v1
    v_lshl_add_u32 v4, v5, 3, v4
    v_add_u32 v4, s72, v4
    ds_read_b64_tr_b16 v[176:177], v4 offset:0
    ds_read_b64_tr_b16 v[178:179], v4 offset:512
    ds_read_b64_tr_b16 v[180:181], v4 offset:1024
    ds_read_b64_tr_b16 v[182:183], v4 offset:1536
    ds_read_b64_tr_b16 v[184:185], v4 offset:2048
    ds_read_b64_tr_b16 v[186:187], v4 offset:2560
    ds_read_b64_tr_b16 v[188:189], v4 offset:3072
    ds_read_b64_tr_b16 v[190:191], v4 offset:3584
    s_mul_i32 s76, s75, 86
    s_lshr_b32 s76, s76, 8
    s_mul_i32 s77, s76, 3
    s_sub_u32 s77, s75, s77
    s_mul_i32 s76, s76, 40
    s_lshl_b32 s78, s74, 2
    s_add_u32 s76, s76, s78
    s_mul_i32 s76, s76, 3
    s_add_u32 s76, s76, s77
    s_lshl_b32 s76, s76, 10
    s_add_u32 s76, s76, 20283392
    v_lshlrev_b32 v3, 4, v1
    s_waitcnt lgkmcnt(0)
    s_add_u32 s77, s76, 0
    buffer_store_dwordx4 v[176:179], v3, s[16:19], s77 offen sc1
    s_add_u32 s77, s76, 3072
    buffer_store_dwordx4 v[180:183], v3, s[16:19], s77 offen sc1
    s_add_u32 s77, s76, 6144
    buffer_store_dwordx4 v[184:187], v3, s[16:19], s77 offen sc1
    s_add_u32 s77, s76, 9216
    buffer_store_dwordx4 v[188:191], v3, s[16:19], s77 offen sc1
    v_mov_b32 v4, 0
    v_mov_b32 v5, 0
    v_lshlrev_b32 v6, 16, v176
    v_add_f32 v4, v4, v6
    v_and_b32 v6, 0xffff0000, v176
    v_add_f32 v5, v5, v6
    v_lshlrev_b32 v6, 16, v177
    v_add_f32 v4, v4, v6
    v_and_b32 v6, 0xffff0000, v177
    v_add_f32 v5, v5, v6
    v_lshlrev_b32 v6, 16, v178
    v_add_f32 v4, v4, v6
    v_and_b32 v6, 0xffff0000, v178
    v_add_f32 v5, v5, v6
    v_lshlrev_b32 v6, 16, v179
    v_add_f32 v4, v4, v6
    v_and_b32 v6, 0xffff0000, v179
    v_add_f32 v5, v5, v6
    v_lshlrev_b32 v6, 16, v180
    v_add_f32 v4, v4, v6
    v_and_b32 v6, 0xffff0000, v180
    v_add_f32 v5, v5, v6
    v_lshlrev_b32 v6, 16, v181
    v_add_f32 v4, v4, v6
    v_and_b32 v6, 0xffff0000, v181
    v_add_f32 v5, v5, v6
    v_lshlrev_b32 v6, 16, v182
    v_add_f32 v4, v4, v6
    v_and_b32 v6, 0xffff0000, v182
    v_add_f32 v5, v5, v6
    v_lshlrev_b32 v6, 16, v183
    v_add_f32 v4, v4, v6
    v_and_b32 v6, 0xffff0000, v183
    v_add_f32 v5, v5, v6
    v_lshlrev_b32 v6, 16, v184
    v_add_f32 v4, v4, v6
    v_and_b32 v6, 0xffff0000, v184
    v_add_f32 v5, v5, v6
    v_lshlrev_b32 v6, 16, v185
    v_add_f32 v4, v4, v6
    v_and_b32 v6, 0xffff0000, v185
    v_add_f32 v5, v5, v6
    v_lshlrev_b32 v6, 16, v186
    v_add_f32 v4, v4, v6
    v_and_b32 v6, 0xffff0000, v186
    v_add_f32 v5, v5, v6
    v_lshlrev_b32 v6, 16, v187
    v_add_f32 v4, v4, v6
    v_and_b32 v6, 0xffff0000, v187
    v_add_f32 v5, v5, v6
    v_lshlrev_b32 v6, 16, v188
    v_add_f32 v4, v4, v6
    v_and_b32 v6, 0xffff0000, v188
    v_add_f32 v5, v5, v6
    v_lshlrev_b32 v6, 16, v189
    v_add_f32 v4, v4, v6
    v_and_b32 v6, 0xffff0000, v189
    v_add_f32 v5, v5, v6
    v_lshlrev_b32 v6, 16, v190
    v_add_f32 v4, v4, v6
    v_and_b32 v6, 0xffff0000, v190
    v_add_f32 v5, v5, v6
    v_lshlrev_b32 v6, 16, v191
    v_add_f32 v4, v4, v6
    v_and_b32 v6, 0xffff0000, v191
    v_add_f32 v5, v5, v6
    v_add_f32 v4, v4, v5
    v_mov_b32 v5, v4
    s_nop 1
    v_permlane32_swap_b32 v4, v5
    v_add_f32 v4, v4, v5
    v_and_b32 v5, 31, v1
    v_lshlrev_b32 v5, 2, v5
    s_mul_i32 s76, s74, 6144
    s_lshl_b32 s77, s75, 7
    s_add_u32 s76, s76, s77
    s_add_u32 s76, s76, 24215552
    buffer_store_dword v4, v5, s[16:19], s76 offen sc1
    s_branch L_rtf_donel
L_rtf_16l:
    s_cmp_ge_u32 s71, 960
    s_mov_b32 s75, 480
    s_cmov_b32 s75, 960
    s_mov_b32 s76, 22249472
    s_cmov_b32 s76, 19464192
    s_mov_b32 s78, 245760
    s_cmov_b32 s78, 102400
    s_sub_u32 s75, s71, s75
    s_mul_i32 s74, s75, 6554
    s_lshr_b32 s74, s74, 16
    s_mul_i32 s77, s74, 10
    s_sub_u32 s75, s75, s77
    s_mul_i32 s74, s74, 5120
    s_add_u32 s76, s76, s74
    s_lshl_b32 s77, s75, 2
    v_lshrrev_b32 v4, 4, v1
    v_lshlrev_b32 v4, 3, v4
    v_and_b32 v5, 15, v1
    v_lshrrev_b32 v5, 2, v5
    v_add_u32 v4, v4, v5
    v_lshlrev_b32 v4, 7, v4
    v_and_b32 v5, 3, v1
    v_lshl_add_u32 v4, v5, 3, v4
    v_add_u32 v4, s72, v4
    ds_read_b64_tr_b16 v[176:177], v4 offset:0
    ds_read_b64_tr_b16 v[178:179], v4 offset:512
    ds_read_b64_tr_b16 v[180:181], v4 offset:32
    ds_read_b64_tr_b16 v[182:183], v4 offset:544
    ds_read_b64_tr_b16 v[184:185], v4 offset:64
    ds_read_b64_tr_b16 v[186:187], v4 offset:576
    ds_read_b64_tr_b16 v[188:189], v4 offset:96
    ds_read_b64_tr_b16 v[190:191], v4 offset:608
    v_lshlrev_b32 v3, 4, v1
    s_waitcnt lgkmcnt(0)
    s_add_u32 s79, s77, 0
    s_mul_i32 s74, s79, 52
    s_lshr_b32 s74, s74, 8
    s_mul_i32 s75, s74, 5
    s_sub_u32 s75, s79, s75
    s_mul_i32 s74, s74, s78
    s_lshl_b32 s75, s75, 10
    s_add_u32 s74, s74, s75
    s_add_u32 s74, s74, s76
    buffer_store_dwordx4 v[176:179], v3, s[16:19], s74 offen sc1
    s_add_u32 s79, s77, 1
    s_mul_i32 s74, s79, 52
    s_lshr_b32 s74, s74, 8
    s_mul_i32 s75, s74, 5
    s_sub_u32 s75, s79, s75
    s_mul_i32 s74, s74, s78
    s_lshl_b32 s75, s75, 10
    s_add_u32 s74, s74, s75
    s_add_u32 s74, s74, s76
    buffer_store_dwordx4 v[180:183], v3, s[16:19], s74 offen sc1
    s_add_u32 s79, s77, 2
    s_mul_i32 s74, s79, 52
    s_lshr_b32 s74, s74, 8
    s_mul_i32 s75, s74, 5
    s_sub_u32 s75, s79, s75
    s_mul_i32 s74, s74, s78
    s_lshl_b32 s75, s75, 10
    s_add_u32 s74, s74, s75
    s_add_u32 s74, s74, s76
    buffer_store_dwordx4 v[184:187], v3, s[16:19], s74 offen sc1
    s_add_u32 s79, s77, 3
    s_mul_i32 s74, s79, 52
    s_lshr_b32 s74, s74, 8
    s_mul_i32 s75, s74, 5
    s_sub_u32 s75, s79, s75
    s_mul_i32 s74, s74, s78
    s_lshl_b32 s75, s75, 10
    s_add_u32 s74, s74, s75
    s_add_u32 s74, s74, s76
    buffer_store_dwordx4 v[188:191], v3, s[16:19], s74 offen sc1
L_rtf_donel:
    s_mov_b32 s70, 3
    s_branch L_p2_rtback
L_p2_rt3:
    s_cmp_eq_u32 s70, 3
    s_cbranch_scc0 L_p2_rt4
    s_mov_b32 s70, 4
    s_and_b32 s4, s2, 7
    s_lshr_b32 s5, s2, 3
    s_and_b32 s94, s5, 7
    s_lshr_b32 s6, s5, 3
    s_lshl_b32 s4, s4, 2
    s_add_u32 s93, s4, s6
    s_and_b32 s95, s21, 1
    v_mov_b32 v4, 0x7ff00000
    s_lshl_b32 s4, s93, 1
    s_add_u32 s4, s4, s95
    s_mul_i32 s4, s4, 40960
    s_mul_i32 s5, s94, 5120
    s_add_u32 s4, s4, s5
    s_add_u32 s4, s4, 10551296
    s_mul_i32 s5, s94, 16384
    s_lshl_b32 s6, s93, 9
    s_add_u32 s5, s5, s6
    s_add_u32 s5, s5, 24276992
    s_cmp_lt_u32 s21, 2
    s_cselect_b32 s4, s4, s5
    s_cselect_b32 s5, 40, 4
    v_lshlrev_b32 v3, 7, v1
    v_cmp_gt_u32 vcc, s5, v1
    s_nop 1
    v_cndmask_b32 v3, v4, v3, vcc
    buffer_load_dword v200, v3, s[16:19], s4 offen sc1
    s_sub_u32 s5, s80, 1024
    v_lshlrev_b32 v3, 7, v1
    v_subrev_u32 v5, 16, v1
    v_lshlrev_b32 v5, 7, v5
    s_and_b32 s4, s81, 0xfffffe00
    s_sub_u32 s4, s4, s5
    v_add_u32 v5, s4, v5
    v_cmp_gt_u32 vcc, 16, v1
    s_nop 1
    v_cndmask_b32 v3, v5, v3, vcc
    v_cmp_gt_u32 vcc, 20, v1
    s_nop 1
    v_cndmask_b32 v3, v4, v3, vcc
    buffer_load_dword v202, v3, s[16:19], s5 offen sc1
    s_cmp_eq_u32 s85, 0
    s_cbranch_scc1 L_p2_rtback
    v_mov_b32 v3, 163652
    v_mov_b32 v4, 1
    s_mov_b64 exec, 1
    ds_add_rtn_u32 v4, v3, v4
    s_waitcnt lgkmcnt(0)
    v_readfirstlane_b32 s29, v4
    s_mov_b64 exec, -1
    s_nop 2
    s_cmp_eq_u32 s29, 3
    s_cbranch_scc0 L_p2_rtback
    s_mov_b32 s29, 24438784
    v_mov_b32 v3, 0
    v_mov_b32 v4, 1
    s_mov_b64 exec, 1
    buffer_atomic_add v4, v3, s[16:19], s29 offen sc1
    s_mov_b64 exec, -1
    s_branch L_p2_rtback
L_p2_rt4:
    s_cmp_eq_u32 s70, 4
    s_cbranch_scc0 L_p2_rt5
    s_mov_b32 s4, 24438912
    buffer_load_dword v193, v172, s[16:19], s4 offen sc1
    s_and_b32 s4, s2, 7
    s_lshr_b32 s5, s2, 3
    s_and_b32 s94, s5, 7
    s_lshr_b32 s6, s5, 3
    s_lshl_b32 s4, s4, 2
    s_add_u32 s93, s4, s6
    s_and_b32 s95, s21, 1
    v_mov_b32 v4, 0x7ff00000
    s_lshr_b32 s5, s2, 3
    s_and_b32 s5, s5, 15
    s_mul_i32 s5, s5, 6144
    s_lshl_b32 s4, s91, 2
    s_add_u32 s4, s4, s21
    s_mul_i32 s4, s4, 98304
    s_add_u32 s4, s4, s5
    s_add_u32 s4, s4, 13172736
    v_lshlrev_b32 v3, 7, v1
    v_cmp_gt_u32 vcc, 48, v1
    s_nop 1
    v_cndmask_b32 v3, v4, v3, vcc
    buffer_load_dword v201, v3, s[16:19], s4 offen sc1
    s_mov_b32 s70, 5
    s_branch L_p2_rtback
L_p2_rt5:
    v_readfirstlane_b32 s4, v193
    s_nop 3
    s_cmp_ge_u32 s4, 16
    s_cbranch_scc1 L_p2_rt6
    s_mov_b32 s70, 0
    s_branch L_p2_rtback
L_p2_rt6:
    s_sub_u32 s4, s70, 5
    s_mul_i32 s4, s4, 44
    s_mul_i32 s5, s21, 11
    s_add_u32 s4, s4, s5
    s_min_u32 s4, s4, 74
    s_lshl_b32 s4, s4, 10
    s_lshr_b32 s5, s2, 3
    s_and_b32 s5, s5, 7
    s_mul_i32 s5, s5, 102400
    s_add_u32 s5, s5, s4
    s_add_u32 s5, s5, 19464192
    s_add_u32 m0, s4, 0
    s_add_u32 s6, s5, 0
    buffer_load_dwordx4 v2, s[16:19], s6 offen offset:0 sc1 lds
    buffer_load_dwordx4 v2, s[16:19], s6 offen offset:1024 sc1 lds
    buffer_load_dwordx4 v2, s[16:19], s6 offen offset:2048 sc1 lds
    buffer_load_dwordx4 v2, s[16:19], s6 offen offset:3072 sc1 lds
    s_add_u32 m0, s4, 4096
    s_add_u32 s6, s5, 4096
    buffer_load_dwordx4 v2, s[16:19], s6 offen offset:0 sc1 lds
    buffer_load_dwordx4 v2, s[16:19], s6 offen offset:1024 sc1 lds
    buffer_load_dwordx4 v2, s[16:19], s6 offen offset:2048 sc1 lds
    buffer_load_dwordx4 v2, s[16:19], s6 offen offset:3072 sc1 lds
    s_add_u32 m0, s4, 8192
    s_add_u32 s6, s5, 8192
    buffer_load_dwordx4 v2, s[16:19], s6 offen offset:0 sc1 lds
    buffer_load_dwordx4 v2, s[16:19], s6 offen offset:1024 sc1 lds
    buffer_load_dwordx4 v2, s[16:19], s6 offen offset:2048 sc1 lds
    s_add_u32 s70, s70, 1
    s_cmp_eq_u32 s70, 7
    s_cselect_b32 s83, 1, 0
    s_cselect_b32 s70, 0, s70
    s_branch L_p2_rtback
L_p2_loopend:
    v_cvt_pk_bf16_f32 v143, v134, v135
    s_nop 1
    v_mfma_f32_32x32x16_bf16 v[88:103], v[168:171], v[140:143], v[88:103]
    s_setprio 0
    buffer_load_dword v203, v172, s[16:19], s87 offen sc1
    buffer_load_dword v204, v172, s[16:19], s82 offen sc1
    s_nop 7
    s_nop 1
    s_cmp_eq_u32 s25, 0
    s_cbranch_scc0 L_p2_q1
    ds_write_b128 v195, v[56:59] offset:0
    ds_write_b128 v195, v[60:63] offset:1024
    ds_write_b128 v195, v[64:67] offset:2048
    ds_write_b128 v195, v[72:75] offset:3072
    ds_write_b128 v195, v[76:79] offset:4096
    ds_write_b128 v195, v[80:83] offset:5120
    ds_write_b128 v195, v[88:91] offset:6144
    ds_write_b128 v195, v[92:95] offset:7168
    ds_write_b128 v195, v[96:99] offset:8192
    s_waitcnt lgkmcnt(0)
    s_branch L_p2_qd
L_p2_q1:
    s_cmp_eq_u32 s25, 1
    s_cbranch_scc0 L_p2_q2
    ds_write_b128 v195, v[72:75] offset:0
    ds_write_b128 v195, v[76:79] offset:1024
    ds_write_b128 v195, v[80:83] offset:2048
    ds_write_b128 v195, v[88:91] offset:3072
    ds_write_b128 v195, v[92:95] offset:4096
    ds_write_b128 v195, v[96:99] offset:5120
    ds_write_b128 v195, v[40:43] offset:6144
    ds_write_b128 v195, v[44:47] offset:7168
    ds_write_b128 v195, v[48:51] offset:8192
    s_waitcnt lgkmcnt(0)
    v_mov_b32 v40, v56
    v_mov_b32 v41, v57
    v_mov_b32 v42, v58
    v_mov_b32 v43, v59
    v_mov_b32 v44, v60
    v_mov_b32 v45, v61
    v_mov_b32 v46, v62
    v_mov_b32 v47, v63
    v_mov_b32 v48, v64
    v_mov_b32 v49, v65
    v_mov_b32 v50, v66
    v_mov_b32 v51, v67
    s_branch L_p2_qd
L_p2_q2:
    s_cmp_eq_u32 s25, 2
    s_cbranch_scc0 L_p2_q3
    ds_write_b128 v195, v[88:91] offset:0
    ds_write_b128 v195, v[92:95] offset:1024
    ds_write_b128 v195, v[96:99] offset:2048
    ds_write_b128 v195, v[40:43] offset:3072
    ds_write_b128 v195, v[44:47] offset:4096
    ds_write_b128 v195, v[48:51] offset:5120
    ds_write_b128 v195, v[56:59] offset:6144
    ds_write_b128 v195, v[60:63] offset:7168
    ds_write_b128 v195, v[64:67] offset:8192
    s_waitcnt lgkmcnt(0)
    v_mov_b32 v40, v72
    v_mov_b32 v41, v73
    v_mov_b32 v42, v74
    v_mov_b32 v43, v75
    v_mov_b32 v44, v76
    v_mov_b32 v45, v77
    v_mov_b32 v46, v78
    v_mov_b32 v47, v79
    v_mov_b32 v48, v80
    v_mov_b32 v49, v81
    v_mov_b32 v50, v82
    v_mov_b32 v51, v83
    s_branch L_p2_qd
L_p2_q3:
    ds_write_b128 v195, v[40:43] offset:0
    ds_write_b128 v195, v[44:47] offset:1024
    ds_write_b128 v195, v[48:51] offset:2048
    ds_write_b128 v195, v[56:59] offset:3072
    ds_write_b128 v195, v[60:63] offset:4096
    ds_write_b128 v195, v[64:67] offset:5120
    ds_write_b128 v195, v[72:75] offset:6144
    ds_write_b128 v195, v[76:79] offset:7168
    ds_write_b128 v195, v[80:83] offset:8192
    s_waitcnt lgkmcnt(0)
    v_mov_b32 v40, v88
    v_mov_b32 v41, v89
    v_mov_b32 v42, v90
    v_mov_b32 v43, v91
    v_mov_b32 v44, v92
    v_mov_b32 v45, v93
    v_mov_b32 v46, v94
    v_mov_b32 v47, v95
    v_mov_b32 v48, v96
    v_mov_b32 v49, v97
    v_mov_b32 v50, v98
    v_mov_b32 v51, v99
L_p2_qd:
    s_barrier
    ds_read_b128 v[176:179], v196 offset:0
    ds_read_b128 v[180:183], v196 offset:1024
    ds_read_b128 v[184:187], v196 offset:2048
    ds_read_b128 v[208:211], v197 offset:0
    ds_read_b128 v[212:215], v197 offset:1024
    ds_read_b128 v[216:219], v197 offset:2048
    ds_read_b128 v[220:223], v198 offset:0
    ds_read_b128 v[224:227], v198 offset:1024
    ds_read_b128 v[228:231], v198 offset:2048
    s_waitcnt lgkmcnt(3)
    v_add_f32 v176, v176, v208
    v_add_f32 v177, v177, v209
    v_add_f32 v178, v178, v210
    v_add_f32 v179, v179, v211
    v_add_f32 v180, v180, v212
    v_add_f32 v181, v181, v213
    v_add_f32 v182, v182, v214
    v_add_f32 v183, v183, v215
    v_add_f32 v184, v184, v216
    v_add_f32 v185, v185, v217
    v_add_f32 v186, v186, v218
    v_add_f32 v187, v187, v219
    s_waitcnt lgkmcnt(0)
    v_add_f32 v40, v40, v220
    v_add_f32 v41, v41, v221
    v_add_f32 v42, v42, v222
    v_add_f32 v43, v43, v223
    v_add_f32 v44, v44, v224
    v_add_f32 v45, v45, v225
    v_add_f32 v46, v46, v226
    v_add_f32 v47, v47, v227
    v_add_f32 v48, v48, v228
    v_add_f32 v49, v49, v229
    v_add_f32 v50, v50, v230
    v_add_f32 v51, v51, v231
    v_add_f32 v40, v40, v176
    v_add_f32 v41, v41, v177
    v_add_f32 v42, v42, v178
    v_add_f32 v43, v43, v179
    v_add_f32 v44, v44, v180
    v_add_f32 v45, v45, v181
    v_add_f32 v46, v46, v182
    v_add_f32 v47, v47, v183
    v_add_f32 v48, v48, v184
    v_add_f32 v49, v49, v185
    v_add_f32 v50, v50, v186
    v_add_f32 v51, v51, v187
    v_mov_b32 v232, v48
    v_mov_b32 v4, v48
    s_nop 1
    v_permlane32_swap_b32 v232, v4
    v_rcp_f32 v5, v4
    s_nop 0
    v_mul_f32 v208, v40, v5
    v_mul_f32 v209, v41, v5
    v_mul_f32 v210, v42, v5
    v_mul_f32 v211, v43, v5
    v_mul_f32 v212, v44, v5
    v_mul_f32 v213, v45, v5
    v_mul_f32 v214, v46, v5
    v_mul_f32 v215, v47, v5
    v_mul_f32 v216, v48, v5
    v_mul_f32 v217, v49, v5
    v_mul_f32 v218, v50, v5
    v_mul_f32 v219, v51, v5
    v_cvt_pk_bf16_f32 v234, v208, v209
    v_cvt_pk_bf16_f32 v235, v210, v211
    v_cvt_pk_bf16_f32 v236, v212, v213
    v_cvt_pk_bf16_f32 v237, v214, v215
    v_cvt_pk_bf16_f32 v238, v216, v217
    v_cvt_pk_bf16_f32 v239, v218, v219
    s_waitcnt vmcnt(0)
    v_readfirstlane_b32 s4, v204
    s_nop 3
    s_and_b32 s5, s4, 0x3ff
    s_lshl_b32 s5, s5, 4
    s_bfe_u32 s6, s4, 0x7000a
    s_mul_i32 s6, s6, s6
    s_lshr_b32 s4, s4, 17
    s_cmp_eq_u32 s5, s6
    s_cselect_b32 s90, 1, 0
    s_cmp_eq_u32 s4, 16
    s_cselect_b32 s90, s90, 0
    s_cmp_eq_u32 s90, 0
    s_cbranch_scc1 L_p2_o_slow
    buffer_store_dwordx4 v[234:237], v2, s[16:19], s80 offen
    s_mov_b64 exec, s[38:39]
    buffer_store_dwordx2 v[238:239], v13, s[16:19], s81 offen
    s_mov_b64 exec, -1
    s_branch L_p2_o_join
L_p2_o_slow:
    buffer_store_dwordx4 v[234:237], v2, s[16:19], s80 offen sc1
    s_mov_b64 exec, s[38:39]
    buffer_store_dwordx2 v[238:239], v13, s[16:19], s81 offen sc1
    s_mov_b64 exec, -1
L_p2_o_join:
    s_mov_b32 s31, 0
    s_cmp_lg_u32 s32, 0
    s_cbranch_scc1 L_p2_dec
    s_mov_b32 s29, 0x1f800000
    s_mov_b32 s30, 0x5f800000
    v_cmp_nge_f32 vcc, v4, s29
    v_cmp_nle_f32 s[4:5], v4, s30
    s_nop 3
    s_or_b64 vcc, vcc, s[4:5]
    v_mul_f32 v5, 0, v40
    v_fma_f32 v5, v41, 0, v5
    v_fma_f32 v5, v42, 0, v5
    v_fma_f32 v5, v43, 0, v5
    v_fma_f32 v5, v44, 0, v5
    v_fma_f32 v5, v45, 0, v5
    v_fma_f32 v5, v46, 0, v5
    v_fma_f32 v5, v47, 0, v5
    v_fma_f32 v5, v48, 0, v5
    v_fma_f32 v5, v49, 0, v5
    v_fma_f32 v5, v50, 0, v5
    v_fma_f32 v5, v51, 0, v5
    v_cmp_u_f32 s[4:5], v5, v5
    s_nop 3
    s_or_b64 vcc, vcc, s[4:5]
    s_cmp_lg_u64 vcc, 0
    s_cselect_b32 s31, 1, 0
L_p2_dec:
    v_mov_b32 v5, s31
    s_lshl_b32 s29, s20, 2
    s_add_u32 s29, s29, 163584
    v_mov_b32 v6, s29
    ds_write_b32 v6, v5
    s_waitcnt vmcnt(0) lgkmcnt(0)
    s_barrier
    v_mov_b32 v6, 163584
    ds_read_b128 v[176:179], v6
    ds_read_b128 v[180:183], v6 offset:16
    s_waitcnt lgkmcnt(0)
    v_or_b32 v176, v176, v177
    v_or_b32 v176, v176, v178
    v_or_b32 v176, v176, v179
    v_or_b32 v176, v176, v180
    v_or_b32 v176, v176, v181
    v_or_b32 v176, v176, v182
    v_or_b32 v176, v176, v183
    s_nop 0
    v_readfirstlane_b32 s31, v176
    s_nop 3
    s_cmp_eq_u32 s31, 0
    s_cbranch_scc1 L_p2_done
    s_mov_b32 s32, 1
    v_mov_b32 v240, 0xff800000
    v_mov_b32 v241, 0xff800000
    v_mov_b32 v242, 0xff800000
    v_mov_b32 v243, 0xff800000
    s_mov_b32 s26, s33
    s_mov_b32 s28, 0
L_p2_maxloop:
    buffer_load_dwordx4 v[144:147], v10, s[16:19], s26 offen sc1
    s_mov_b64 exec, s[38:39]
    buffer_load_dwordx2 v[152:153], v11, s[16:19], s26 offen sc1
    s_mov_b64 exec, -1
    s_add_u32 s26, s26, 5120
    s_add_u32 s28, s28, 1
    s_waitcnt vmcnt(0)
    v_mfma_f32_32x32x16_bf16 v[104:119], v[144:147], v[16:19], 0
    v_mfma_f32_32x32x8bf16_1k v[104:119], v[152:153], v[32:33], v[104:119]
    s_nop 7
    s_nop 7
    v_max3_f32 v240, v240, v104, v105
    v_max3_f32 v240, v240, v106, v107
    v_max3_f32 v240, v240, v108, v109
    v_max3_f32 v240, v240, v110, v111
    v_max3_f32 v240, v240, v112, v113
    v_max3_f32 v240, v240, v114, v115
    v_max3_f32 v240, v240, v116, v117
    v_max3_f32 v240, v240, v118, v119
    v_mfma_f32_32x32x16_bf16 v[104:119], v[144:147], v[20:23], 0
    v_mfma_f32_32x32x8bf16_1k v[104:119], v[152:153], v[34:35], v[104:119]
    s_nop 7
    s_nop 7
    v_max3_f32 v241, v241, v104, v105
    v_max3_f32 v241, v241, v106, v107
    v_max3_f32 v241, v241, v108, v109
    v_max3_f32 v241, v241, v110, v111
    v_max3_f32 v241, v241, v112, v113
    v_max3_f32 v241, v241, v114, v115
    v_max3_f32 v241, v241, v116, v117
    v_max3_f32 v241, v241, v118, v119
    v_mfma_f32_32x32x16_bf16 v[104:119], v[144:147], v[24:27], 0
    v_mfma_f32_32x32x8bf16_1k v[104:119], v[152:153], v[36:37], v[104:119]
    s_nop 7
    s_nop 7
    v_max3_f32 v242, v242, v104, v105
    v_max3_f32 v242, v242, v106, v107
    v_max3_f32 v242, v242, v108, v109
    v_max3_f32 v242, v242, v110, v111
    v_max3_f32 v242, v242, v112, v113
    v_max3_f32 v242, v242, v114, v115
    v_max3_f32 v242, v242, v116, v117
    v_max3_f32 v242, v242, v118, v119
    v_mfma_f32_32x32x16_bf16 v[104:119], v[144:147], v[28:31], 0
    v_mfma_f32_32x32x8bf16_1k v[104:119], v[152:153], v[38:39], v[104:119]
    s_nop 7
    s_nop 7
    v_max3_f32 v243, v243, v104, v105
    v_max3_f32 v243, v243, v106, v107
    v_max3_f32 v243, v243, v108, v109
    v_max3_f32 v243, v243, v110, v111
    v_max3_f32 v243, v243, v112, v113
    v_max3_f32 v243, v243, v114, v115
    v_max3_f32 v243, v243, v116, v117
    v_max3_f32 v243, v243, v118, v119
    s_cmp_lt_u32 s28, 16
    s_cbranch_scc1 L_p2_maxloop
    s_lshl_b32 s29, s20, 9
    s_add_u32 s29, s29, 88064
    v_lshlrev_b32 v6, 2, v8
    v_add_u32 v3, s29, v6
    v_mov_b32 v4, v240
    s_nop 1
    v_permlane32_swap_b32 v240, v4
    v_max_f32 v240, v240, v4
    ds_write_b32 v3, v240 offset:0
    v_mov_b32 v4, v241
    s_nop 1
    v_permlane32_swap_b32 v241, v4
    v_max_f32 v241, v241, v4
    ds_write_b32 v3, v241 offset:128
    v_mov_b32 v4, v242
    s_nop 1
    v_permlane32_swap_b32 v242, v4
    v_max_f32 v242, v242, v4
    ds_write_b32 v3, v242 offset:256
    v_mov_b32 v4, v243
    s_nop 1
    v_permlane32_swap_b32 v243, v4
    v_max_f32 v243, v243, v4
    ds_write_b32 v3, v243 offset:384
    s_waitcnt lgkmcnt(0)
    s_barrier
    s_and_b32 s29, s20, 4
    s_lshl_b32 s29, s29, 9
    s_add_u32 s29, s29, 88064
    v_add_u32 v3, s29, v6
    ds_read_b32 v176, v3 offset:0
    ds_read_b32 v177, v3 offset:512
    ds_read_b32 v178, v3 offset:1024
    ds_read_b32 v179, v3 offset:1536
    s_waitcnt lgkmcnt(0)
    v_max3_f32 v176, v176, v177, v178
    v_max_f32 v176, v176, v179
    v_sub_f32 v176, 0, v176
    v_cvt_pk_bf16_f32 v177, v176, v176
    v_and_b32 v178, 0xffff0000, v177
    v_sub_f32 v178, v176, v178
    v_cvt_pk_bf16_f32 v177, v176, v178
    v_cmp_gt_u32 vcc, 32, v1
    s_nop 1
    v_cndmask_b32 v32, v177, v32, vcc
    ds_read_b32 v176, v3 offset:128
    ds_read_b32 v177, v3 offset:640
    ds_read_b32 v178, v3 offset:1152
    ds_read_b32 v179, v3 offset:1664
    s_waitcnt lgkmcnt(0)
    v_max3_f32 v176, v176, v177, v178
    v_max_f32 v176, v176, v179
    v_sub_f32 v176, 0, v176
    v_cvt_pk_bf16_f32 v177, v176, v176
    v_and_b32 v178, 0xffff0000, v177
    v_sub_f32 v178, v176, v178
    v_cvt_pk_bf16_f32 v177, v176, v178
    v_cmp_gt_u32 vcc, 32, v1
    s_nop 1
    v_cndmask_b32 v34, v177, v34, vcc
    ds_read_b32 v176, v3 offset:256
    ds_read_b32 v177, v3 offset:768
    ds_read_b32 v178, v3 offset:1280
    ds_read_b32 v179, v3 offset:1792
    s_waitcnt lgkmcnt(0)
    v_max3_f32 v176, v176, v177, v178
    v_max_f32 v176, v176, v179
    v_sub_f32 v176, 0, v176
    v_cvt_pk_bf16_f32 v177, v176, v176
    v_and_b32 v178, 0xffff0000, v177
    v_sub_f32 v178, v176, v178
    v_cvt_pk_bf16_f32 v177, v176, v178
    v_cmp_gt_u32 vcc, 32, v1
    s_nop 1
    v_cndmask_b32 v36, v177, v36, vcc
    ds_read_b32 v176, v3 offset:384
    ds_read_b32 v177, v3 offset:896
    ds_read_b32 v178, v3 offset:1408
    ds_read_b32 v179, v3 offset:1920
    s_waitcnt lgkmcnt(0)
    v_max3_f32 v176, v176, v177, v178
    v_max_f32 v176, v176, v179
    v_sub_f32 v176, 0, v176
    v_cvt_pk_bf16_f32 v177, v176, v176
    v_and_b32 v178, 0xffff0000, v177
    v_sub_f32 v178, v176, v178
    v_cvt_pk_bf16_f32 v177, v176, v178
    v_cmp_gt_u32 vcc, 32, v1
    s_nop 1
    v_cndmask_b32 v38, v177, v38, vcc
    s_barrier
    s_branch L_p2_pass
L_p2_done:
    v_readfirstlane_b32 s31, v203
    s_nop 3
    s_cmp_ge_u32 s31, 240
    s_cbranch_scc1 L_p2_rtok
    v_mov_b32 v3, 0
    s_mov_b32 s29, 24438784
    s_mov_b32 s30, 0
    s_mov_b64 exec, 1
L_poll_rt:
    buffer_load_dword v4, v3, s[16:19], s29 offen sc1
    s_add_u32 s30, s30, 1
    s_waitcnt vmcnt(0)
    v_cmp_gt_u32 vcc, 240, v4
    s_cmp_gt_u32 s30, 40000
    s_cbranch_scc1 L_pollx_rt
    s_nop 1
    s_cbranch_vccz L_pollx_rt
    s_sleep 1
    s_branch L_poll_rt
L_pollx_rt:
    s_mov_b64 exec, -1
L_p2_rtok:
    s_cmp_lg_u32 s20, 4
    s_cbranch_scc1 L_p2_noarr
    s_lshl_b32 s29, s91, 7
    s_add_u32 s29, s29, 24440832
    s_lshl_b32 s4, s92, 2
    v_mov_b32 v3, s4
    v_mov_b32 v4, 1
    s_mov_b64 exec, 1
    s_cmp_eq_u32 s90, 0
    s_cbranch_scc1 L_fs_slow1
    buffer_store_dword v4, v3, s[16:19], s29 offen
    s_branch L_fs_done1
L_fs_slow1:
    buffer_store_dword v4, v3, s[16:19], s29 offen sc1
L_fs_done1:
    s_mov_b64 exec, -1
L_p2_noarr:
    s_and_b32 s4, s2, 7
    s_lshr_b32 s5, s2, 3
    s_and_b32 s24, s5, 7
    s_lshr_b32 s6, s5, 3
    s_lshl_b32 s4, s4, 2
    s_add_u32 s23, s4, s6
    s_lshr_b32 s32, s21, 1
    s_and_b32 s33, s21, 1
    s_cmp_eq_u32 s22, 0
    s_cbranch_scc1 L_wo_compute
    s_cmp_lg_u32 s83, 0
    s_cbranch_scc1 L_wo_pre
    s_mov_b32 s4, 0
    s_mul_i32 s5, s21, 11
    s_add_u32 s4, s4, s5
    s_min_u32 s4, s4, 74
    s_lshl_b32 s4, s4, 10
    s_lshr_b32 s5, s2, 3
    s_and_b32 s5, s5, 7
    s_mul_i32 s5, s5, 102400
    s_add_u32 s5, s5, s4
    s_add_u32 s5, s5, 19464192
    s_add_u32 m0, s4, 0
    s_add_u32 s6, s5, 0
    buffer_load_dwordx4 v2, s[16:19], s6 offen offset:0 sc1 lds
    buffer_load_dwordx4 v2, s[16:19], s6 offen offset:1024 sc1 lds
    buffer_load_dwordx4 v2, s[16:19], s6 offen offset:2048 sc1 lds
    buffer_load_dwordx4 v2, s[16:19], s6 offen offset:3072 sc1 lds
    s_add_u32 m0, s4, 4096
    s_add_u32 s6, s5, 4096
    buffer_load_dwordx4 v2, s[16:19], s6 offen offset:0 sc1 lds
    buffer_load_dwordx4 v2, s[16:19], s6 offen offset:1024 sc1 lds
    buffer_load_dwordx4 v2, s[16:19], s6 offen offset:2048 sc1 lds
    buffer_load_dwordx4 v2, s[16:19], s6 offen offset:3072 sc1 lds
    s_add_u32 m0, s4, 8192
    s_add_u32 s6, s5, 8192
    buffer_load_dwordx4 v2, s[16:19], s6 offen offset:0 sc1 lds
    buffer_load_dwordx4 v2, s[16:19], s6 offen offset:1024 sc1 lds
    buffer_load_dwordx4 v2, s[16:19], s6 offen offset:2048 sc1 lds
    s_mov_b32 s4, 44
    s_mul_i32 s5, s21, 11
    s_add_u32 s4, s4, s5
    s_min_u32 s4, s4, 74
    s_lshl_b32 s4, s4, 10
    s_lshr_b32 s5, s2, 3
    s_and_b32 s5, s5, 7
    s_mul_i32 s5, s5, 102400
    s_add_u32 s5, s5, s4
    s_add_u32 s5, s5, 19464192
    s_add_u32 m0, s4, 0
    s_add_u32 s6, s5, 0
    buffer_load_dwordx4 v2, s[16:19], s6 offen offset:0 sc1 lds
    buffer_load_dwordx4 v2, s[16:19], s6 offen offset:1024 sc1 lds
    buffer_load_dwordx4 v2, s[16:19], s6 offen offset:2048 sc1 lds
    buffer_load_dwordx4 v2, s[16:19], s6 offen offset:3072 sc1 lds
    s_add_u32 m0, s4, 4096
    s_add_u32 s6, s5, 4096
    buffer_load_dwordx4 v2, s[16:19], s6 offen offset:0 sc1 lds
    buffer_load_dwordx4 v2, s[16:19], s6 offen offset:1024 sc1 lds
    buffer_load_dwordx4 v2, s[16:19], s6 offen offset:2048 sc1 lds
    buffer_load_dwordx4 v2, s[16:19], s6 offen offset:3072 sc1 lds
    s_add_u32 m0, s4, 8192
    s_add_u32 s6, s5, 8192
    buffer_load_dwordx4 v2, s[16:19], s6 offen offset:0 sc1 lds
    buffer_load_dwordx4 v2, s[16:19], s6 offen offset:1024 sc1 lds
    buffer_load_dwordx4 v2, s[16:19], s6 offen offset:2048 sc1 lds
L_wo_pre:
    s_lshl_b32 s26, s21, 2
    s_min_u32 s26, s26, 11
    s_add_u32 s26, s26, 85
    s_lshl_b32 s26, s26, 10
    s_mul_i32 s25, s24, 102400
    s_add_u32 s25, s25, s26
    s_add_u32 s25, s25, 19464192
    s_add_u32 m0, s26, 0
    s_add_u32 s27, s25, 0
    buffer_load_dwordx4 v2, s[16:19], s27 offen offset:0 sc1 lds
    buffer_load_dwordx4 v2, s[16:19], s27 offen offset:1024 sc1 lds
    buffer_load_dwordx4 v2, s[16:19], s27 offen offset:2048 sc1 lds
    buffer_load_dwordx4 v2, s[16:19], s27 offen offset:3072 sc1 lds
    s_mul_i32 s28, s23, 81920
    s_mul_i32 s27, s24, 160
    s_add_u32 s28, s28, s27
    s_lshl_b32 s27, s21, 6
    s_add_u32 s27, s27, 0
    v_add_u32 v3, s27, v1
    v_mul_u32_u24 v4, 6554, v3
    v_lshrrev_b32 v4, 16, v4
    v_mul_u32_u24 v5, 10, v4
    v_sub_u32 v5, v3, v5
    v_mul_u32_u24 v4, 1280, v4
    v_lshl_add_u32 v4, v5, 4, v4
    s_lshl_b32 s27, s21, 10
    s_add_u32 m0, s27, 102400
    s_nop 0
    buffer_load_dwordx4 v4, s[8:11], s28 offen lds
    s_lshl_b32 s27, s21, 6
    s_add_u32 s27, s27, 256
    v_add_u32 v3, s27, v1
    v_mul_u32_u24 v4, 6554, v3
    v_lshrrev_b32 v4, 16, v4
    v_mul_u32_u24 v5, 10, v4
    v_sub_u32 v5, v3, v5
    v_mul_u32_u24 v4, 1280, v4
    v_lshl_add_u32 v4, v5, 4, v4
    s_lshl_b32 s27, s21, 10
    s_add_u32 m0, s27, 106496
    s_nop 0
    buffer_load_dwordx4 v4, s[8:11], s28 offen lds
    s_lshl_b32 s27, s21, 6
    s_add_u32 s27, s27, 512
    v_add_u32 v3, s27, v1
    v_mul_u32_u24 v4, 6554, v3
    v_lshrrev_b32 v4, 16, v4
    v_mul_u32_u24 v5, 10, v4
    v_sub_u32 v5, v3, v5
    v_mul_u32_u24 v4, 1280, v4
    v_lshl_add_u32 v4, v5, 4, v4
    s_lshl_b32 s27, s21, 10
    s_add_u32 m0, s27, 110592
    s_cmp_ge_u32 s21, 2
    s_cbranch_scc1 L_wo_nox
    buffer_load_dwordx4 v4, s[8:11], s28 offen lds
L_wo_nox:
    s_lshr_b32 s5, s2, 3
    s_and_b32 s5, s5, 15
    s_mul_i32 s25, s5, 122880
    s_mul_i32 s26, s21, 7168
    s_min_u32 s26, s26, 20480
    s_add_u32 s25, s25, s26
    s_add_u32 s25, s25, 20283392
    s_add_u32 m0, s26, 133120
    s_add_u32 s27, s25, 0
    buffer_load_dwordx4 v2, s[16:19], s27 offen offset:0 sc1 lds
    buffer_load_dwordx4 v2, s[16:19], s27 offen offset:1024 sc1 lds
    buffer_load_dwordx4 v2, s[16:19], s27 offen offset:2048 sc1 lds
    buffer_load_dwordx4 v2, s[16:19], s27 offen offset:3072 sc1 lds
    s_add_u32 m0, s26, 137216
    s_add_u32 s27, s25, 4096
    buffer_load_dwordx4 v2, s[16:19], s27 offen offset:0 sc1 lds
    buffer_load_dwordx4 v2, s[16:19], s27 offen offset:1024 sc1 lds
    buffer_load_dwordx4 v2, s[16:19], s27 offen offset:2048 sc1 lds
    s_waitcnt vmcnt(7)
    v_mov_b32 v3, 163672
    v_mov_b32 v4, 1
    s_mov_b64 exec, 1
    ds_add_u32 v3, v4
    s_mov_b64 exec, -1
    s_lshr_b32 s5, s2, 3
    s_and_b32 s5, s5, 7
    s_mul_i32 s25, s5, 245760
    s_and_b32 s4, s21, 1
    s_mul_i32 s4, s4, 122880
    s_add_u32 s25, s25, s4
    s_add_u32 s25, s25, 22326272
    s_lshr_b32 s6, s21, 1
    s_lshl_b32 s6, s6, 3
    s_add_u32 s4, s6, 0
    s_min_u32 s4, s4, 14
    s_lshl_b32 s4, s4, 10
    s_add_u32 s4, s4, s25
    s_add_u32 s4, s4, 0
    buffer_load_dwordx4 v[100:103], v2, s[16:19], s4 offen sc1
    s_add_u32 s4, s6, 1
    s_min_u32 s4, s4, 14
    s_lshl_b32 s4, s4, 10
    s_add_u32 s4, s4, s25
    s_add_u32 s4, s4, 0
    buffer_load_dwordx4 v[104:107], v2, s[16:19], s4 offen sc1
    s_add_u32 s4, s6, 2
    s_min_u32 s4, s4, 14
    s_lshl_b32 s4, s4, 10
    s_add_u32 s4, s4, s25
    s_add_u32 s4, s4, 0
    buffer_load_dwordx4 v[108:111], v2, s[16:19], s4 offen sc1
    s_add_u32 s4, s6, 3
    s_min_u32 s4, s4, 14
    s_lshl_b32 s4, s4, 10
    s_add_u32 s4, s4, s25
    s_add_u32 s4, s4, 0
    buffer_load_dwordx4 v[112:115], v2, s[16:19], s4 offen sc1
    s_add_u32 s4, s6, 4
    s_min_u32 s4, s4, 14
    s_lshl_b32 s4, s4, 10
    s_add_u32 s4, s4, s25
    s_add_u32 s4, s4, 0
    buffer_load_dwordx4 v[116:119], v2, s[16:19], s4 offen sc1
    s_add_u32 s4, s6, 5
    s_min_u32 s4, s4, 14
    s_lshl_b32 s4, s4, 10
    s_add_u32 s4, s4, s25
    s_add_u32 s4, s4, 0
    buffer_load_dwordx4 v[120:123], v2, s[16:19], s4 offen sc1
    s_add_u32 s4, s6, 6
    s_min_u32 s4, s4, 14
    s_lshl_b32 s4, s4, 10
    s_add_u32 s4, s4, s25
    s_add_u32 s4, s4, 0
    buffer_load_dwordx4 v[124:127], v2, s[16:19], s4 offen sc1
    s_add_u32 s4, s6, 7
    s_min_u32 s4, s4, 14
    s_lshl_b32 s4, s4, 10
    s_add_u32 s4, s4, s25
    s_add_u32 s4, s4, 0
    buffer_load_dwordx4 v[128:131], v2, s[16:19], s4 offen sc1
    s_barrier
    s_lshr_b32 s5, s2, 3
    s_and_b32 s5, s5, 15
    s_mul_i32 s25, s5, 122880
    s_mul_i32 s26, s21, 24576
    s_min_u32 s26, s26, 70656
    s_add_u32 s25, s25, s26
    s_add_u32 s25, s25, 20311040
    s_add_u32 m0, s26, 0
    s_add_u32 s27, s25, 0
    buffer_load_dwordx4 v2, s[16:19], s27 offen offset:0 sc1 lds
    buffer_load_dwordx4 v2, s[16:19], s27 offen offset:1024 sc1 lds
    buffer_load_dwordx4 v2, s[16:19], s27 offen offset:2048 sc1 lds
    buffer_load_dwordx4 v2, s[16:19], s27 offen offset:3072 sc1 lds
    s_add_u32 m0, s26, 4096
    s_add_u32 s27, s25, 4096
    buffer_load_dwordx4 v2, s[16:19], s27 offen offset:0 sc1 lds
    buffer_load_dwordx4 v2, s[16:19], s27 offen offset:1024 sc1 lds
    buffer_load_dwordx4 v2, s[16:19], s27 offen offset:2048 sc1 lds
    buffer_load_dwordx4 v2, s[16:19], s27 offen offset:3072 sc1 lds
    s_add_u32 m0, s26, 8192
    s_add_u32 s27, s25, 8192
    buffer_load_dwordx4 v2, s[16:19], s27 offen offset:0 sc1 lds
    buffer_load_dwordx4 v2, s[16:19], s27 offen offset:1024 sc1 lds
    buffer_load_dwordx4 v2, s[16:19], s27 offen offset:2048 sc1 lds
    buffer_load_dwordx4 v2, s[16:19], s27 offen offset:3072 sc1 lds
    s_add_u32 m0, s26, 12288
    s_add_u32 s27, s25, 12288
    buffer_load_dwordx4 v2, s[16:19], s27 offen offset:0 sc1 lds
    buffer_load_dwordx4 v2, s[16:19], s27 offen offset:1024 sc1 lds
    buffer_load_dwordx4 v2, s[16:19], s27 offen offset:2048 sc1 lds
    buffer_load_dwordx4 v2, s[16:19], s27 offen offset:3072 sc1 lds
    s_add_u32 m0, s26, 16384
    s_add_u32 s27, s25, 16384
    buffer_load_dwordx4 v2, s[16:19], s27 offen offset:0 sc1 lds
    buffer_load_dwordx4 v2, s[16:19], s27 offen offset:1024 sc1 lds
    buffer_load_dwordx4 v2, s[16:19], s27 offen offset:2048 sc1 lds
    buffer_load_dwordx4 v2, s[16:19], s27 offen offset:3072 sc1 lds
    s_add_u32 m0, s26, 20480
    s_add_u32 s27, s25, 20480
    buffer_load_dwordx4 v2, s[16:19], s27 offen offset:0 sc1 lds
    buffer_load_dwordx4 v2, s[16:19], s27 offen offset:1024 sc1 lds
    buffer_load_dwordx4 v2, s[16:19], s27 offen offset:2048 sc1 lds
    buffer_load_dwordx4 v2, s[16:19], s27 offen offset:3072 sc1 lds
    s_branch L_wo_done
L_wo_compute:
    v_and_b32 v48, 15, v1
    v_lshrrev_b32 v49, 4, v1
    v_lshrrev_b32 v3, 1, v49
    v_lshlrev_b32 v3, 10, v3
    v_and_b32 v4, 1, v49
    v_lshl_add_u32 v3, v4, 9, v3
    v_lshl_add_u32 v3, v48, 4, v3
    s_lshl_b32 s28, s33, 8
    v_add_u32 v50, s28, v3
    s_xor_b32 s28, s28, 256
    v_add_u32 v51, s28, v3
    v_and_b32 v3, 1, v49
    v_lshlrev_b32 v3, 9, v3
    v_lshrrev_b32 v4, 1, v49
    v_lshl_add_u32 v3, v4, 3, v3
    v_lshl_add_u32 v3, v48, 4, v3
    s_lshl_b32 s28, s33, 8
    v_add_u32 v52, s28, v3
    s_lshl_b32 s37, s23, 1
    s_add_u32 s37, s37, s32
    s_mul_i32 s37, s37, 40960
    s_mul_i32 s27, s24, 5120
    s_add_u32 s37, s37, s27
    s_add_u32 s37, s37, 10551296
    s_mul_i32 s27, s33, 51200
    v_add_u32 v53, s27, v2
    v_mov_b32 v8, 0
    v_mov_b32 v9, 0
    v_mov_b32 v10, 0
    v_mov_b32 v11, 0
    v_mov_b32 v12, 0
    v_mov_b32 v13, 0
    v_mov_b32 v14, 0
    v_mov_b32 v15, 0
    v_mov_b32 v16, 0
    v_mov_b32 v17, 0
    v_mov_b32 v18, 0
    v_mov_b32 v19, 0
    v_mov_b32 v20, 0
    v_mov_b32 v21, 0
    v_mov_b32 v22, 0
    v_mov_b32 v23, 0
    v_mov_b32 v24, 0
    v_mov_b32 v25, 0
    v_mov_b32 v26, 0
    v_mov_b32 v27, 0
    v_mov_b32 v28, 0
    v_mov_b32 v29, 0
    v_mov_b32 v30, 0
    v_mov_b32 v31, 0
    v_mov_b32 v32, 0
    v_mov_b32 v33, 0
    v_mov_b32 v34, 0
    v_mov_b32 v35, 0
    v_mov_b32 v36, 0
    v_mov_b32 v37, 0
    v_mov_b32 v38, 0
    v_mov_b32 v39, 0
    v_mov_b32 v40, 0
    v_mov_b32 v41, 0
    v_mov_b32 v42, 0
    v_mov_b32 v43, 0
    v_mov_b32 v44, 0
    v_mov_b32 v45, 0
    v_mov_b32 v46, 0
    v_mov_b32 v47, 0
    s_lshl_b32 s26, s23, 1
    s_add_u32 s26, s26, s32
    s_mul_i32 s26, s26, 40960
    s_mul_i32 s27, s33, 20480
    s_add_u32 s26, s26, s27
    s_add_u32 s26, s26, 7929856
    s_cmp_lg_u32 s20, 0
    s_cbranch_scc1 L_wo_nopoll
    s_lshl_b32 s28, s91, 7
    s_add_u32 s28, s28, 24440832
    v_lshlrev_b32 v3, 2, v1
    s_mov_b32 s29, 0
    s_mov_b64 exec, 0xffff
L_poll_wo:
    buffer_load_dword v4, v3, s[16:19], s28 offen sc1
    s_add_u32 s29, s29, 1
    s_waitcnt vmcnt(0)
    v_cmp_gt_u32 vcc, 1, v4
    s_cmp_gt_u32 s29, 40000
    s_cbranch_scc1 L_pollx_wo
    s_nop 1
    s_cbranch_vccz L_pollx_wo
    s_sleep 1
    s_branch L_poll_wo
L_pollx_wo:
    s_mov_b64 exec, -1
    v_mov_b32 v3, 163672
    v_mov_b32 v4, 16
    s_mov_b64 exec, 1
    ds_add_u32 v3, v4
    s_mov_b64 exec, -1
L_wo_nopoll:
    v_mov_b32 v3, 163672
    s_mov_b32 s28, 0
L_spin_z3:
    ds_read_b32 v4, v3
    s_add_u32 s28, s28, 1
    s_waitcnt lgkmcnt(0)
    v_readfirstlane_b32 s27, v4
    s_cmp_gt_u32 s28, 1600000
    s_cbranch_scc1 L_spinx_z3
    s_nop 1
    s_cmp_ge_u32 s27, 20
    s_cbranch_scc0 L_spin_z3
L_spinx_z3:
    buffer_load_dwordx4 v[116:119], v50, s[16:19], s26 offen sc1
    buffer_load_dwordx4 v[120:123], v51, s[16:19], s26 offen sc1
    s_add_u32 s93, s26, 2048
    buffer_load_dwordx4 v[124:127], v50, s[16:19], s93 offen sc1
    buffer_load_dwordx4 v[128:131], v51, s[16:19], s93 offen sc1
    s_add_u32 s93, s26, 4096
    buffer_load_dwordx4 v[132:135], v50, s[16:19], s93 offen sc1
    buffer_load_dwordx4 v[136:139], v51, s[16:19], s93 offen sc1
    s_add_u32 s93, s26, 6144
    buffer_load_dwordx4 v[140:143], v50, s[16:19], s93 offen sc1
    buffer_load_dwordx4 v[144:147], v51, s[16:19], s93 offen sc1
    ds_read_b128 v[56:59], v53 offset:0
    ds_read_b128 v[60:63], v53 offset:1024
    ds_read_b128 v[64:67], v53 offset:2048
    ds_read_b128 v[68:71], v53 offset:3072
    ds_read_b128 v[72:75], v53 offset:4096
    ds_read_b128 v[76:79], v53 offset:5120
    ds_read_b128 v[80:83], v53 offset:6144
    ds_read_b128 v[84:87], v53 offset:7168
    ds_read_b128 v[88:91], v53 offset:8192
    ds_read_b128 v[92:95], v53 offset:9216
    s_waitcnt vmcnt(6) lgkmcnt(5)
    v_mfma_f32_16x16x32_bf16 v[8:11], v[56:59], v[116:119], v[8:11]
    ds_read_b128 v[96:99], v53 offset:10240
    v_mfma_f32_16x16x32_bf16 v[28:31], v[56:59], v[120:123], v[28:31]
    ds_read_b128 v[100:103], v53 offset:11264
    v_mfma_f32_16x16x32_bf16 v[12:15], v[60:63], v[116:119], v[12:15]
    ds_read_b128 v[104:107], v53 offset:12288
    v_mfma_f32_16x16x32_bf16 v[32:35], v[60:63], v[120:123], v[32:35]
    ds_read_b128 v[108:111], v53 offset:13312
    v_mfma_f32_16x16x32_bf16 v[16:19], v[64:67], v[116:119], v[16:19]
    ds_read_b128 v[112:115], v53 offset:14336
    v_mfma_f32_16x16x32_bf16 v[36:39], v[64:67], v[120:123], v[36:39]
    s_add_u32 s93, s26, 8192
    v_mfma_f32_16x16x32_bf16 v[20:23], v[68:71], v[116:119], v[20:23]
    buffer_load_dwordx4 v[148:151], v50, s[16:19], s93 offen sc1
    v_mfma_f32_16x16x32_bf16 v[40:43], v[68:71], v[120:123], v[40:43]
    buffer_load_dwordx4 v[152:155], v51, s[16:19], s93 offen sc1
    v_mfma_f32_16x16x32_bf16 v[24:27], v[72:75], v[116:119], v[24:27]
    v_mfma_f32_16x16x32_bf16 v[44:47], v[72:75], v[120:123], v[44:47]
    s_waitcnt vmcnt(6) lgkmcnt(5)
    v_mfma_f32_16x16x32_bf16 v[8:11], v[76:79], v[124:127], v[8:11]
    ds_read_b128 v[56:59], v53 offset:15360
    v_mfma_f32_16x16x32_bf16 v[28:31], v[76:79], v[128:131], v[28:31]
    ds_read_b128 v[60:63], v53 offset:16384
    v_mfma_f32_16x16x32_bf16 v[12:15], v[80:83], v[124:127], v[12:15]
    ds_read_b128 v[64:67], v53 offset:17408
    v_mfma_f32_16x16x32_bf16 v[32:35], v[80:83], v[128:131], v[32:35]
    ds_read_b128 v[68:71], v53 offset:18432
    v_mfma_f32_16x16x32_bf16 v[16:19], v[84:87], v[124:127], v[16:19]
    ds_read_b128 v[72:75], v53 offset:19456
    v_mfma_f32_16x16x32_bf16 v[36:39], v[84:87], v[128:131], v[36:39]
    s_add_u32 s93, s26, 10240
    v_mfma_f32_16x16x32_bf16 v[20:23], v[88:91], v[124:127], v[20:23]
    buffer_load_dwordx4 v[116:119], v50, s[16:19], s93 offen sc1
    v_mfma_f32_16x16x32_bf16 v[40:43], v[88:91], v[128:131], v[40:43]
    buffer_load_dwordx4 v[120:123], v51, s[16:19], s93 offen sc1
    v_mfma_f32_16x16x32_bf16 v[24:27], v[92:95], v[124:127], v[24:27]
    v_mfma_f32_16x16x32_bf16 v[44:47], v[92:95], v[128:131], v[44:47]
    s_waitcnt vmcnt(6) lgkmcnt(5)
    v_mfma_f32_16x16x32_bf16 v[8:11], v[96:99], v[132:135], v[8:11]
    ds_read_b128 v[76:79], v53 offset:20480
    v_mfma_f32_16x16x32_bf16 v[28:31], v[96:99], v[136:139], v[28:31]
    ds_read_b128 v[80:83], v53 offset:21504
    v_mfma_f32_16x16x32_bf16 v[12:15], v[100:103], v[132:135], v[12:15]
    ds_read_b128 v[84:87], v53 offset:22528
    v_mfma_f32_16x16x32_bf16 v[32:35], v[100:103], v[136:139], v[32:35]
    ds_read_b128 v[88:91], v53 offset:23552
    v_mfma_f32_16x16x32_bf16 v[16:19], v[104:107], v[132:135], v[16:19]
    ds_read_b128 v[92:95], v53 offset:24576
    v_mfma_f32_16x16x32_bf16 v[36:39], v[104:107], v[136:139], v[36:39]
    s_add_u32 s93, s26, 12288
    v_mfma_f32_16x16x32_bf16 v[20:23], v[108:111], v[132:135], v[20:23]
    buffer_load_dwordx4 v[124:127], v50, s[16:19], s93 offen sc1
    v_mfma_f32_16x16x32_bf16 v[40:43], v[108:111], v[136:139], v[40:43]
    buffer_load_dwordx4 v[128:131], v51, s[16:19], s93 offen sc1
    v_mfma_f32_16x16x32_bf16 v[24:27], v[112:115], v[132:135], v[24:27]
    v_mfma_f32_16x16x32_bf16 v[44:47], v[112:115], v[136:139], v[44:47]
    s_waitcnt vmcnt(6) lgkmcnt(5)
    v_mfma_f32_16x16x32_bf16 v[8:11], v[56:59], v[140:143], v[8:11]
    ds_read_b128 v[96:99], v53 offset:25600
    v_mfma_f32_16x16x32_bf16 v[28:31], v[56:59], v[144:147], v[28:31]
    ds_read_b128 v[100:103], v53 offset:26624
    v_mfma_f32_16x16x32_bf16 v[12:15], v[60:63], v[140:143], v[12:15]
    ds_read_b128 v[104:107], v53 offset:27648
    v_mfma_f32_16x16x32_bf16 v[32:35], v[60:63], v[144:147], v[32:35]
    ds_read_b128 v[108:111], v53 offset:28672
    v_mfma_f32_16x16x32_bf16 v[16:19], v[64:67], v[140:143], v[16:19]
    ds_read_b128 v[112:115], v53 offset:29696
    v_mfma_f32_16x16x32_bf16 v[36:39], v[64:67], v[144:147], v[36:39]
    s_add_u32 s93, s26, 14336
    v_mfma_f32_16x16x32_bf16 v[20:23], v[68:71], v[140:143], v[20:23]
    buffer_load_dwordx4 v[132:135], v50, s[16:19], s93 offen sc1
    v_mfma_f32_16x16x32_bf16 v[40:43], v[68:71], v[144:147], v[40:43]
    buffer_load_dwordx4 v[136:139], v51, s[16:19], s93 offen sc1
    v_mfma_f32_16x16x32_bf16 v[24:27], v[72:75], v[140:143], v[24:27]
    v_mfma_f32_16x16x32_bf16 v[44:47], v[72:75], v[144:147], v[44:47]
    s_waitcnt vmcnt(6) lgkmcnt(5)
    v_mfma_f32_16x16x32_bf16 v[8:11], v[76:79], v[148:151], v[8:11]
    ds_read_b128 v[56:59], v53 offset:30720
    v_mfma_f32_16x16x32_bf16 v[28:31], v[76:79], v[152:155], v[28:31]
    ds_read_b128 v[60:63], v53 offset:31744
    v_mfma_f32_16x16x32_bf16 v[12:15], v[80:83], v[148:151], v[12:15]
    ds_read_b128 v[64:67], v53 offset:32768
    v_mfma_f32_16x16x32_bf16 v[32:35], v[80:83], v[152:155], v[32:35]
    ds_read_b128 v[68:71], v53 offset:33792
    v_mfma_f32_16x16x32_bf16 v[16:19], v[84:87], v[148:151], v[16:19]
    ds_read_b128 v[72:75], v53 offset:34816
    v_mfma_f32_16x16x32_bf16 v[36:39], v[84:87], v[152:155], v[36:39]
    s_add_u32 s93, s26, 16384
    v_mfma_f32_16x16x32_bf16 v[20:23], v[88:91], v[148:151], v[20:23]
    buffer_load_dwordx4 v[140:143], v50, s[16:19], s93 offen sc1
    v_mfma_f32_16x16x32_bf16 v[40:43], v[88:91], v[152:155], v[40:43]
    buffer_load_dwordx4 v[144:147], v51, s[16:19], s93 offen sc1
    v_mfma_f32_16x16x32_bf16 v[24:27], v[92:95], v[148:151], v[24:27]
    v_mfma_f32_16x16x32_bf16 v[44:47], v[92:95], v[152:155], v[44:47]
    s_waitcnt vmcnt(6) lgkmcnt(5)
    v_mfma_f32_16x16x32_bf16 v[8:11], v[96:99], v[116:119], v[8:11]
    ds_read_b128 v[76:79], v53 offset:35840
    v_mfma_f32_16x16x32_bf16 v[28:31], v[96:99], v[120:123], v[28:31]
    ds_read_b128 v[80:83], v53 offset:36864
    v_mfma_f32_16x16x32_bf16 v[12:15], v[100:103], v[116:119], v[12:15]
    ds_read_b128 v[84:87], v53 offset:37888
    v_mfma_f32_16x16x32_bf16 v[32:35], v[100:103], v[120:123], v[32:35]
    ds_read_b128 v[88:91], v53 offset:38912
    v_mfma_f32_16x16x32_bf16 v[16:19], v[104:107], v[116:119], v[16:19]
    ds_read_b128 v[92:95], v53 offset:39936
    v_mfma_f32_16x16x32_bf16 v[36:39], v[104:107], v[120:123], v[36:39]
    s_add_u32 s93, s26, 18432
    v_mfma_f32_16x16x32_bf16 v[20:23], v[108:111], v[116:119], v[20:23]
    buffer_load_dwordx4 v[148:151], v50, s[16:19], s93 offen sc1
    v_mfma_f32_16x16x32_bf16 v[40:43], v[108:111], v[120:123], v[40:43]
    buffer_load_dwordx4 v[152:155], v51, s[16:19], s93 offen sc1
    v_mfma_f32_16x16x32_bf16 v[24:27], v[112:115], v[116:119], v[24:27]
    v_mfma_f32_16x16x32_bf16 v[44:47], v[112:115], v[120:123], v[44:47]
    s_waitcnt vmcnt(6) lgkmcnt(5)
    v_mfma_f32_16x16x32_bf16 v[8:11], v[56:59], v[124:127], v[8:11]
    ds_read_b128 v[96:99], v53 offset:40960
    v_mfma_f32_16x16x32_bf16 v[28:31], v[56:59], v[128:131], v[28:31]
    ds_read_b128 v[100:103], v53 offset:41984
    v_mfma_f32_16x16x32_bf16 v[12:15], v[60:63], v[124:127], v[12:15]
    ds_read_b128 v[104:107], v53 offset:43008
    v_mfma_f32_16x16x32_bf16 v[32:35], v[60:63], v[128:131], v[32:35]
    ds_read_b128 v[108:111], v53 offset:44032
    v_mfma_f32_16x16x32_bf16 v[16:19], v[64:67], v[124:127], v[16:19]
    ds_read_b128 v[112:115], v53 offset:45056
    v_mfma_f32_16x16x32_bf16 v[36:39], v[64:67], v[128:131], v[36:39]
    v_mfma_f32_16x16x32_bf16 v[20:23], v[68:71], v[124:127], v[20:23]
    v_mfma_f32_16x16x32_bf16 v[40:43], v[68:71], v[128:131], v[40:43]
    v_mfma_f32_16x16x32_bf16 v[24:27], v[72:75], v[124:127], v[24:27]
    v_mfma_f32_16x16x32_bf16 v[44:47], v[72:75], v[128:131], v[44:47]
    s_waitcnt vmcnt(4) lgkmcnt(5)
    v_mfma_f32_16x16x32_bf16 v[8:11], v[76:79], v[132:135], v[8:11]
    ds_read_b128 v[56:59], v53 offset:46080
    v_mfma_f32_16x16x32_bf16 v[28:31], v[76:79], v[136:139], v[28:31]
    ds_read_b128 v[60:63], v53 offset:47104
    v_mfma_f32_16x16x32_bf16 v[12:15], v[80:83], v[132:135], v[12:15]
    ds_read_b128 v[64:67], v53 offset:48128
    v_mfma_f32_16x16x32_bf16 v[32:35], v[80:83], v[136:139], v[32:35]
    ds_read_b128 v[68:71], v53 offset:49152
    v_mfma_f32_16x16x32_bf16 v[16:19], v[84:87], v[132:135], v[16:19]
    ds_read_b128 v[72:75], v53 offset:50176
    v_mfma_f32_16x16x32_bf16 v[36:39], v[84:87], v[136:139], v[36:39]
    v_mfma_f32_16x16x32_bf16 v[20:23], v[88:91], v[132:135], v[20:23]
    v_mfma_f32_16x16x32_bf16 v[40:43], v[88:91], v[136:139], v[40:43]
    v_mfma_f32_16x16x32_bf16 v[24:27], v[92:95], v[132:135], v[24:27]
    v_mfma_f32_16x16x32_bf16 v[44:47], v[92:95], v[136:139], v[44:47]
    s_waitcnt vmcnt(2) lgkmcnt(5)
    v_mfma_f32_16x16x32_bf16 v[8:11], v[96:99], v[140:143], v[8:11]
    v_mfma_f32_16x16x32_bf16 v[28:31], v[96:99], v[144:147], v[28:31]
    v_mfma_f32_16x16x32_bf16 v[12:15], v[100:103], v[140:143], v[12:15]
    v_mfma_f32_16x16x32_bf16 v[32:35], v[100:103], v[144:147], v[32:35]
    v_mfma_f32_16x16x32_bf16 v[16:19], v[104:107], v[140:143], v[16:19]
    v_mfma_f32_16x16x32_bf16 v[36:39], v[104:107], v[144:147], v[36:39]
    v_mfma_f32_16x16x32_bf16 v[20:23], v[108:111], v[140:143], v[20:23]
    v_mfma_f32_16x16x32_bf16 v[40:43], v[108:111], v[144:147], v[40:43]
    v_mfma_f32_16x16x32_bf16 v[24:27], v[112:115], v[140:143], v[24:27]
    v_mfma_f32_16x16x32_bf16 v[44:47], v[112:115], v[144:147], v[44:47]
    s_waitcnt vmcnt(0) lgkmcnt(0)
    v_mfma_f32_16x16x32_bf16 v[8:11], v[56:59], v[148:151], v[8:11]
    v_mfma_f32_16x16x32_bf16 v[28:31], v[56:59], v[152:155], v[28:31]
    v_mfma_f32_16x16x32_bf16 v[12:15], v[60:63], v[148:151], v[12:15]
    v_mfma_f32_16x16x32_bf16 v[32:35], v[60:63], v[152:155], v[32:35]
    v_mfma_f32_16x16x32_bf16 v[16:19], v[64:67], v[148:151], v[16:19]
    v_mfma_f32_16x16x32_bf16 v[36:39], v[64:67], v[152:155], v[36:39]
    v_mfma_f32_16x16x32_bf16 v[20:23], v[68:71], v[148:151], v[20:23]
    v_mfma_f32_16x16x32_bf16 v[40:43], v[68:71], v[152:155], v[40:43]
    v_mfma_f32_16x16x32_bf16 v[24:27], v[72:75], v[148:151], v[24:27]
    v_mfma_f32_16x16x32_bf16 v[44:47], v[72:75], v[152:155], v[44:47]
    s_nop 7
    s_waitcnt lgkmcnt(0)
    s_mul_i32 s27, s21, 5120
    s_add_u32 s27, s27, 112640
    v_add_u32 v3, s27, v2
    ds_write_b128 v3, v[28:31] offset:0
    ds_write_b128 v3, v[32:35] offset:1024
    ds_write_b128 v3, v[36:39] offset:2048
    ds_write_b128 v3, v[40:43] offset:3072
    ds_write_b128 v3, v[44:47] offset:4096
    s_waitcnt lgkmcnt(0)
    s_barrier
    s_xor_b32 s27, s21, 1
    s_mul_i32 s27, s27, 5120
    s_add_u32 s27, s27, 112640
    v_add_u32 v3, s27, v2
    ds_read_b128 v[28:31], v3 offset:0
    ds_read_b128 v[32:35], v3 offset:1024
    ds_read_b128 v[36:39], v3 offset:2048
    ds_read_b128 v[40:43], v3 offset:3072
    ds_read_b128 v[44:47], v3 offset:4096
    s_lshl_b32 s27, s32, 5
    s_lshl_b32 s28, s33, 4
    s_add_u32 s27, s27, s28
    v_add_u32 v166, s27, v48
    v_mul_u32_u24 v4, 160, v166
    v_lshl_add_u32 v4, v49, 3, v4
    v_add_u32 v4, 102400, v4
    ds_read_b64 v[156:157], v4 offset:0
    ds_read_b64 v[158:159], v4 offset:32
    ds_read_b64 v[160:161], v4 offset:64
    ds_read_b64 v[162:163], v4 offset:96
    ds_read_b64 v[164:165], v4 offset:128
    s_waitcnt lgkmcnt(0)
    v_mov_b32 v178, 0
    v_mov_b32 v179, 0
    v_add_f32 v8, v8, v28
    v_add_f32 v9, v9, v29
    v_add_f32 v10, v10, v30
    v_add_f32 v11, v11, v31
    v_lshlrev_b32 v5, 16, v156
    v_and_b32 v6, 0xffff0000, v156
    v_add_f32 v8, v8, v5
    v_add_f32 v9, v9, v6
    v_lshlrev_b32 v5, 16, v157
    v_and_b32 v6, 0xffff0000, v157
    v_add_f32 v10, v10, v5
    v_add_f32 v11, v11, v6
    v_cvt_pk_bf16_f32 v168, v8, v9
    v_cvt_pk_bf16_f32 v169, v10, v11
    v_add_f32 v12, v12, v32
    v_add_f32 v13, v13, v33
    v_add_f32 v14, v14, v34
    v_add_f32 v15, v15, v35
    v_lshlrev_b32 v5, 16, v158
    v_and_b32 v6, 0xffff0000, v158
    v_add_f32 v12, v12, v5
    v_add_f32 v13, v13, v6
    v_lshlrev_b32 v5, 16, v159
    v_and_b32 v6, 0xffff0000, v159
    v_add_f32 v14, v14, v5
    v_add_f32 v15, v15, v6
    v_cvt_pk_bf16_f32 v170, v12, v13
    v_cvt_pk_bf16_f32 v171, v14, v15
    v_add_f32 v16, v16, v36
    v_add_f32 v17, v17, v37
    v_add_f32 v18, v18, v38
    v_add_f32 v19, v19, v39
    v_lshlrev_b32 v5, 16, v160
    v_and_b32 v6, 0xffff0000, v160
    v_add_f32 v16, v16, v5
    v_add_f32 v17, v17, v6
    v_lshlrev_b32 v5, 16, v161
    v_and_b32 v6, 0xffff0000, v161
    v_add_f32 v18, v18, v5
    v_add_f32 v19, v19, v6
    v_cvt_pk_bf16_f32 v172, v16, v17
    v_cvt_pk_bf16_f32 v173, v18, v19
    v_add_f32 v20, v20, v40
    v_add_f32 v21, v21, v41
    v_add_f32 v22, v22, v42
    v_add_f32 v23, v23, v43
    v_lshlrev_b32 v5, 16, v162
    v_and_b32 v6, 0xffff0000, v162
    v_add_f32 v20, v20, v5
    v_add_f32 v21, v21, v6
    v_lshlrev_b32 v5, 16, v163
    v_and_b32 v6, 0xffff0000, v163
    v_add_f32 v22, v22, v5
    v_add_f32 v23, v23, v6
    v_cvt_pk_bf16_f32 v174, v20, v21
    v_cvt_pk_bf16_f32 v175, v22, v23
    v_add_f32 v24, v24, v44
    v_add_f32 v25, v25, v45
    v_add_f32 v26, v26, v46
    v_add_f32 v27, v27, v47
    v_lshlrev_b32 v5, 16, v164
    v_and_b32 v6, 0xffff0000, v164
    v_add_f32 v24, v24, v5
    v_add_f32 v25, v25, v6
    v_lshlrev_b32 v5, 16, v165
    v_and_b32 v6, 0xffff0000, v165
    v_add_f32 v26, v26, v5
    v_add_f32 v27, v27, v6
    v_cvt_pk_bf16_f32 v176, v24, v25
    v_cvt_pk_bf16_f32 v177, v26, v27
    s_cmp_eq_u32 s90, 0
    s_cbranch_scc1 L_wo_h_slow
    buffer_store_dwordx2 v[168:169], v52, s[16:19], s37 offen offset:0
    buffer_store_dwordx2 v[170:171], v52, s[16:19], s37 offen offset:1024
    buffer_store_dwordx2 v[172:173], v52, s[16:19], s37 offen offset:2048
    buffer_store_dwordx2 v[174:175], v52, s[16:19], s37 offen offset:3072
    s_add_u32 s27, s37, 4096
    buffer_store_dwordx2 v[176:177], v52, s[16:19], s27 offen
    s_branch L_wo_h_join
L_wo_h_slow:
    buffer_store_dwordx2 v[168:169], v52, s[16:19], s37 offen offset:0 sc1
    buffer_store_dwordx2 v[170:171], v52, s[16:19], s37 offen offset:1024 sc1
    buffer_store_dwordx2 v[172:173], v52, s[16:19], s37 offen offset:2048 sc1
    buffer_store_dwordx2 v[174:175], v52, s[16:19], s37 offen offset:3072 sc1
    s_add_u32 s27, s37, 4096
    buffer_store_dwordx2 v[176:177], v52, s[16:19], s27 offen sc1
L_wo_h_join:
    v_lshlrev_b32 v5, 16, v168
    v_and_b32 v6, 0xffff0000, v168
    v_add_f32 v178, v178, v5
    v_fmac_f32 v179, v5, v5
    v_add_f32 v178, v178, v6
    v_fmac_f32 v179, v6, v6
    v_lshlrev_b32 v5, 16, v169
    v_and_b32 v6, 0xffff0000, v169
    v_add_f32 v178, v178, v5
    v_fmac_f32 v179, v5, v5
    v_add_f32 v178, v178, v6
    v_fmac_f32 v179, v6, v6
    v_lshlrev_b32 v5, 16, v170
    v_and_b32 v6, 0xffff0000, v170
    v_add_f32 v178, v178, v5
    v_fmac_f32 v179, v5, v5
    v_add_f32 v178, v178, v6
    v_fmac_f32 v179, v6, v6
    v_lshlrev_b32 v5, 16, v171
    v_and_b32 v6, 0xffff0000, v171
    v_add_f32 v178, v178, v5
    v_fmac_f32 v179, v5, v5
    v_add_f32 v178, v178, v6
    v_fmac_f32 v179, v6, v6
    v_lshlrev_b32 v5, 16, v172
    v_and_b32 v6, 0xffff0000, v172
    v_add_f32 v178, v178, v5
    v_fmac_f32 v179, v5, v5
    v_add_f32 v178, v178, v6
    v_fmac_f32 v179, v6, v6
    v_lshlrev_b32 v5, 16, v173
    v_and_b32 v6, 0xffff0000, v173
    v_add_f32 v178, v178, v5
    v_fmac_f32 v179, v5, v5
    v_add_f32 v178, v178, v6
    v_fmac_f32 v179, v6, v6
    v_lshlrev_b32 v5, 16, v174
    v_and_b32 v6, 0xffff0000, v174
    v_add_f32 v178, v178, v5
    v_fmac_f32 v179, v5, v5
    v_add_f32 v178, v178, v6
    v_fmac_f32 v179, v6, v6
    v_lshlrev_b32 v5, 16, v175
    v_and_b32 v6, 0xffff0000, v175
    v_add_f32 v178, v178, v5
    v_fmac_f32 v179, v5, v5
    v_add_f32 v178, v178, v6
    v_fmac_f32 v179, v6, v6
    v_lshlrev_b32 v5, 16, v176
    v_and_b32 v6, 0xffff0000, v176
    v_add_f32 v178, v178, v5
    v_fmac_f32 v179, v5, v5
    v_add_f32 v178, v178, v6
    v_fmac_f32 v179, v6, v6
    v_lshlrev_b32 v5, 16, v177
    v_and_b32 v6, 0xffff0000, v177
    v_add_f32 v178, v178, v5
    v_fmac_f32 v179, v5, v5
    v_add_f32 v178, v178, v6
    v_fmac_f32 v179, v6, v6
    v_mov_b32 v5, v178
    s_nop 1
    v_permlane32_swap_b32 v178, v5
    v_add_f32 v178, v178, v5
    v_mov_b32 v5, v178
    s_nop 1
    v_permlane16_swap_b32 v178, v5
    v_add_f32 v178, v178, v5
    v_mov_b32 v5, v179
    s_nop 1
    v_permlane32_swap_b32 v179, v5
    v_add_f32 v179, v179, v5
    v_mov_b32 v5, v179
    s_nop 1
    v_permlane16_swap_b32 v179, v5
    v_add_f32 v179, v179, v5
    v_mov_b32 v180, v178
    v_mov_b32 v181, v179
    s_lshl_b32 s27, s23, 6
    v_add_u32 v5, s27, v166
    v_lshlrev_b32 v5, 3, v5
    s_mul_i32 s27, s24, 16384
    s_add_u32 s27, s27, 24276992
    s_mov_b64 exec, 0xffff
    s_cmp_eq_u32 s90, 0
    s_cbranch_scc1 L_wo_st_slow
    buffer_store_dwordx2 v[180:181], v5, s[16:19], s27 offen
    s_branch L_wo_st_join
L_wo_st_slow:
    buffer_store_dwordx2 v[180:181], v5, s[16:19], s27 offen sc1
L_wo_st_join:
    s_mov_b64 exec, -1
L_wo_done:
    s_lshr_b32 s5, s2, 3
    s_and_b32 s24, s5, 15
    s_cmp_eq_u32 s22, 0
    s_cbranch_scc1 L_f1_compute
    v_and_b32 v3, 31, v1
    v_lshlrev_b32 v3, 2, v3
    s_mul_i32 s27, s24, 384
    s_lshl_b32 s28, s21, 7
    s_add_u32 s27, s27, s28
    s_add_u32 s27, s27, 24215552
    buffer_load_dword v8, v3, s[16:19], s27 offen sc1
    s_add_u32 s27, s27, 6144
    buffer_load_dword v9, v3, s[16:19], s27 offen sc1
    s_add_u32 s27, s27, 6144
    buffer_load_dword v10, v3, s[16:19], s27 offen sc1
    s_add_u32 s27, s27, 6144
    buffer_load_dword v11, v3, s[16:19], s27 offen sc1
    s_add_u32 s27, s27, 6144
    buffer_load_dword v12, v3, s[16:19], s27 offen sc1
    s_add_u32 s27, s27, 6144
    buffer_load_dword v13, v3, s[16:19], s27 offen sc1
    s_add_u32 s27, s27, 6144
    buffer_load_dword v14, v3, s[16:19], s27 offen sc1
    s_add_u32 s27, s27, 6144
    buffer_load_dword v15, v3, s[16:19], s27 offen sc1
    s_add_u32 s27, s27, 6144
    buffer_load_dword v16, v3, s[16:19], s27 offen sc1
    s_add_u32 s27, s27, 6144
    buffer_load_dword v17, v3, s[16:19], s27 offen sc1
    s_waitcnt vmcnt(0)
    v_add_f32 v8, v8, v9
    v_add_f32 v8, v8, v10
    v_add_f32 v8, v8, v11
    v_add_f32 v8, v8, v12
    v_add_f32 v8, v8, v13
    v_add_f32 v8, v8, v14
    v_add_f32 v8, v8, v15
    v_add_f32 v8, v8, v16
    v_add_f32 v8, v8, v17
    s_lshl_b32 s28, s21, 7
    s_add_u32 s28, s28, 161792
    v_add_u32 v3, s28, v3
    ds_write_b32 v3, v8
    s_waitcnt lgkmcnt(0)
    v_mov_b32 v4, 163676
    v_mov_b32 v5, 1
    s_mov_b64 exec, 1
    ds_add_u32 v4, v5
    s_mov_b64 exec, -1
    s_lshr_b32 s4, s2, 3
    s_lshl_b32 s4, s4, 2
    s_add_u32 s4, s4, s21
    s_mul_i32 s4, s4, 1024
    s_add_u32 s4, s4, 22249472
    v_lshlrev_b32 v4, 7, v1
    s_mov_b64 exec, 0xff
    buffer_load_dword v18, v4, s[16:19], s4 offen sc1
    s_mov_b64 exec, -1
    s_add_u32 s4, s4, 131072
    s_sleep 4
    s_mov_b64 exec, 0xff
    buffer_load_dword v18, v4, s[16:19], s4 offen sc1
    s_mov_b64 exec, -1
    s_add_u32 s4, s4, 131072
    s_sleep 4
    s_mov_b64 exec, 0xff
    buffer_load_dword v18, v4, s[16:19], s4 offen sc1
    s_mov_b64 exec, -1
    s_add_u32 s4, s4, 131072
    s_sleep 4
    s_mov_b64 exec, 0xff
    buffer_load_dword v18, v4, s[16:19], s4 offen sc1
    s_mov_b64 exec, -1
    s_add_u32 s4, s4, 131072
    s_sleep 4
    s_mov_b64 exec, 0xff
    buffer_load_dword v18, v4, s[16:19], s4 offen sc1
    s_mov_b64 exec, -1
    s_add_u32 s4, s4, 131072
    s_sleep 4
    s_mov_b64 exec, 0xff
    buffer_load_dword v18, v4, s[16:19], s4 offen sc1
    s_mov_b64 exec, -1
    s_add_u32 s4, s4, 131072
    s_sleep 4
    s_mov_b64 exec, 0xff
    buffer_load_dword v18, v4, s[16:19], s4 offen sc1
    s_mov_b64 exec, -1
    s_add_u32 s4, s4, 131072
    s_sleep 4
    s_mov_b64 exec, 0xff
    buffer_load_dword v18, v4, s[16:19], s4 offen sc1
    s_mov_b64 exec, -1
    s_add_u32 s4, s4, 131072
    s_sleep 4
    s_mov_b64 exec, 0xff
    buffer_load_dword v18, v4, s[16:19], s4 offen sc1
    s_mov_b64 exec, -1
    s_add_u32 s4, s4, 131072
    s_sleep 4
    s_mov_b64 exec, 0xff
    buffer_load_dword v18, v4, s[16:19], s4 offen sc1
    s_mov_b64 exec, -1
    s_add_u32 s4, s4, 131072
    s_sleep 4
    s_mov_b64 exec, 0xff
    buffer_load_dword v18, v4, s[16:19], s4 offen sc1
    s_mov_b64 exec, -1
    s_add_u32 s4, s4, 131072
    s_sleep 4
    s_mov_b64 exec, 0xff
    buffer_load_dword v18, v4, s[16:19], s4 offen sc1
    s_mov_b64 exec, -1
    s_add_u32 s4, s4, 131072
    s_sleep 4
    s_mov_b64 exec, 0xff
    buffer_load_dword v18, v4, s[16:19], s4 offen sc1
    s_mov_b64 exec, -1
    s_add_u32 s4, s4, 131072
    s_sleep 4
    s_mov_b64 exec, 0xff
    buffer_load_dword v18, v4, s[16:19], s4 offen sc1
    s_mov_b64 exec, -1
    s_add_u32 s4, s4, 131072
    s_sleep 4
    s_mov_b64 exec, 0xff
    buffer_load_dword v18, v4, s[16:19], s4 offen sc1
    s_mov_b64 exec, -1
    s_barrier
    s_branch L_f1_done
L_f1_compute:
    s_waitcnt vmcnt(0)
    s_lshl_b32 s36, s91, 7
    s_add_u32 s36, s36, 24442880
    v_mov_b32 v5, 163660
    v_mov_b32 v6, 1
    s_mov_b64 exec, 1
    ds_add_rtn_u32 v6, v5, v6
    s_waitcnt lgkmcnt(0)
    v_readfirstlane_b32 s27, v6
    s_mov_b64 exec, -1
    s_nop 2
    s_cmp_eq_u32 s27, 3
    s_cbranch_scc0 L_f1_noflag
    s_lshl_b32 s36, s91, 7
    s_add_u32 s36, s36, 24442880
    s_lshl_b32 s4, s92, 2
    v_mov_b32 v5, s4
    v_mov_b32 v6, 1
    s_mov_b64 exec, 1
    s_cmp_eq_u32 s90, 0
    s_cbranch_scc1 L_fs_slow2
    buffer_store_dword v6, v5, s[16:19], s36 offen
    s_branch L_fs_done2
L_fs_slow2:
    buffer_store_dword v6, v5, s[16:19], s36 offen sc1
L_fs_done2:
    s_mov_b64 exec, -1
L_f1_noflag:
    v_and_b32 v139, 31, v1
    v_lshrrev_b32 v140, 5, v1
    v_add_u32 v136, 133120, v2
    v_mov_b32 v137, v2
    v_add_u32 v138, 49152, v2
    v_mov_b32 v8, 0
    v_mov_b32 v9, 0
    v_mov_b32 v10, 0
    v_mov_b32 v11, 0
    v_mov_b32 v12, 0
    v_mov_b32 v13, 0
    v_mov_b32 v14, 0
    v_mov_b32 v15, 0
    v_mov_b32 v16, 0
    v_mov_b32 v17, 0
    v_mov_b32 v18, 0
    v_mov_b32 v19, 0
    v_mov_b32 v20, 0
    v_mov_b32 v21, 0
    v_mov_b32 v22, 0
    v_mov_b32 v23, 0
    v_mov_b32 v24, 0
    v_mov_b32 v25, 0
    v_mov_b32 v26, 0
    v_mov_b32 v27, 0
    v_mov_b32 v28, 0
    v_mov_b32 v29, 0
    v_mov_b32 v30, 0
    v_mov_b32 v31, 0
    v_mov_b32 v32, 0
    v_mov_b32 v33, 0
    v_mov_b32 v34, 0
    v_mov_b32 v35, 0
    v_mov_b32 v36, 0
    v_mov_b32 v37, 0
    v_mov_b32 v38, 0
    v_mov_b32 v39, 0
    v_mov_b32 v40, 0
    v_mov_b32 v41, 0
    v_mov_b32 v42, 0
    v_mov_b32 v43, 0
    v_mov_b32 v44, 0
    v_mov_b32 v45, 0
    v_mov_b32 v46, 0
    v_mov_b32 v47, 0
    v_mov_b32 v48, 0
    v_mov_b32 v49, 0
    v_mov_b32 v50, 0
    v_mov_b32 v51, 0
    v_mov_b32 v52, 0
    v_mov_b32 v53, 0
    v_mov_b32 v54, 0
    v_mov_b32 v55, 0
    s_lshl_b32 s27, s91, 7
    s_lshl_b32 s28, s21, 5
    s_add_u32 s27, s27, s28
    v_add_u32 v3, s27, v139
    v_lshlrev_b32 v3, 3, v3
    v_mul_u32_u24 v4, 65536, v140
    v_add_u32 v3, v3, v4
    s_lshl_b32 s26, s91, 2
    s_add_u32 s26, s26, s21
    s_mul_i32 s26, s26, 40960
    s_add_u32 s26, s26, 10551296
    s_cmp_lg_u32 s20, 0
    s_cbranch_scc1 L_f1_nopoll
    v_lshlrev_b32 v5, 2, v1
    s_mov_b32 s29, 0
    s_mov_b64 exec, 0xffff
L_poll_f1:
    buffer_load_dword v6, v5, s[16:19], s36 offen sc1
    s_add_u32 s29, s29, 1
    s_waitcnt vmcnt(0)
    v_cmp_gt_u32 vcc, 1, v6
    s_cmp_gt_u32 s29, 40000
    s_cbranch_scc1 L_pollx_f1
    s_nop 1
    s_cbranch_vccz L_pollx_f1
    s_sleep 1
    s_branch L_poll_f1
L_pollx_f1:
    s_mov_b64 exec, -1
    v_mov_b32 v5, 163676
    v_mov_b32 v6, 16
    s_mov_b64 exec, 1
    ds_add_u32 v5, v6
    s_mov_b64 exec, -1
L_f1_nopoll:
    v_mov_b32 v5, 163676
    s_mov_b32 s28, 0
L_spin_z4:
    ds_read_b32 v6, v5
    s_add_u32 s28, s28, 1
    s_waitcnt lgkmcnt(0)
    v_readfirstlane_b32 s27, v6
    s_cmp_gt_u32 s28, 1600000
    s_cbranch_scc1 L_spinx_z4
    s_nop 1
    s_cmp_ge_u32 s27, 20
    s_cbranch_scc0 L_spin_z4
L_spinx_z4:
    buffer_load_dwordx4 v[92:95], v2, s[16:19], s26 offen offset:0 sc1
    buffer_load_dwordx4 v[96:99], v2, s[16:19], s26 offen offset:1024 sc1
    buffer_load_dwordx4 v[100:103], v2, s[16:19], s26 offen offset:2048 sc1
    buffer_load_dwordx4 v[104:107], v2, s[16:19], s26 offen offset:3072 sc1
    s_mov_b32 s27, 24276992
    buffer_load_dwordx2 v[142:143], v3, s[16:19], s27 offen sc1
    s_mov_b32 s27, 24293376
    buffer_load_dwordx2 v[144:145], v3, s[16:19], s27 offen sc1
    s_mov_b32 s27, 24309760
    buffer_load_dwordx2 v[146:147], v3, s[16:19], s27 offen sc1
    s_mov_b32 s27, 24326144
    buffer_load_dwordx2 v[148:149], v3, s[16:19], s27 offen sc1
    s_add_u32 s93, s26, 4096
    buffer_load_dwordx4 v[108:111], v2, s[16:19], s93 offen offset:0 sc1
    buffer_load_dwordx4 v[112:115], v2, s[16:19], s93 offen offset:1024 sc1
    buffer_load_dwordx4 v[116:119], v2, s[16:19], s93 offen offset:2048 sc1
    buffer_load_dwordx4 v[120:123], v2, s[16:19], s93 offen offset:3072 sc1
    s_add_u32 s93, s26, 8192
    buffer_load_dwordx4 v[124:127], v2, s[16:19], s93 offen offset:0 sc1
    buffer_load_dwordx4 v[128:131], v2, s[16:19], s93 offen offset:1024 sc1
    ds_read_b128 v[56:59], v136 offset:0
    ds_read_b128 v[60:63], v136 offset:1024
    ds_read_b128 v[64:67], v136 offset:2048
    ds_read_b128 v[68:71], v136 offset:3072
    ds_read_b128 v[72:75], v136 offset:4096
    ds_read_b128 v[76:79], v136 offset:5120
    v_lshlrev_b32 v4, 4, v140
    v_add_u32 v4, 161792, v4
    s_waitcnt vmcnt(13) lgkmcnt(3)
    v_mfma_f32_32x32x16_bf16 v[8:23], v[56:59], v[92:95], v[8:23]
    ds_read_b128 v[80:83], v136 offset:6144
    ds_read_b128 v[84:87], v136 offset:7168
    v_mfma_f32_32x32x16_bf16 v[24:39], v[60:63], v[92:95], v[24:39]
    ds_read_b128 v[88:91], v136 offset:8192
    buffer_load_dwordx4 v[132:135], v2, s[16:19], s93 offen offset:2048 sc1
    v_mfma_f32_32x32x16_bf16 v[40:55], v[64:67], v[92:95], v[40:55]
    s_waitcnt vmcnt(13) lgkmcnt(3)
    v_mfma_f32_32x32x16_bf16 v[8:23], v[68:71], v[96:99], v[8:23]
    ds_read_b128 v[56:59], v136 offset:9216
    ds_read_b128 v[60:63], v136 offset:10240
    v_mfma_f32_32x32x16_bf16 v[24:39], v[72:75], v[96:99], v[24:39]
    ds_read_b128 v[64:67], v136 offset:11264
    buffer_load_dwordx4 v[92:95], v2, s[16:19], s93 offen offset:3072 sc1
    v_mfma_f32_32x32x16_bf16 v[40:55], v[76:79], v[96:99], v[40:55]
    s_waitcnt vmcnt(13) lgkmcnt(3)
    v_mfma_f32_32x32x16_bf16 v[8:23], v[80:83], v[100:103], v[8:23]
    ds_read_b128 v[68:71], v136 offset:12288
    ds_read_b128 v[72:75], v136 offset:13312
    v_mfma_f32_32x32x16_bf16 v[24:39], v[84:87], v[100:103], v[24:39]
    ds_read_b128 v[76:79], v136 offset:14336
    s_add_u32 s93, s26, 12288
    buffer_load_dwordx4 v[96:99], v2, s[16:19], s93 offen offset:0 sc1
    v_mfma_f32_32x32x16_bf16 v[40:55], v[88:91], v[100:103], v[40:55]
    s_waitcnt vmcnt(13) lgkmcnt(3)
    v_mfma_f32_32x32x16_bf16 v[8:23], v[56:59], v[104:107], v[8:23]
    ds_read_b128 v[80:83], v136 offset:15360
    ds_read_b128 v[84:87], v136 offset:16384
    v_mfma_f32_32x32x16_bf16 v[24:39], v[60:63], v[104:107], v[24:39]
    ds_read_b128 v[88:91], v136 offset:17408
    buffer_load_dwordx4 v[100:103], v2, s[16:19], s93 offen offset:1024 sc1
    v_mfma_f32_32x32x16_bf16 v[40:55], v[64:67], v[104:107], v[40:55]
    s_waitcnt vmcnt(9) lgkmcnt(3)
    v_mfma_f32_32x32x16_bf16 v[8:23], v[68:71], v[108:111], v[8:23]
    ds_read_b128 v[56:59], v136 offset:18432
    ds_read_b128 v[60:63], v136 offset:19456
    v_mfma_f32_32x32x16_bf16 v[24:39], v[72:75], v[108:111], v[24:39]
    ds_read_b128 v[64:67], v136 offset:20480
    buffer_load_dwordx4 v[104:107], v2, s[16:19], s93 offen offset:2048 sc1
    v_mfma_f32_32x32x16_bf16 v[40:55], v[76:79], v[108:111], v[40:55]
    s_waitcnt vmcnt(9) lgkmcnt(3)
    v_mfma_f32_32x32x16_bf16 v[8:23], v[80:83], v[112:115], v[8:23]
    ds_read_b128 v[68:71], v136 offset:21504
    ds_read_b128 v[72:75], v136 offset:22528
    v_mfma_f32_32x32x16_bf16 v[24:39], v[84:87], v[112:115], v[24:39]
    ds_read_b128 v[76:79], v136 offset:23552
    buffer_load_dwordx4 v[108:111], v2, s[16:19], s93 offen offset:3072 sc1
    v_mfma_f32_32x32x16_bf16 v[40:55], v[88:91], v[112:115], v[40:55]
    s_waitcnt vmcnt(9) lgkmcnt(3)
    v_mfma_f32_32x32x16_bf16 v[8:23], v[56:59], v[116:119], v[8:23]
    ds_read_b128 v[80:83], v136 offset:24576
    ds_read_b128 v[84:87], v136 offset:25600
    v_mfma_f32_32x32x16_bf16 v[24:39], v[60:63], v[116:119], v[24:39]
    ds_read_b128 v[88:91], v136 offset:26624
    s_add_u32 s93, s26, 16384
    buffer_load_dwordx4 v[112:115], v2, s[16:19], s93 offen offset:0 sc1
    v_mfma_f32_32x32x16_bf16 v[40:55], v[64:67], v[116:119], v[40:55]
    s_waitcnt vmcnt(9) lgkmcnt(3)
    v_mfma_f32_32x32x16_bf16 v[8:23], v[68:71], v[120:123], v[8:23]
    ds_read_b128 v[56:59], v137 offset:0
    ds_read_b128 v[60:63], v137 offset:1024
    v_mfma_f32_32x32x16_bf16 v[24:39], v[72:75], v[120:123], v[24:39]
    ds_read_b128 v[64:67], v137 offset:2048
    buffer_load_dwordx4 v[116:119], v2, s[16:19], s93 offen offset:1024 sc1
    v_mfma_f32_32x32x16_bf16 v[40:55], v[76:79], v[120:123], v[40:55]
    s_waitcnt vmcnt(9) lgkmcnt(3)
    v_mfma_f32_32x32x16_bf16 v[8:23], v[80:83], v[124:127], v[8:23]
    ds_read_b128 v[68:71], v137 offset:3072
    ds_read_b128 v[72:75], v137 offset:4096
    v_mfma_f32_32x32x16_bf16 v[24:39], v[84:87], v[124:127], v[24:39]
    ds_read_b128 v[76:79], v137 offset:5120
    buffer_load_dwordx4 v[120:123], v2, s[16:19], s93 offen offset:2048 sc1
    v_add_f32 v142, v142, v144
    v_add_f32 v143, v143, v145
    v_add_f32 v142, v142, v146
    v_mfma_f32_32x32x16_bf16 v[40:55], v[88:91], v[124:127], v[40:55]
    s_waitcnt vmcnt(9) lgkmcnt(3)
    v_mfma_f32_32x32x16_bf16 v[8:23], v[56:59], v[128:131], v[8:23]
    ds_read_b128 v[80:83], v137 offset:6144
    ds_read_b128 v[84:87], v137 offset:7168
    v_mfma_f32_32x32x16_bf16 v[24:39], v[60:63], v[128:131], v[24:39]
    ds_read_b128 v[88:91], v137 offset:8192
    buffer_load_dwordx4 v[124:127], v2, s[16:19], s93 offen offset:3072 sc1
    v_add_f32 v143, v143, v147
    v_add_f32 v142, v142, v148
    v_add_f32 v143, v143, v149
    v_mfma_f32_32x32x16_bf16 v[40:55], v[64:67], v[128:131], v[40:55]
    s_waitcnt vmcnt(9) lgkmcnt(3)
    v_mfma_f32_32x32x16_bf16 v[8:23], v[68:71], v[132:135], v[8:23]
    ds_read_b128 v[56:59], v137 offset:9216
    ds_read_b128 v[60:63], v137 offset:10240
    v_mfma_f32_32x32x16_bf16 v[24:39], v[72:75], v[132:135], v[24:39]
    ds_read_b128 v[64:67], v137 offset:11264
    s_add_u32 s93, s26, 20480
    buffer_load_dwordx4 v[128:131], v2, s[16:19], s93 offen offset:0 sc1
    v_mov_b32 v5, v142
    s_nop 1
    v_permlane32_swap_b32 v142, v5
    v_mfma_f32_32x32x16_bf16 v[40:55], v[76:79], v[132:135], v[40:55]
    s_waitcnt vmcnt(9) lgkmcnt(3)
    v_mfma_f32_32x32x16_bf16 v[8:23], v[80:83], v[92:95], v[8:23]
    ds_read_b128 v[68:71], v137 offset:12288
    ds_read_b128 v[72:75], v137 offset:13312
    v_mfma_f32_32x32x16_bf16 v[24:39], v[84:87], v[92:95], v[24:39]
    ds_read_b128 v[76:79], v137 offset:14336
    buffer_load_dwordx4 v[132:135], v2, s[16:19], s93 offen offset:1024 sc1
    v_add_f32 v142, v142, v5
    v_mov_b32 v5, v143
    s_nop 1
    v_mfma_f32_32x32x16_bf16 v[40:55], v[88:91], v[92:95], v[40:55]
    s_waitcnt vmcnt(9) lgkmcnt(3)
    v_mfma_f32_32x32x16_bf16 v[8:23], v[56:59], v[96:99], v[8:23]
    ds_read_b128 v[80:83], v137 offset:15360
    ds_read_b128 v[84:87], v137 offset:16384
    v_mfma_f32_32x32x16_bf16 v[24:39], v[60:63], v[96:99], v[24:39]
    ds_read_b128 v[88:91], v137 offset:17408
    buffer_load_dwordx4 v[92:95], v2, s[16:19], s93 offen offset:2048 sc1
    v_permlane32_swap_b32 v143, v5
    v_add_f32 v143, v143, v5
    v_mul_f32 v142, 0x3acccccd, v142
    v_mfma_f32_32x32x16_bf16 v[40:55], v[64:67], v[96:99], v[40:55]
    s_waitcnt vmcnt(9) lgkmcnt(3)
    v_mfma_f32_32x32x16_bf16 v[8:23], v[68:71], v[100:103], v[8:23]
    ds_read_b128 v[56:59], v137 offset:18432
    ds_read_b128 v[60:63], v137 offset:19456
    v_mfma_f32_32x32x16_bf16 v[24:39], v[72:75], v[100:103], v[24:39]
    ds_read_b128 v[64:67], v137 offset:20480
    buffer_load_dwordx4 v[96:99], v2, s[16:19], s93 offen offset:3072 sc1
    v_mul_f32 v143, 0x3acccccd, v143
    v_fma_f32 v143, -v142, v142, v143
    v_max_f32 v143, 0, v143
    v_mfma_f32_32x32x16_bf16 v[40:55], v[76:79], v[100:103], v[40:55]
    s_waitcnt vmcnt(9) lgkmcnt(3)
    v_mfma_f32_32x32x16_bf16 v[8:23], v[80:83], v[104:107], v[8:23]
    ds_read_b128 v[68:71], v137 offset:21504
    ds_read_b128 v[72:75], v137 offset:22528
    v_mfma_f32_32x32x16_bf16 v[24:39], v[84:87], v[104:107], v[24:39]
    ds_read_b128 v[76:79], v137 offset:23552
    s_add_u32 s93, s26, 24576
    buffer_load_dwordx4 v[100:103], v2, s[16:19], s93 offen offset:0 sc1
    v_add_f32 v143, 0x3727c5ac, v143
    v_rsq_f32 v150, v143
    s_nop 0
    v_mfma_f32_32x32x16_bf16 v[40:55], v[88:91], v[104:107], v[40:55]
    s_waitcnt vmcnt(9) lgkmcnt(3)
    v_mfma_f32_32x32x16_bf16 v[8:23], v[56:59], v[108:111], v[8:23]
    ds_read_b128 v[80:83], v137 offset:24576
    ds_read_b128 v[84:87], v137 offset:25600
    v_mfma_f32_32x32x16_bf16 v[24:39], v[60:63], v[108:111], v[24:39]
    ds_read_b128 v[88:91], v137 offset:26624
    buffer_load_dwordx4 v[104:107], v2, s[16:19], s93 offen offset:1024 sc1
    v_mul_f32 v151, v142, v150
    v_mfma_f32_32x32x16_bf16 v[40:55], v[64:67], v[108:111], v[40:55]
    s_waitcnt vmcnt(9) lgkmcnt(3)
    v_mfma_f32_32x32x16_bf16 v[8:23], v[68:71], v[112:115], v[8:23]
    ds_read_b128 v[56:59], v137 offset:27648
    ds_read_b128 v[60:63], v137 offset:28672
    v_mfma_f32_32x32x16_bf16 v[24:39], v[72:75], v[112:115], v[24:39]
    ds_read_b128 v[64:67], v137 offset:29696
    buffer_load_dwordx4 v[108:111], v2, s[16:19], s93 offen offset:2048 sc1
    v_mfma_f32_32x32x16_bf16 v[40:55], v[76:79], v[112:115], v[40:55]
    s_waitcnt vmcnt(9) lgkmcnt(3)
    v_mfma_f32_32x32x16_bf16 v[8:23], v[80:83], v[116:119], v[8:23]
    ds_read_b128 v[68:71], v137 offset:30720
    ds_read_b128 v[72:75], v137 offset:31744
    v_mfma_f32_32x32x16_bf16 v[24:39], v[84:87], v[116:119], v[24:39]
    ds_read_b128 v[76:79], v137 offset:32768
    buffer_load_dwordx4 v[112:115], v2, s[16:19], s93 offen offset:3072 sc1
    v_mfma_f32_32x32x16_bf16 v[40:55], v[88:91], v[116:119], v[40:55]
    s_waitcnt vmcnt(9) lgkmcnt(3)
    v_mfma_f32_32x32x16_bf16 v[8:23], v[56:59], v[120:123], v[8:23]
    ds_read_b128 v[80:83], v137 offset:33792
    ds_read_b128 v[84:87], v137 offset:34816
    v_mfma_f32_32x32x16_bf16 v[24:39], v[60:63], v[120:123], v[24:39]
    ds_read_b128 v[88:91], v137 offset:35840
    s_add_u32 s93, s26, 28672
    buffer_load_dwordx4 v[116:119], v2, s[16:19], s93 offen offset:0 sc1
    v_mfma_f32_32x32x16_bf16 v[40:55], v[64:67], v[120:123], v[40:55]
    s_waitcnt vmcnt(9) lgkmcnt(3)
    v_mfma_f32_32x32x16_bf16 v[8:23], v[68:71], v[124:127], v[8:23]
    ds_read_b128 v[56:59], v137 offset:36864
    ds_read_b128 v[60:63], v137 offset:37888
    v_mfma_f32_32x32x16_bf16 v[24:39], v[72:75], v[124:127], v[24:39]
    ds_read_b128 v[64:67], v137 offset:38912
    buffer_load_dwordx4 v[120:123], v2, s[16:19], s93 offen offset:1024 sc1
    v_mfma_f32_32x32x16_bf16 v[40:55], v[76:79], v[124:127], v[40:55]
    s_waitcnt vmcnt(9) lgkmcnt(3)
    v_mfma_f32_32x32x16_bf16 v[8:23], v[80:83], v[128:131], v[8:23]
    ds_read_b128 v[68:71], v137 offset:39936
    ds_read_b128 v[72:75], v137 offset:40960
    v_mfma_f32_32x32x16_bf16 v[24:39], v[84:87], v[128:131], v[24:39]
    ds_read_b128 v[76:79], v137 offset:41984
    buffer_load_dwordx4 v[124:127], v2, s[16:19], s93 offen offset:2048 sc1
    v_mfma_f32_32x32x16_bf16 v[40:55], v[88:91], v[128:131], v[40:55]
    s_waitcnt vmcnt(9) lgkmcnt(3)
    v_mfma_f32_32x32x16_bf16 v[8:23], v[56:59], v[132:135], v[8:23]
    ds_read_b128 v[80:83], v137 offset:43008
    ds_read_b128 v[84:87], v137 offset:44032
    v_mfma_f32_32x32x16_bf16 v[24:39], v[60:63], v[132:135], v[24:39]
    ds_read_b128 v[88:91], v137 offset:45056
    buffer_load_dwordx4 v[128:131], v2, s[16:19], s93 offen offset:3072 sc1
    v_mfma_f32_32x32x16_bf16 v[40:55], v[64:67], v[132:135], v[40:55]
    s_waitcnt vmcnt(9) lgkmcnt(3)
    v_mfma_f32_32x32x16_bf16 v[8:23], v[68:71], v[92:95], v[8:23]
    ds_read_b128 v[56:59], v137 offset:46080
    ds_read_b128 v[60:63], v137 offset:47104
    v_mfma_f32_32x32x16_bf16 v[24:39], v[72:75], v[92:95], v[24:39]
    ds_read_b128 v[64:67], v137 offset:48128
    s_add_u32 s93, s26, 32768
    buffer_load_dwordx4 v[132:135], v2, s[16:19], s93 offen offset:0 sc1
    v_mfma_f32_32x32x16_bf16 v[40:55], v[76:79], v[92:95], v[40:55]
    s_waitcnt vmcnt(9) lgkmcnt(3)
    v_mfma_f32_32x32x16_bf16 v[8:23], v[80:83], v[96:99], v[8:23]
    ds_read_b128 v[68:71], v138 offset:0
    ds_read_b128 v[72:75], v138 offset:1024
    v_mfma_f32_32x32x16_bf16 v[24:39], v[84:87], v[96:99], v[24:39]
    ds_read_b128 v[76:79], v138 offset:2048
    buffer_load_dwordx4 v[92:95], v2, s[16:19], s93 offen offset:1024 sc1
    v_mfma_f32_32x32x16_bf16 v[40:55], v[88:91], v[96:99], v[40:55]
    s_waitcnt vmcnt(9) lgkmcnt(3)
    v_mfma_f32_32x32x16_bf16 v[8:23], v[56:59], v[100:103], v[8:23]
    ds_read_b128 v[80:83], v138 offset:3072
    ds_read_b128 v[84:87], v138 offset:4096
    v_mfma_f32_32x32x16_bf16 v[24:39], v[60:63], v[100:103], v[24:39]
    ds_read_b128 v[88:91], v138 offset:5120
    buffer_load_dwordx4 v[96:99], v2, s[16:19], s93 offen offset:2048 sc1
    v_mfma_f32_32x32x16_bf16 v[40:55], v[64:67], v[100:103], v[40:55]
    s_waitcnt vmcnt(9) lgkmcnt(3)
    v_mfma_f32_32x32x16_bf16 v[8:23], v[68:71], v[104:107], v[8:23]
    ds_read_b128 v[56:59], v138 offset:6144
    ds_read_b128 v[60:63], v138 offset:7168
    v_mfma_f32_32x32x16_bf16 v[24:39], v[72:75], v[104:107], v[24:39]
    ds_read_b128 v[64:67], v138 offset:8192
    buffer_load_dwordx4 v[100:103], v2, s[16:19], s93 offen offset:3072 sc1
    v_mfma_f32_32x32x16_bf16 v[40:55], v[76:79], v[104:107], v[40:55]
    s_waitcnt vmcnt(9) lgkmcnt(3)
    v_mfma_f32_32x32x16_bf16 v[8:23], v[80:83], v[108:111], v[8:23]
    ds_read_b128 v[68:71], v138 offset:9216
    ds_read_b128 v[72:75], v138 offset:10240
    v_mfma_f32_32x32x16_bf16 v[24:39], v[84:87], v[108:111], v[24:39]
    ds_read_b128 v[76:79], v138 offset:11264
    s_add_u32 s93, s26, 36864
    buffer_load_dwordx4 v[104:107], v2, s[16:19], s93 offen offset:0 sc1
    v_mfma_f32_32x32x16_bf16 v[40:55], v[88:91], v[108:111], v[40:55]
    s_waitcnt vmcnt(9) lgkmcnt(3)
    v_mfma_f32_32x32x16_bf16 v[8:23], v[56:59], v[112:115], v[8:23]
    ds_read_b128 v[80:83], v138 offset:12288
    ds_read_b128 v[84:87], v138 offset:13312
    v_mfma_f32_32x32x16_bf16 v[24:39], v[60:63], v[112:115], v[24:39]
    ds_read_b128 v[88:91], v138 offset:14336
    buffer_load_dwordx4 v[108:111], v2, s[16:19], s93 offen offset:1024 sc1
    v_mfma_f32_32x32x16_bf16 v[40:55], v[64:67], v[112:115], v[40:55]
    s_waitcnt vmcnt(9) lgkmcnt(3)
    v_mfma_f32_32x32x16_bf16 v[8:23], v[68:71], v[116:119], v[8:23]
    ds_read_b128 v[56:59], v138 offset:15360
    ds_read_b128 v[60:63], v138 offset:16384
    v_mfma_f32_32x32x16_bf16 v[24:39], v[72:75], v[116:119], v[24:39]
    ds_read_b128 v[64:67], v138 offset:17408
    buffer_load_dwordx4 v[112:115], v2, s[16:19], s93 offen offset:2048 sc1
    v_mfma_f32_32x32x16_bf16 v[40:55], v[76:79], v[116:119], v[40:55]
    s_waitcnt vmcnt(9) lgkmcnt(3)
    v_mfma_f32_32x32x16_bf16 v[8:23], v[80:83], v[120:123], v[8:23]
    ds_read_b128 v[68:71], v138 offset:18432
    ds_read_b128 v[72:75], v138 offset:19456
    v_mfma_f32_32x32x16_bf16 v[24:39], v[84:87], v[120:123], v[24:39]
    ds_read_b128 v[76:79], v138 offset:20480
    buffer_load_dwordx4 v[116:119], v2, s[16:19], s93 offen offset:3072 sc1
    v_mfma_f32_32x32x16_bf16 v[40:55], v[88:91], v[120:123], v[40:55]
    s_waitcnt vmcnt(9) lgkmcnt(3)
    v_mfma_f32_32x32x16_bf16 v[8:23], v[56:59], v[124:127], v[8:23]
    ds_read_b128 v[80:83], v138 offset:21504
    ds_read_b128 v[84:87], v138 offset:22528
    v_mfma_f32_32x32x16_bf16 v[24:39], v[60:63], v[124:127], v[24:39]
    ds_read_b128 v[88:91], v138 offset:23552
    v_mfma_f32_32x32x16_bf16 v[40:55], v[64:67], v[124:127], v[40:55]
    s_waitcnt vmcnt(8) lgkmcnt(3)
    v_mfma_f32_32x32x16_bf16 v[8:23], v[68:71], v[128:131], v[8:23]
    ds_read_b128 v[56:59], v138 offset:24576
    ds_read_b128 v[60:63], v138 offset:25600
    v_mfma_f32_32x32x16_bf16 v[24:39], v[72:75], v[128:131], v[24:39]
    ds_read_b128 v[64:67], v138 offset:26624
    v_mfma_f32_32x32x16_bf16 v[40:55], v[76:79], v[128:131], v[40:55]
    s_waitcnt vmcnt(7) lgkmcnt(3)
    v_mfma_f32_32x32x16_bf16 v[8:23], v[80:83], v[132:135], v[8:23]
    ds_read_b128 v[68:71], v138 offset:27648
    ds_read_b128 v[72:75], v138 offset:28672
    v_mfma_f32_32x32x16_bf16 v[24:39], v[84:87], v[132:135], v[24:39]
    ds_read_b128 v[76:79], v138 offset:29696
    v_mfma_f32_32x32x16_bf16 v[40:55], v[88:91], v[132:135], v[40:55]
    s_waitcnt vmcnt(6) lgkmcnt(3)
    v_mfma_f32_32x32x16_bf16 v[8:23], v[56:59], v[92:95], v[8:23]
    ds_read_b128 v[80:83], v138 offset:30720
    ds_read_b128 v[84:87], v138 offset:31744
    v_mfma_f32_32x32x16_bf16 v[24:39], v[60:63], v[92:95], v[24:39]
    ds_read_b128 v[88:91], v138 offset:32768
    v_mfma_f32_32x32x16_bf16 v[40:55], v[64:67], v[92:95], v[40:55]
    s_waitcnt vmcnt(5) lgkmcnt(3)
    v_mfma_f32_32x32x16_bf16 v[8:23], v[68:71], v[96:99], v[8:23]
    ds_read_b128 v[56:59], v138 offset:33792
    ds_read_b128 v[60:63], v138 offset:34816
    v_mfma_f32_32x32x16_bf16 v[24:39], v[72:75], v[96:99], v[24:39]
    ds_read_b128 v[64:67], v138 offset:35840
    v_mfma_f32_32x32x16_bf16 v[40:55], v[76:79], v[96:99], v[40:55]
    s_waitcnt vmcnt(4) lgkmcnt(3)
    v_mfma_f32_32x32x16_bf16 v[8:23], v[80:83], v[100:103], v[8:23]
    ds_read_b128 v[68:71], v138 offset:36864
    ds_read_b128 v[72:75], v138 offset:37888
    v_mfma_f32_32x32x16_bf16 v[24:39], v[84:87], v[100:103], v[24:39]
    ds_read_b128 v[76:79], v138 offset:38912
    v_mfma_f32_32x32x16_bf16 v[40:55], v[88:91], v[100:103], v[40:55]
    s_waitcnt vmcnt(3) lgkmcnt(3)
    v_mfma_f32_32x32x16_bf16 v[8:23], v[56:59], v[104:107], v[8:23]
    ds_read_b128 v[80:83], v138 offset:39936
    ds_read_b128 v[84:87], v138 offset:40960
    v_mfma_f32_32x32x16_bf16 v[24:39], v[60:63], v[104:107], v[24:39]
    ds_read_b128 v[88:91], v138 offset:41984
    v_mfma_f32_32x32x16_bf16 v[40:55], v[64:67], v[104:107], v[40:55]
    s_waitcnt vmcnt(2) lgkmcnt(3)
    v_mfma_f32_32x32x16_bf16 v[8:23], v[68:71], v[108:111], v[8:23]
    ds_read_b128 v[56:59], v138 offset:43008
    ds_read_b128 v[60:63], v138 offset:44032
    v_mfma_f32_32x32x16_bf16 v[24:39], v[72:75], v[108:111], v[24:39]
    ds_read_b128 v[64:67], v138 offset:45056
    v_mfma_f32_32x32x16_bf16 v[40:55], v[76:79], v[108:111], v[40:55]
    s_waitcnt vmcnt(1) lgkmcnt(3)
    v_mfma_f32_32x32x16_bf16 v[8:23], v[80:83], v[112:115], v[8:23]
    v_mfma_f32_32x32x16_bf16 v[24:39], v[84:87], v[112:115], v[24:39]
    v_mfma_f32_32x32x16_bf16 v[40:55], v[88:91], v[112:115], v[40:55]
    s_waitcnt vmcnt(0) lgkmcnt(0)
    v_mfma_f32_32x32x16_bf16 v[8:23], v[56:59], v[116:119], v[8:23]
    v_mfma_f32_32x32x16_bf16 v[24:39], v[60:63], v[116:119], v[24:39]
    v_mfma_f32_32x32x16_bf16 v[40:55], v[64:67], v[116:119], v[40:55]
    ds_read_b128 v[152:155], v4 offset:0
    ds_read_b128 v[156:159], v4 offset:32
    ds_read_b128 v[160:163], v4 offset:64
    ds_read_b128 v[164:167], v4 offset:96
    ds_read_b128 v[168:171], v4 offset:128
    ds_read_b128 v[172:175], v4 offset:160
    ds_read_b128 v[176:179], v4 offset:192
    ds_read_b128 v[180:183], v4 offset:224
    ds_read_b128 v[184:187], v4 offset:256
    ds_read_b128 v[188:191], v4 offset:288
    ds_read_b128 v[192:195], v4 offset:320
    ds_read_b128 v[196:199], v4 offset:352
    s_waitcnt lgkmcnt(0)
    s_barrier
    s_lshl_b32 s27, s91, 2
    s_add_u32 s27, s27, s21
    s_mul_i32 s27, s27, 98304
    s_mul_i32 s28, s24, 6144
    s_add_u32 s27, s27, s28
    s_add_u32 s27, s27, 13172736
    s_mov_b32 s29, 0xbfb8aa3b
    s_cmp_eq_u32 s90, 0
    s_cbranch_scc1 L_f1_epi_slow
    v_pk_mul_f32 v[208:209], v[152:153], v[150:151] op_sel:[0,1] op_sel_hi:[1,1]
    v_pk_mul_f32 v[210:211], v[154:155], v[150:151] op_sel:[0,1] op_sel_hi:[1,1]
    v_pk_mul_f32 v[212:213], v[156:157], v[150:151] op_sel:[0,1] op_sel_hi:[1,1]
    v_pk_mul_f32 v[214:215], v[158:159], v[150:151] op_sel:[0,1] op_sel_hi:[1,1]
    v_pk_fma_f32 v[8:9], v[8:9], v[150:151], v[208:209] op_sel_hi:[1,0,1] neg_lo:[0,0,1] neg_hi:[0,0,1]
    v_pk_fma_f32 v[10:11], v[10:11], v[150:151], v[210:211] op_sel_hi:[1,0,1] neg_lo:[0,0,1] neg_hi:[0,0,1]
    v_pk_fma_f32 v[12:13], v[12:13], v[150:151], v[212:213] op_sel_hi:[1,0,1] neg_lo:[0,0,1] neg_hi:[0,0,1]
    v_pk_fma_f32 v[14:15], v[14:15], v[150:151], v[214:215] op_sel_hi:[1,0,1] neg_lo:[0,0,1] neg_hi:[0,0,1]
    v_mul_f32 v208, s29, v8
    v_mul_f32 v209, s29, v9
    v_mul_f32 v210, s29, v10
    v_mul_f32 v211, s29, v11
    v_mul_f32 v212, s29, v12
    v_mul_f32 v213, s29, v13
    v_mul_f32 v214, s29, v14
    v_mul_f32 v215, s29, v15
    v_exp_f32 v208, v208
    v_exp_f32 v209, v209
    v_exp_f32 v210, v210
    v_exp_f32 v211, v211
    v_exp_f32 v212, v212
    v_exp_f32 v213, v213
    v_exp_f32 v214, v214
    v_exp_f32 v215, v215
    v_pk_add_f32 v[208:209], v[208:209], 1.0 op_sel_hi:[1,0]
    v_pk_add_f32 v[210:211], v[210:211], 1.0 op_sel_hi:[1,0]
    v_pk_add_f32 v[212:213], v[212:213], 1.0 op_sel_hi:[1,0]
    v_pk_add_f32 v[214:215], v[214:215], 1.0 op_sel_hi:[1,0]
    v_rcp_f32 v208, v208
    v_rcp_f32 v209, v209
    v_rcp_f32 v210, v210
    v_rcp_f32 v211, v211
    v_rcp_f32 v212, v212
    v_rcp_f32 v213, v213
    v_rcp_f32 v214, v214
    v_rcp_f32 v215, v215
    v_pk_mul_f32 v[8:9], v[8:9], v[208:209]
    v_pk_mul_f32 v[10:11], v[10:11], v[210:211]
    v_pk_mul_f32 v[12:13], v[12:13], v[212:213]
    v_pk_mul_f32 v[14:15], v[14:15], v[214:215]
    v_cvt_pk_bf16_f32 v200, v8, v9
    v_cvt_pk_bf16_f32 v201, v10, v11
    v_cvt_pk_bf16_f32 v202, v12, v13
    v_cvt_pk_bf16_f32 v203, v14, v15
    buffer_store_dwordx4 v[200:203], v2, s[16:19], s27 offen offset:0
    v_pk_mul_f32 v[208:209], v[160:161], v[150:151] op_sel:[0,1] op_sel_hi:[1,1]
    v_pk_mul_f32 v[210:211], v[162:163], v[150:151] op_sel:[0,1] op_sel_hi:[1,1]
    v_pk_mul_f32 v[212:213], v[164:165], v[150:151] op_sel:[0,1] op_sel_hi:[1,1]
    v_pk_mul_f32 v[214:215], v[166:167], v[150:151] op_sel:[0,1] op_sel_hi:[1,1]
    v_pk_fma_f32 v[16:17], v[16:17], v[150:151], v[208:209] op_sel_hi:[1,0,1] neg_lo:[0,0,1] neg_hi:[0,0,1]
    v_pk_fma_f32 v[18:19], v[18:19], v[150:151], v[210:211] op_sel_hi:[1,0,1] neg_lo:[0,0,1] neg_hi:[0,0,1]
    v_pk_fma_f32 v[20:21], v[20:21], v[150:151], v[212:213] op_sel_hi:[1,0,1] neg_lo:[0,0,1] neg_hi:[0,0,1]
    v_pk_fma_f32 v[22:23], v[22:23], v[150:151], v[214:215] op_sel_hi:[1,0,1] neg_lo:[0,0,1] neg_hi:[0,0,1]
    v_mul_f32 v208, s29, v16
    v_mul_f32 v209, s29, v17
    v_mul_f32 v210, s29, v18
    v_mul_f32 v211, s29, v19
    v_mul_f32 v212, s29, v20
    v_mul_f32 v213, s29, v21
    v_mul_f32 v214, s29, v22
    v_mul_f32 v215, s29, v23
    v_exp_f32 v208, v208
    v_exp_f32 v209, v209
    v_exp_f32 v210, v210
    v_exp_f32 v211, v211
    v_exp_f32 v212, v212
    v_exp_f32 v213, v213
    v_exp_f32 v214, v214
    v_exp_f32 v215, v215
    v_pk_add_f32 v[208:209], v[208:209], 1.0 op_sel_hi:[1,0]
    v_pk_add_f32 v[210:211], v[210:211], 1.0 op_sel_hi:[1,0]
    v_pk_add_f32 v[212:213], v[212:213], 1.0 op_sel_hi:[1,0]
    v_pk_add_f32 v[214:215], v[214:215], 1.0 op_sel_hi:[1,0]
    v_rcp_f32 v208, v208
    v_rcp_f32 v209, v209
    v_rcp_f32 v210, v210
    v_rcp_f32 v211, v211
    v_rcp_f32 v212, v212
    v_rcp_f32 v213, v213
    v_rcp_f32 v214, v214
    v_rcp_f32 v215, v215
    v_pk_mul_f32 v[16:17], v[16:17], v[208:209]
    v_pk_mul_f32 v[18:19], v[18:19], v[210:211]
    v_pk_mul_f32 v[20:21], v[20:21], v[212:213]
    v_pk_mul_f32 v[22:23], v[22:23], v[214:215]
    v_cvt_pk_bf16_f32 v204, v16, v17
    v_cvt_pk_bf16_f32 v205, v18, v19
    v_cvt_pk_bf16_f32 v206, v20, v21
    v_cvt_pk_bf16_f32 v207, v22, v23
    buffer_store_dwordx4 v[204:207], v2, s[16:19], s27 offen offset:1024
    v_pk_mul_f32 v[208:209], v[168:169], v[150:151] op_sel:[0,1] op_sel_hi:[1,1]
    v_pk_mul_f32 v[210:211], v[170:171], v[150:151] op_sel:[0,1] op_sel_hi:[1,1]
    v_pk_mul_f32 v[212:213], v[172:173], v[150:151] op_sel:[0,1] op_sel_hi:[1,1]
    v_pk_mul_f32 v[214:215], v[174:175], v[150:151] op_sel:[0,1] op_sel_hi:[1,1]
    v_pk_fma_f32 v[24:25], v[24:25], v[150:151], v[208:209] op_sel_hi:[1,0,1] neg_lo:[0,0,1] neg_hi:[0,0,1]
    v_pk_fma_f32 v[26:27], v[26:27], v[150:151], v[210:211] op_sel_hi:[1,0,1] neg_lo:[0,0,1] neg_hi:[0,0,1]
    v_pk_fma_f32 v[28:29], v[28:29], v[150:151], v[212:213] op_sel_hi:[1,0,1] neg_lo:[0,0,1] neg_hi:[0,0,1]
    v_pk_fma_f32 v[30:31], v[30:31], v[150:151], v[214:215] op_sel_hi:[1,0,1] neg_lo:[0,0,1] neg_hi:[0,0,1]
    v_mul_f32 v208, s29, v24
    v_mul_f32 v209, s29, v25
    v_mul_f32 v210, s29, v26
    v_mul_f32 v211, s29, v27
    v_mul_f32 v212, s29, v28
    v_mul_f32 v213, s29, v29
    v_mul_f32 v214, s29, v30
    v_mul_f32 v215, s29, v31
    v_exp_f32 v208, v208
    v_exp_f32 v209, v209
    v_exp_f32 v210, v210
    v_exp_f32 v211, v211
    v_exp_f32 v212, v212
    v_exp_f32 v213, v213
    v_exp_f32 v214, v214
    v_exp_f32 v215, v215
    v_pk_add_f32 v[208:209], v[208:209], 1.0 op_sel_hi:[1,0]
    v_pk_add_f32 v[210:211], v[210:211], 1.0 op_sel_hi:[1,0]
    v_pk_add_f32 v[212:213], v[212:213], 1.0 op_sel_hi:[1,0]
    v_pk_add_f32 v[214:215], v[214:215], 1.0 op_sel_hi:[1,0]
    v_rcp_f32 v208, v208
    v_rcp_f32 v209, v209
    v_rcp_f32 v210, v210
    v_rcp_f32 v211, v211
    v_rcp_f32 v212, v212
    v_rcp_f32 v213, v213
    v_rcp_f32 v214, v214
    v_rcp_f32 v215, v215
    v_pk_mul_f32 v[24:25], v[24:25], v[208:209]
    v_pk_mul_f32 v[26:27], v[26:27], v[210:211]
    v_pk_mul_f32 v[28:29], v[28:29], v[212:213]
    v_pk_mul_f32 v[30:31], v[30:31], v[214:215]
    v_cvt_pk_bf16_f32 v200, v24, v25
    v_cvt_pk_bf16_f32 v201, v26, v27
    v_cvt_pk_bf16_f32 v202, v28, v29
    v_cvt_pk_bf16_f32 v203, v30, v31
    buffer_store_dwordx4 v[200:203], v2, s[16:19], s27 offen offset:2048
    v_pk_mul_f32 v[208:209], v[176:177], v[150:151] op_sel:[0,1] op_sel_hi:[1,1]
    v_pk_mul_f32 v[210:211], v[178:179], v[150:151] op_sel:[0,1] op_sel_hi:[1,1]
    v_pk_mul_f32 v[212:213], v[180:181], v[150:151] op_sel:[0,1] op_sel_hi:[1,1]
    v_pk_mul_f32 v[214:215], v[182:183], v[150:151] op_sel:[0,1] op_sel_hi:[1,1]
    v_pk_fma_f32 v[32:33], v[32:33], v[150:151], v[208:209] op_sel_hi:[1,0,1] neg_lo:[0,0,1] neg_hi:[0,0,1]
    v_pk_fma_f32 v[34:35], v[34:35], v[150:151], v[210:211] op_sel_hi:[1,0,1] neg_lo:[0,0,1] neg_hi:[0,0,1]
    v_pk_fma_f32 v[36:37], v[36:37], v[150:151], v[212:213] op_sel_hi:[1,0,1] neg_lo:[0,0,1] neg_hi:[0,0,1]
    v_pk_fma_f32 v[38:39], v[38:39], v[150:151], v[214:215] op_sel_hi:[1,0,1] neg_lo:[0,0,1] neg_hi:[0,0,1]
    v_mul_f32 v208, s29, v32
    v_mul_f32 v209, s29, v33
    v_mul_f32 v210, s29, v34
    v_mul_f32 v211, s29, v35
    v_mul_f32 v212, s29, v36
    v_mul_f32 v213, s29, v37
    v_mul_f32 v214, s29, v38
    v_mul_f32 v215, s29, v39
    v_exp_f32 v208, v208
    v_exp_f32 v209, v209
    v_exp_f32 v210, v210
    v_exp_f32 v211, v211
    v_exp_f32 v212, v212
    v_exp_f32 v213, v213
    v_exp_f32 v214, v214
    v_exp_f32 v215, v215
    v_pk_add_f32 v[208:209], v[208:209], 1.0 op_sel_hi:[1,0]
    v_pk_add_f32 v[210:211], v[210:211], 1.0 op_sel_hi:[1,0]
    v_pk_add_f32 v[212:213], v[212:213], 1.0 op_sel_hi:[1,0]
    v_pk_add_f32 v[214:215], v[214:215], 1.0 op_sel_hi:[1,0]
    v_rcp_f32 v208, v208
    v_rcp_f32 v209, v209
    v_rcp_f32 v210, v210
    v_rcp_f32 v211, v211
    v_rcp_f32 v212, v212
    v_rcp_f32 v213, v213
    v_rcp_f32 v214, v214
    v_rcp_f32 v215, v215
    v_pk_mul_f32 v[32:33], v[32:33], v[208:209]
    v_pk_mul_f32 v[34:35], v[34:35], v[210:211]
    v_pk_mul_f32 v[36:37], v[36:37], v[212:213]
    v_pk_mul_f32 v[38:39], v[38:39], v[214:215]
    v_cvt_pk_bf16_f32 v204, v32, v33
    v_cvt_pk_bf16_f32 v205, v34, v35
    v_cvt_pk_bf16_f32 v206, v36, v37
    v_cvt_pk_bf16_f32 v207, v38, v39
    buffer_store_dwordx4 v[204:207], v2, s[16:19], s27 offen offset:3072
    v_pk_mul_f32 v[208:209], v[184:185], v[150:151] op_sel:[0,1] op_sel_hi:[1,1]
    v_pk_mul_f32 v[210:211], v[186:187], v[150:151] op_sel:[0,1] op_sel_hi:[1,1]
    v_pk_mul_f32 v[212:213], v[188:189], v[150:151] op_sel:[0,1] op_sel_hi:[1,1]
    v_pk_mul_f32 v[214:215], v[190:191], v[150:151] op_sel:[0,1] op_sel_hi:[1,1]
    v_pk_fma_f32 v[40:41], v[40:41], v[150:151], v[208:209] op_sel_hi:[1,0,1] neg_lo:[0,0,1] neg_hi:[0,0,1]
    v_pk_fma_f32 v[42:43], v[42:43], v[150:151], v[210:211] op_sel_hi:[1,0,1] neg_lo:[0,0,1] neg_hi:[0,0,1]
    v_pk_fma_f32 v[44:45], v[44:45], v[150:151], v[212:213] op_sel_hi:[1,0,1] neg_lo:[0,0,1] neg_hi:[0,0,1]
    v_pk_fma_f32 v[46:47], v[46:47], v[150:151], v[214:215] op_sel_hi:[1,0,1] neg_lo:[0,0,1] neg_hi:[0,0,1]
    v_mul_f32 v208, s29, v40
    v_mul_f32 v209, s29, v41
    v_mul_f32 v210, s29, v42
    v_mul_f32 v211, s29, v43
    v_mul_f32 v212, s29, v44
    v_mul_f32 v213, s29, v45
    v_mul_f32 v214, s29, v46
    v_mul_f32 v215, s29, v47
    v_exp_f32 v208, v208
    v_exp_f32 v209, v209
    v_exp_f32 v210, v210
    v_exp_f32 v211, v211
    v_exp_f32 v212, v212
    v_exp_f32 v213, v213
    v_exp_f32 v214, v214
    v_exp_f32 v215, v215
    v_pk_add_f32 v[208:209], v[208:209], 1.0 op_sel_hi:[1,0]
    v_pk_add_f32 v[210:211], v[210:211], 1.0 op_sel_hi:[1,0]
    v_pk_add_f32 v[212:213], v[212:213], 1.0 op_sel_hi:[1,0]
    v_pk_add_f32 v[214:215], v[214:215], 1.0 op_sel_hi:[1,0]
    v_rcp_f32 v208, v208
    v_rcp_f32 v209, v209
    v_rcp_f32 v210, v210
    v_rcp_f32 v211, v211
    v_rcp_f32 v212, v212
    v_rcp_f32 v213, v213
    v_rcp_f32 v214, v214
    v_rcp_f32 v215, v215
    v_pk_mul_f32 v[40:41], v[40:41], v[208:209]
    v_pk_mul_f32 v[42:43], v[42:43], v[210:211]
    v_pk_mul_f32 v[44:45], v[44:45], v[212:213]
    v_pk_mul_f32 v[46:47], v[46:47], v[214:215]
    v_cvt_pk_bf16_f32 v200, v40, v41
    v_cvt_pk_bf16_f32 v201, v42, v43
    v_cvt_pk_bf16_f32 v202, v44, v45
    v_cvt_pk_bf16_f32 v203, v46, v47
    s_add_u32 s28, s27, 4096
    buffer_store_dwordx4 v[200:203], v2, s[16:19], s28 offen
    v_pk_mul_f32 v[208:209], v[192:193], v[150:151] op_sel:[0,1] op_sel_hi:[1,1]
    v_pk_mul_f32 v[210:211], v[194:195], v[150:151] op_sel:[0,1] op_sel_hi:[1,1]
    v_pk_mul_f32 v[212:213], v[196:197], v[150:151] op_sel:[0,1] op_sel_hi:[1,1]
    v_pk_mul_f32 v[214:215], v[198:199], v[150:151] op_sel:[0,1] op_sel_hi:[1,1]
    v_pk_fma_f32 v[48:49], v[48:49], v[150:151], v[208:209] op_sel_hi:[1,0,1] neg_lo:[0,0,1] neg_hi:[0,0,1]
    v_pk_fma_f32 v[50:51], v[50:51], v[150:151], v[210:211] op_sel_hi:[1,0,1] neg_lo:[0,0,1] neg_hi:[0,0,1]
    v_pk_fma_f32 v[52:53], v[52:53], v[150:151], v[212:213] op_sel_hi:[1,0,1] neg_lo:[0,0,1] neg_hi:[0,0,1]
    v_pk_fma_f32 v[54:55], v[54:55], v[150:151], v[214:215] op_sel_hi:[1,0,1] neg_lo:[0,0,1] neg_hi:[0,0,1]
    v_mul_f32 v208, s29, v48
    v_mul_f32 v209, s29, v49
    v_mul_f32 v210, s29, v50
    v_mul_f32 v211, s29, v51
    v_mul_f32 v212, s29, v52
    v_mul_f32 v213, s29, v53
    v_mul_f32 v214, s29, v54
    v_mul_f32 v215, s29, v55
    v_exp_f32 v208, v208
    v_exp_f32 v209, v209
    v_exp_f32 v210, v210
    v_exp_f32 v211, v211
    v_exp_f32 v212, v212
    v_exp_f32 v213, v213
    v_exp_f32 v214, v214
    v_exp_f32 v215, v215
    v_pk_add_f32 v[208:209], v[208:209], 1.0 op_sel_hi:[1,0]
    v_pk_add_f32 v[210:211], v[210:211], 1.0 op_sel_hi:[1,0]
    v_pk_add_f32 v[212:213], v[212:213], 1.0 op_sel_hi:[1,0]
    v_pk_add_f32 v[214:215], v[214:215], 1.0 op_sel_hi:[1,0]
    v_rcp_f32 v208, v208
    v_rcp_f32 v209, v209
    v_rcp_f32 v210, v210
    v_rcp_f32 v211, v211
    v_rcp_f32 v212, v212
    v_rcp_f32 v213, v213
    v_rcp_f32 v214, v214
    v_rcp_f32 v215, v215
    v_pk_mul_f32 v[48:49], v[48:49], v[208:209]
    v_pk_mul_f32 v[50:51], v[50:51], v[210:211]
    v_pk_mul_f32 v[52:53], v[52:53], v[212:213]
    v_pk_mul_f32 v[54:55], v[54:55], v[214:215]
    v_cvt_pk_bf16_f32 v204, v48, v49
    v_cvt_pk_bf16_f32 v205, v50, v51
    v_cvt_pk_bf16_f32 v206, v52, v53
    v_cvt_pk_bf16_f32 v207, v54, v55
    s_add_u32 s28, s27, 5120
    buffer_store_dwordx4 v[204:207], v2, s[16:19], s28 offen
    s_branch L_f1_epi_join
L_f1_epi_slow:
    v_pk_mul_f32 v[208:209], v[152:153], v[150:151] op_sel:[0,1] op_sel_hi:[1,1]
    v_pk_mul_f32 v[210:211], v[154:155], v[150:151] op_sel:[0,1] op_sel_hi:[1,1]
    v_pk_mul_f32 v[212:213], v[156:157], v[150:151] op_sel:[0,1] op_sel_hi:[1,1]
    v_pk_mul_f32 v[214:215], v[158:159], v[150:151] op_sel:[0,1] op_sel_hi:[1,1]
    v_pk_fma_f32 v[8:9], v[8:9], v[150:151], v[208:209] op_sel_hi:[1,0,1] neg_lo:[0,0,1] neg_hi:[0,0,1]
    v_pk_fma_f32 v[10:11], v[10:11], v[150:151], v[210:211] op_sel_hi:[1,0,1] neg_lo:[0,0,1] neg_hi:[0,0,1]
    v_pk_fma_f32 v[12:13], v[12:13], v[150:151], v[212:213] op_sel_hi:[1,0,1] neg_lo:[0,0,1] neg_hi:[0,0,1]
    v_pk_fma_f32 v[14:15], v[14:15], v[150:151], v[214:215] op_sel_hi:[1,0,1] neg_lo:[0,0,1] neg_hi:[0,0,1]
    v_mul_f32 v208, s29, v8
    v_mul_f32 v209, s29, v9
    v_mul_f32 v210, s29, v10
    v_mul_f32 v211, s29, v11
    v_mul_f32 v212, s29, v12
    v_mul_f32 v213, s29, v13
    v_mul_f32 v214, s29, v14
    v_mul_f32 v215, s29, v15
    v_exp_f32 v208, v208
    v_exp_f32 v209, v209
    v_exp_f32 v210, v210
    v_exp_f32 v211, v211
    v_exp_f32 v212, v212
    v_exp_f32 v213, v213
    v_exp_f32 v214, v214
    v_exp_f32 v215, v215
    v_pk_add_f32 v[208:209], v[208:209], 1.0 op_sel_hi:[1,0]
    v_pk_add_f32 v[210:211], v[210:211], 1.0 op_sel_hi:[1,0]
    v_pk_add_f32 v[212:213], v[212:213], 1.0 op_sel_hi:[1,0]
    v_pk_add_f32 v[214:215], v[214:215], 1.0 op_sel_hi:[1,0]
    v_rcp_f32 v208, v208
    v_rcp_f32 v209, v209
    v_rcp_f32 v210, v210
    v_rcp_f32 v211, v211
    v_rcp_f32 v212, v212
    v_rcp_f32 v213, v213
    v_rcp_f32 v214, v214
    v_rcp_f32 v215, v215
    v_pk_mul_f32 v[8:9], v[8:9], v[208:209]
    v_pk_mul_f32 v[10:11], v[10:11], v[210:211]
    v_pk_mul_f32 v[12:13], v[12:13], v[212:213]
    v_pk_mul_f32 v[14:15], v[14:15], v[214:215]
    v_cvt_pk_bf16_f32 v200, v8, v9
    v_cvt_pk_bf16_f32 v201, v10, v11
    v_cvt_pk_bf16_f32 v202, v12, v13
    v_cvt_pk_bf16_f32 v203, v14, v15
    buffer_store_dwordx4 v[200:203], v2, s[16:19], s27 offen offset:0 sc1
    v_pk_mul_f32 v[208:209], v[160:161], v[150:151] op_sel:[0,1] op_sel_hi:[1,1]
    v_pk_mul_f32 v[210:211], v[162:163], v[150:151] op_sel:[0,1] op_sel_hi:[1,1]
    v_pk_mul_f32 v[212:213], v[164:165], v[150:151] op_sel:[0,1] op_sel_hi:[1,1]
    v_pk_mul_f32 v[214:215], v[166:167], v[150:151] op_sel:[0,1] op_sel_hi:[1,1]
    v_pk_fma_f32 v[16:17], v[16:17], v[150:151], v[208:209] op_sel_hi:[1,0,1] neg_lo:[0,0,1] neg_hi:[0,0,1]
    v_pk_fma_f32 v[18:19], v[18:19], v[150:151], v[210:211] op_sel_hi:[1,0,1] neg_lo:[0,0,1] neg_hi:[0,0,1]
    v_pk_fma_f32 v[20:21], v[20:21], v[150:151], v[212:213] op_sel_hi:[1,0,1] neg_lo:[0,0,1] neg_hi:[0,0,1]
    v_pk_fma_f32 v[22:23], v[22:23], v[150:151], v[214:215] op_sel_hi:[1,0,1] neg_lo:[0,0,1] neg_hi:[0,0,1]
    v_mul_f32 v208, s29, v16
    v_mul_f32 v209, s29, v17
    v_mul_f32 v210, s29, v18
    v_mul_f32 v211, s29, v19
    v_mul_f32 v212, s29, v20
    v_mul_f32 v213, s29, v21
    v_mul_f32 v214, s29, v22
    v_mul_f32 v215, s29, v23
    v_exp_f32 v208, v208
    v_exp_f32 v209, v209
    v_exp_f32 v210, v210
    v_exp_f32 v211, v211
    v_exp_f32 v212, v212
    v_exp_f32 v213, v213
    v_exp_f32 v214, v214
    v_exp_f32 v215, v215
    v_pk_add_f32 v[208:209], v[208:209], 1.0 op_sel_hi:[1,0]
    v_pk_add_f32 v[210:211], v[210:211], 1.0 op_sel_hi:[1,0]
    v_pk_add_f32 v[212:213], v[212:213], 1.0 op_sel_hi:[1,0]
    v_pk_add_f32 v[214:215], v[214:215], 1.0 op_sel_hi:[1,0]
    v_rcp_f32 v208, v208
    v_rcp_f32 v209, v209
    v_rcp_f32 v210, v210
    v_rcp_f32 v211, v211
    v_rcp_f32 v212, v212
    v_rcp_f32 v213, v213
    v_rcp_f32 v214, v214
    v_rcp_f32 v215, v215
    v_pk_mul_f32 v[16:17], v[16:17], v[208:209]
    v_pk_mul_f32 v[18:19], v[18:19], v[210:211]
    v_pk_mul_f32 v[20:21], v[20:21], v[212:213]
    v_pk_mul_f32 v[22:23], v[22:23], v[214:215]
    v_cvt_pk_bf16_f32 v204, v16, v17
    v_cvt_pk_bf16_f32 v205, v18, v19
    v_cvt_pk_bf16_f32 v206, v20, v21
    v_cvt_pk_bf16_f32 v207, v22, v23
    buffer_store_dwordx4 v[204:207], v2, s[16:19], s27 offen offset:1024 sc1
    v_pk_mul_f32 v[208:209], v[168:169], v[150:151] op_sel:[0,1] op_sel_hi:[1,1]
    v_pk_mul_f32 v[210:211], v[170:171], v[150:151] op_sel:[0,1] op_sel_hi:[1,1]
    v_pk_mul_f32 v[212:213], v[172:173], v[150:151] op_sel:[0,1] op_sel_hi:[1,1]
    v_pk_mul_f32 v[214:215], v[174:175], v[150:151] op_sel:[0,1] op_sel_hi:[1,1]
    v_pk_fma_f32 v[24:25], v[24:25], v[150:151], v[208:209] op_sel_hi:[1,0,1] neg_lo:[0,0,1] neg_hi:[0,0,1]
    v_pk_fma_f32 v[26:27], v[26:27], v[150:151], v[210:211] op_sel_hi:[1,0,1] neg_lo:[0,0,1] neg_hi:[0,0,1]
    v_pk_fma_f32 v[28:29], v[28:29], v[150:151], v[212:213] op_sel_hi:[1,0,1] neg_lo:[0,0,1] neg_hi:[0,0,1]
    v_pk_fma_f32 v[30:31], v[30:31], v[150:151], v[214:215] op_sel_hi:[1,0,1] neg_lo:[0,0,1] neg_hi:[0,0,1]
    v_mul_f32 v208, s29, v24
    v_mul_f32 v209, s29, v25
    v_mul_f32 v210, s29, v26
    v_mul_f32 v211, s29, v27
    v_mul_f32 v212, s29, v28
    v_mul_f32 v213, s29, v29
    v_mul_f32 v214, s29, v30
    v_mul_f32 v215, s29, v31
    v_exp_f32 v208, v208
    v_exp_f32 v209, v209
    v_exp_f32 v210, v210
    v_exp_f32 v211, v211
    v_exp_f32 v212, v212
    v_exp_f32 v213, v213
    v_exp_f32 v214, v214
    v_exp_f32 v215, v215
    v_pk_add_f32 v[208:209], v[208:209], 1.0 op_sel_hi:[1,0]
    v_pk_add_f32 v[210:211], v[210:211], 1.0 op_sel_hi:[1,0]
    v_pk_add_f32 v[212:213], v[212:213], 1.0 op_sel_hi:[1,0]
    v_pk_add_f32 v[214:215], v[214:215], 1.0 op_sel_hi:[1,0]
    v_rcp_f32 v208, v208
    v_rcp_f32 v209, v209
    v_rcp_f32 v210, v210
    v_rcp_f32 v211, v211
    v_rcp_f32 v212, v212
    v_rcp_f32 v213, v213
    v_rcp_f32 v214, v214
    v_rcp_f32 v215, v215
    v_pk_mul_f32 v[24:25], v[24:25], v[208:209]
    v_pk_mul_f32 v[26:27], v[26:27], v[210:211]
    v_pk_mul_f32 v[28:29], v[28:29], v[212:213]
    v_pk_mul_f32 v[30:31], v[30:31], v[214:215]
    v_cvt_pk_bf16_f32 v200, v24, v25
    v_cvt_pk_bf16_f32 v201, v26, v27
    v_cvt_pk_bf16_f32 v202, v28, v29
    v_cvt_pk_bf16_f32 v203, v30, v31
    buffer_store_dwordx4 v[200:203], v2, s[16:19], s27 offen offset:2048 sc1
    v_pk_mul_f32 v[208:209], v[176:177], v[150:151] op_sel:[0,1] op_sel_hi:[1,1]
    v_pk_mul_f32 v[210:211], v[178:179], v[150:151] op_sel:[0,1] op_sel_hi:[1,1]
    v_pk_mul_f32 v[212:213], v[180:181], v[150:151] op_sel:[0,1] op_sel_hi:[1,1]
    v_pk_mul_f32 v[214:215], v[182:183], v[150:151] op_sel:[0,1] op_sel_hi:[1,1]
    v_pk_fma_f32 v[32:33], v[32:33], v[150:151], v[208:209] op_sel_hi:[1,0,1] neg_lo:[0,0,1] neg_hi:[0,0,1]
    v_pk_fma_f32 v[34:35], v[34:35], v[150:151], v[210:211] op_sel_hi:[1,0,1] neg_lo:[0,0,1] neg_hi:[0,0,1]
    v_pk_fma_f32 v[36:37], v[36:37], v[150:151], v[212:213] op_sel_hi:[1,0,1] neg_lo:[0,0,1] neg_hi:[0,0,1]
    v_pk_fma_f32 v[38:39], v[38:39], v[150:151], v[214:215] op_sel_hi:[1,0,1] neg_lo:[0,0,1] neg_hi:[0,0,1]
    v_mul_f32 v208, s29, v32
    v_mul_f32 v209, s29, v33
    v_mul_f32 v210, s29, v34
    v_mul_f32 v211, s29, v35
    v_mul_f32 v212, s29, v36
    v_mul_f32 v213, s29, v37
    v_mul_f32 v214, s29, v38
    v_mul_f32 v215, s29, v39
    v_exp_f32 v208, v208
    v_exp_f32 v209, v209
    v_exp_f32 v210, v210
    v_exp_f32 v211, v211
    v_exp_f32 v212, v212
    v_exp_f32 v213, v213
    v_exp_f32 v214, v214
    v_exp_f32 v215, v215
    v_pk_add_f32 v[208:209], v[208:209], 1.0 op_sel_hi:[1,0]
    v_pk_add_f32 v[210:211], v[210:211], 1.0 op_sel_hi:[1,0]
    v_pk_add_f32 v[212:213], v[212:213], 1.0 op_sel_hi:[1,0]
    v_pk_add_f32 v[214:215], v[214:215], 1.0 op_sel_hi:[1,0]
    v_rcp_f32 v208, v208
    v_rcp_f32 v209, v209
    v_rcp_f32 v210, v210
    v_rcp_f32 v211, v211
    v_rcp_f32 v212, v212
    v_rcp_f32 v213, v213
    v_rcp_f32 v214, v214
    v_rcp_f32 v215, v215
    v_pk_mul_f32 v[32:33], v[32:33], v[208:209]
    v_pk_mul_f32 v[34:35], v[34:35], v[210:211]
    v_pk_mul_f32 v[36:37], v[36:37], v[212:213]
    v_pk_mul_f32 v[38:39], v[38:39], v[214:215]
    v_cvt_pk_bf16_f32 v204, v32, v33
    v_cvt_pk_bf16_f32 v205, v34, v35
    v_cvt_pk_bf16_f32 v206, v36, v37
    v_cvt_pk_bf16_f32 v207, v38, v39
    buffer_store_dwordx4 v[204:207], v2, s[16:19], s27 offen offset:3072 sc1
    v_pk_mul_f32 v[208:209], v[184:185], v[150:151] op_sel:[0,1] op_sel_hi:[1,1]
    v_pk_mul_f32 v[210:211], v[186:187], v[150:151] op_sel:[0,1] op_sel_hi:[1,1]
    v_pk_mul_f32 v[212:213], v[188:189], v[150:151] op_sel:[0,1] op_sel_hi:[1,1]
    v_pk_mul_f32 v[214:215], v[190:191], v[150:151] op_sel:[0,1] op_sel_hi:[1,1]
    v_pk_fma_f32 v[40:41], v[40:41], v[150:151], v[208:209] op_sel_hi:[1,0,1] neg_lo:[0,0,1] neg_hi:[0,0,1]
    v_pk_fma_f32 v[42:43], v[42:43], v[150:151], v[210:211] op_sel_hi:[1,0,1] neg_lo:[0,0,1] neg_hi:[0,0,1]
    v_pk_fma_f32 v[44:45], v[44:45], v[150:151], v[212:213] op_sel_hi:[1,0,1] neg_lo:[0,0,1] neg_hi:[0,0,1]
    v_pk_fma_f32 v[46:47], v[46:47], v[150:151], v[214:215] op_sel_hi:[1,0,1] neg_lo:[0,0,1] neg_hi:[0,0,1]
    v_mul_f32 v208, s29, v40
    v_mul_f32 v209, s29, v41
    v_mul_f32 v210, s29, v42
    v_mul_f32 v211, s29, v43
    v_mul_f32 v212, s29, v44
    v_mul_f32 v213, s29, v45
    v_mul_f32 v214, s29, v46
    v_mul_f32 v215, s29, v47
    v_exp_f32 v208, v208
    v_exp_f32 v209, v209
    v_exp_f32 v210, v210
    v_exp_f32 v211, v211
    v_exp_f32 v212, v212
    v_exp_f32 v213, v213
    v_exp_f32 v214, v214
    v_exp_f32 v215, v215
    v_pk_add_f32 v[208:209], v[208:209], 1.0 op_sel_hi:[1,0]
    v_pk_add_f32 v[210:211], v[210:211], 1.0 op_sel_hi:[1,0]
    v_pk_add_f32 v[212:213], v[212:213], 1.0 op_sel_hi:[1,0]
    v_pk_add_f32 v[214:215], v[214:215], 1.0 op_sel_hi:[1,0]
    v_rcp_f32 v208, v208
    v_rcp_f32 v209, v209
    v_rcp_f32 v210, v210
    v_rcp_f32 v211, v211
    v_rcp_f32 v212, v212
    v_rcp_f32 v213, v213
    v_rcp_f32 v214, v214
    v_rcp_f32 v215, v215
    v_pk_mul_f32 v[40:41], v[40:41], v[208:209]
    v_pk_mul_f32 v[42:43], v[42:43], v[210:211]
    v_pk_mul_f32 v[44:45], v[44:45], v[212:213]
    v_pk_mul_f32 v[46:47], v[46:47], v[214:215]
    v_cvt_pk_bf16_f32 v200, v40, v41
    v_cvt_pk_bf16_f32 v201, v42, v43
    v_cvt_pk_bf16_f32 v202, v44, v45
    v_cvt_pk_bf16_f32 v203, v46, v47
    s_add_u32 s28, s27, 4096
    buffer_store_dwordx4 v[200:203], v2, s[16:19], s28 offen sc1
    v_pk_mul_f32 v[208:209], v[192:193], v[150:151] op_sel:[0,1] op_sel_hi:[1,1]
    v_pk_mul_f32 v[210:211], v[194:195], v[150:151] op_sel:[0,1] op_sel_hi:[1,1]
    v_pk_mul_f32 v[212:213], v[196:197], v[150:151] op_sel:[0,1] op_sel_hi:[1,1]
    v_pk_mul_f32 v[214:215], v[198:199], v[150:151] op_sel:[0,1] op_sel_hi:[1,1]
    v_pk_fma_f32 v[48:49], v[48:49], v[150:151], v[208:209] op_sel_hi:[1,0,1] neg_lo:[0,0,1] neg_hi:[0,0,1]
    v_pk_fma_f32 v[50:51], v[50:51], v[150:151], v[210:211] op_sel_hi:[1,0,1] neg_lo:[0,0,1] neg_hi:[0,0,1]
    v_pk_fma_f32 v[52:53], v[52:53], v[150:151], v[212:213] op_sel_hi:[1,0,1] neg_lo:[0,0,1] neg_hi:[0,0,1]
    v_pk_fma_f32 v[54:55], v[54:55], v[150:151], v[214:215] op_sel_hi:[1,0,1] neg_lo:[0,0,1] neg_hi:[0,0,1]
    v_mul_f32 v208, s29, v48
    v_mul_f32 v209, s29, v49
    v_mul_f32 v210, s29, v50
    v_mul_f32 v211, s29, v51
    v_mul_f32 v212, s29, v52
    v_mul_f32 v213, s29, v53
    v_mul_f32 v214, s29, v54
    v_mul_f32 v215, s29, v55
    v_exp_f32 v208, v208
    v_exp_f32 v209, v209
    v_exp_f32 v210, v210
    v_exp_f32 v211, v211
    v_exp_f32 v212, v212
    v_exp_f32 v213, v213
    v_exp_f32 v214, v214
    v_exp_f32 v215, v215
    v_pk_add_f32 v[208:209], v[208:209], 1.0 op_sel_hi:[1,0]
    v_pk_add_f32 v[210:211], v[210:211], 1.0 op_sel_hi:[1,0]
    v_pk_add_f32 v[212:213], v[212:213], 1.0 op_sel_hi:[1,0]
    v_pk_add_f32 v[214:215], v[214:215], 1.0 op_sel_hi:[1,0]
    v_rcp_f32 v208, v208
    v_rcp_f32 v209, v209
    v_rcp_f32 v210, v210
    v_rcp_f32 v211, v211
    v_rcp_f32 v212, v212
    v_rcp_f32 v213, v213
    v_rcp_f32 v214, v214
    v_rcp_f32 v215, v215
    v_pk_mul_f32 v[48:49], v[48:49], v[208:209]
    v_pk_mul_f32 v[50:51], v[50:51], v[210:211]
    v_pk_mul_f32 v[52:53], v[52:53], v[212:213]
    v_pk_mul_f32 v[54:55], v[54:55], v[214:215]
    v_cvt_pk_bf16_f32 v204, v48, v49
    v_cvt_pk_bf16_f32 v205, v50, v51
    v_cvt_pk_bf16_f32 v206, v52, v53
    v_cvt_pk_bf16_f32 v207, v54, v55
    s_add_u32 s28, s27, 5120
    buffer_store_dwordx4 v[204:207], v2, s[16:19], s28 offen sc1
L_f1_epi_join:
L_f1_done:
    s_and_b32 s4, s2, 7
    s_lshr_b32 s5, s2, 3
    s_and_b32 s24, s5, 7
    s_lshr_b32 s6, s5, 3
    s_lshl_b32 s4, s4, 2
    s_add_u32 s23, s4, s6
    s_lshr_b32 s32, s21, 1
    s_and_b32 s33, s21, 1
    s_mov_b32 s12, s52
    s_and_b32 s13, s53, 0xffff
    s_mov_b32 s14, 2621440
    s_mov_b32 s15, 0x00020000
    s_cmp_eq_u32 s22, 0
    s_cbranch_scc1 L_w2_compute
    s_mul_i32 s25, s24, 245760
    s_mul_i32 s27, s33, 122880
    s_add_u32 s25, s25, s27
    s_mul_i32 s27, s32, 5120
    s_add_u32 s25, s25, s27
    s_add_u32 s25, s25, 22249472
    s_mul_i32 s34, s33, 5120
    s_mul_i32 s27, s32, 10240
    s_add_u32 s34, s34, s27
    s_add_u32 m0, s34, 0
    s_add_u32 s27, s25, 0
    buffer_load_dwordx4 v2, s[16:19], s27 offen offset:0 sc1 lds
    buffer_load_dwordx4 v2, s[16:19], s27 offen offset:1024 sc1 lds
    buffer_load_dwordx4 v2, s[16:19], s27 offen offset:2048 sc1 lds
    buffer_load_dwordx4 v2, s[16:19], s27 offen offset:3072 sc1 lds
    s_add_u32 m0, s34, 4096
    s_add_u32 s27, s25, 4096
    buffer_load_dwordx4 v2, s[16:19], s27 offen offset:0 sc1 lds
    s_add_u32 m0, s34, 20480
    s_add_u32 s27, s25, 10240
    buffer_load_dwordx4 v2, s[16:19], s27 offen offset:0 sc1 lds
    buffer_load_dwordx4 v2, s[16:19], s27 offen offset:1024 sc1 lds
    buffer_load_dwordx4 v2, s[16:19], s27 offen offset:2048 sc1 lds
    buffer_load_dwordx4 v2, s[16:19], s27 offen offset:3072 sc1 lds
    s_add_u32 m0, s34, 24576
    s_add_u32 s27, s25, 14336
    buffer_load_dwordx4 v2, s[16:19], s27 offen offset:0 sc1 lds
    s_add_u32 m0, s34, 40960
    s_add_u32 s27, s25, 20480
    buffer_load_dwordx4 v2, s[16:19], s27 offen offset:0 sc1 lds
    buffer_load_dwordx4 v2, s[16:19], s27 offen offset:1024 sc1 lds
    buffer_load_dwordx4 v2, s[16:19], s27 offen offset:2048 sc1 lds
    buffer_load_dwordx4 v2, s[16:19], s27 offen offset:3072 sc1 lds
    s_add_u32 m0, s34, 45056
    s_add_u32 s27, s25, 24576
    buffer_load_dwordx4 v2, s[16:19], s27 offen offset:0 sc1 lds
    s_add_u32 m0, s34, 61440
    s_add_u32 s27, s25, 30720
    buffer_load_dwordx4 v2, s[16:19], s27 offen offset:0 sc1 lds
    buffer_load_dwordx4 v2, s[16:19], s27 offen offset:1024 sc1 lds
    buffer_load_dwordx4 v2, s[16:19], s27 offen offset:2048 sc1 lds
    buffer_load_dwordx4 v2, s[16:19], s27 offen offset:3072 sc1 lds
    s_add_u32 m0, s34, 65536
    s_add_u32 s27, s25, 34816
    buffer_load_dwordx4 v2, s[16:19], s27 offen offset:0 sc1 lds
    s_add_u32 m0, s34, 81920
    s_add_u32 s27, s25, 40960
    buffer_load_dwordx4 v2, s[16:19], s27 offen offset:0 sc1 lds
    buffer_load_dwordx4 v2, s[16:19], s27 offen offset:1024 sc1 lds
    buffer_load_dwordx4 v2, s[16:19], s27 offen offset:2048 sc1 lds
    buffer_load_dwordx4 v2, s[16:19], s27 offen offset:3072 sc1 lds
    s_add_u32 m0, s34, 86016
    s_add_u32 s27, s25, 45056
    buffer_load_dwordx4 v2, s[16:19], s27 offen offset:0 sc1 lds
    s_add_u32 m0, s34, 102400
    s_add_u32 s27, s25, 51200
    buffer_load_dwordx4 v2, s[16:19], s27 offen offset:0 sc1 lds
    buffer_load_dwordx4 v2, s[16:19], s27 offen offset:1024 sc1 lds
    buffer_load_dwordx4 v2, s[16:19], s27 offen offset:2048 sc1 lds
    buffer_load_dwordx4 v2, s[16:19], s27 offen offset:3072 sc1 lds
    s_add_u32 m0, s34, 106496
    s_add_u32 s27, s25, 55296
    buffer_load_dwordx4 v2, s[16:19], s27 offen offset:0 sc1 lds
    s_add_u32 m0, s34, 122880
    s_add_u32 s27, s25, 61440
    buffer_load_dwordx4 v2, s[16:19], s27 offen offset:0 sc1 lds
    buffer_load_dwordx4 v2, s[16:19], s27 offen offset:1024 sc1 lds
    buffer_load_dwordx4 v2, s[16:19], s27 offen offset:2048 sc1 lds
    buffer_load_dwordx4 v2, s[16:19], s27 offen offset:3072 sc1 lds
    s_add_u32 m0, s34, 126976
    s_add_u32 s27, s25, 65536
    buffer_load_dwordx4 v2, s[16:19], s27 offen offset:0 sc1 lds
    s_cmp_lg_u32 s32, 0
    s_cbranch_scc1 L_w2_no14
    s_add_u32 m0, s34, 143360
    s_add_u32 s27, s25, 71680
    buffer_load_dwordx4 v2, s[16:19], s27 offen offset:0 sc1 lds
    buffer_load_dwordx4 v2, s[16:19], s27 offen offset:1024 sc1 lds
    buffer_load_dwordx4 v2, s[16:19], s27 offen offset:2048 sc1 lds
    buffer_load_dwordx4 v2, s[16:19], s27 offen offset:3072 sc1 lds
    s_add_u32 m0, s34, 147456
    s_add_u32 s27, s25, 75776
    buffer_load_dwordx4 v2, s[16:19], s27 offen offset:0 sc1 lds
L_w2_no14:
    s_lshr_b32 s5, s2, 3
    s_and_b32 s5, s5, 7
    s_mul_i32 s26, s5, 245760
    s_and_b32 s4, s21, 1
    s_mul_i32 s4, s4, 122880
    s_add_u32 s26, s26, s4
    s_add_u32 s26, s26, 22326272
    s_lshr_b32 s6, s21, 1
    s_lshl_b32 s6, s6, 3
    s_add_u32 s4, s6, 0
    s_min_u32 s4, s4, 14
    s_lshl_b32 s4, s4, 10
    s_add_u32 s4, s4, s26
    s_add_u32 s4, s4, 15360
    buffer_load_dwordx4 v[132:135], v2, s[16:19], s4 offen sc1
    s_add_u32 s4, s6, 1
    s_min_u32 s4, s4, 14
    s_lshl_b32 s4, s4, 10
    s_add_u32 s4, s4, s26
    s_add_u32 s4, s4, 15360
    buffer_load_dwordx4 v[136:139], v2, s[16:19], s4 offen sc1
    s_add_u32 s4, s6, 2
    s_min_u32 s4, s4, 14
    s_lshl_b32 s4, s4, 10
    s_add_u32 s4, s4, s26
    s_add_u32 s4, s4, 15360
    buffer_load_dwordx4 v[140:143], v2, s[16:19], s4 offen sc1
    s_add_u32 s4, s6, 3
    s_min_u32 s4, s4, 14
    s_lshl_b32 s4, s4, 10
    s_add_u32 s4, s4, s26
    s_add_u32 s4, s4, 15360
    buffer_load_dwordx4 v[144:147], v2, s[16:19], s4 offen sc1
    s_add_u32 s4, s6, 4
    s_min_u32 s4, s4, 14
    s_lshl_b32 s4, s4, 10
    s_add_u32 s4, s4, s26
    s_add_u32 s4, s4, 15360
    buffer_load_dwordx4 v[148:151], v2, s[16:19], s4 offen sc1
    s_add_u32 s4, s6, 5
    s_min_u32 s4, s4, 14
    s_lshl_b32 s4, s4, 10
    s_add_u32 s4, s4, s26
    s_add_u32 s4, s4, 15360
    buffer_load_dwordx4 v[152:155], v2, s[16:19], s4 offen sc1
    s_add_u32 s4, s6, 6
    s_min_u32 s4, s4, 14
    s_lshl_b32 s4, s4, 10
    s_add_u32 s4, s4, s26
    s_add_u32 s4, s4, 15360
    buffer_load_dwordx4 v[156:159], v2, s[16:19], s4 offen sc1
    s_add_u32 s4, s6, 7
    s_min_u32 s4, s4, 14
    s_lshl_b32 s4, s4, 10
    s_add_u32 s4, s4, s26
    s_add_u32 s4, s4, 15360
    buffer_load_dwordx4 v[160:163], v2, s[16:19], s4 offen sc1
    s_waitcnt vmcnt(8)
    v_mov_b32 v3, 163680
    v_mov_b32 v4, 1
    s_mov_b64 exec, 1
    ds_add_u32 v3, v4
    s_mov_b64 exec, -1
    s_lshr_b32 s5, s2, 3
    s_and_b32 s5, s5, 7
    s_mul_i32 s26, s5, 245760
    s_and_b32 s4, s21, 1
    s_mul_i32 s4, s4, 122880
    s_add_u32 s26, s26, s4
    s_add_u32 s26, s26, 22326272
    s_lshr_b32 s6, s21, 1
    s_lshl_b32 s6, s6, 3
    s_add_u32 s4, s6, 0
    s_min_u32 s4, s4, 14
    s_lshl_b32 s4, s4, 10
    s_add_u32 s4, s4, s26
    s_add_u32 s4, s4, 30720
    buffer_load_dwordx4 v[164:167], v2, s[16:19], s4 offen sc1
    s_add_u32 s4, s6, 1
    s_min_u32 s4, s4, 14
    s_lshl_b32 s4, s4, 10
    s_add_u32 s4, s4, s26
    s_add_u32 s4, s4, 30720
    buffer_load_dwordx4 v[168:171], v2, s[16:19], s4 offen sc1
    s_add_u32 s4, s6, 2
    s_min_u32 s4, s4, 14
    s_lshl_b32 s4, s4, 10
    s_add_u32 s4, s4, s26
    s_add_u32 s4, s4, 30720
    buffer_load_dwordx4 v[172:175], v2, s[16:19], s4 offen sc1
    s_add_u32 s4, s6, 3
    s_min_u32 s4, s4, 14
    s_lshl_b32 s4, s4, 10
    s_add_u32 s4, s4, s26
    s_add_u32 s4, s4, 30720
    buffer_load_dwordx4 v[176:179], v2, s[16:19], s4 offen sc1
    s_add_u32 s4, s6, 4
    s_min_u32 s4, s4, 14
    s_lshl_b32 s4, s4, 10
    s_add_u32 s4, s4, s26
    s_add_u32 s4, s4, 30720
    buffer_load_dwordx4 v[180:183], v2, s[16:19], s4 offen sc1
    s_add_u32 s4, s6, 5
    s_min_u32 s4, s4, 14
    s_lshl_b32 s4, s4, 10
    s_add_u32 s4, s4, s26
    s_add_u32 s4, s4, 30720
    buffer_load_dwordx4 v[184:187], v2, s[16:19], s4 offen sc1
    s_add_u32 s4, s6, 6
    s_min_u32 s4, s4, 14
    s_lshl_b32 s4, s4, 10
    s_add_u32 s4, s4, s26
    s_add_u32 s4, s4, 30720
    buffer_load_dwordx4 v[188:191], v2, s[16:19], s4 offen sc1
    s_add_u32 s4, s6, 7
    s_min_u32 s4, s4, 14
    s_lshl_b32 s4, s4, 10
    s_add_u32 s4, s4, s26
    s_add_u32 s4, s4, 30720
    buffer_load_dwordx4 v[192:195], v2, s[16:19], s4 offen sc1
    s_mul_i32 s27, s32, 10240
    s_sub_u32 s34, s34, s27
    s_lshl_b32 s4, s32, 3
    s_add_u32 s4, s4, 0
    s_min_u32 s4, s4, 14
    s_mul_i32 s5, s4, 52
    s_lshr_b32 s5, s5, 8
    s_mul_i32 s6, s5, 5
    s_sub_u32 s6, s4, s6
    s_mul_i32 s5, s5, 10240
    s_lshl_b32 s6, s6, 10
    s_add_u32 s5, s5, s6
    s_add_u32 s5, s5, s34
    v_add_u32 v8, s5, v2
    s_lshl_b32 s4, s32, 3
    s_add_u32 s4, s4, 1
    s_min_u32 s4, s4, 14
    s_mul_i32 s5, s4, 52
    s_lshr_b32 s5, s5, 8
    s_mul_i32 s6, s5, 5
    s_sub_u32 s6, s4, s6
    s_mul_i32 s5, s5, 10240
    s_lshl_b32 s6, s6, 10
    s_add_u32 s5, s5, s6
    s_add_u32 s5, s5, s34
    v_add_u32 v9, s5, v2
    s_lshl_b32 s4, s32, 3
    s_add_u32 s4, s4, 2
    s_min_u32 s4, s4, 14
    s_mul_i32 s5, s4, 52
    s_lshr_b32 s5, s5, 8
    s_mul_i32 s6, s5, 5
    s_sub_u32 s6, s4, s6
    s_mul_i32 s5, s5, 10240
    s_lshl_b32 s6, s6, 10
    s_add_u32 s5, s5, s6
    s_add_u32 s5, s5, s34
    v_add_u32 v10, s5, v2
    s_lshl_b32 s4, s32, 3
    s_add_u32 s4, s4, 3
    s_min_u32 s4, s4, 14
    s_mul_i32 s5, s4, 52
    s_lshr_b32 s5, s5, 8
    s_mul_i32 s6, s5, 5
    s_sub_u32 s6, s4, s6
    s_mul_i32 s5, s5, 10240
    s_lshl_b32 s6, s6, 10
    s_add_u32 s5, s5, s6
    s_add_u32 s5, s5, s34
    v_add_u32 v11, s5, v2
    s_lshl_b32 s4, s32, 3
    s_add_u32 s4, s4, 4
    s_min_u32 s4, s4, 14
    s_mul_i32 s5, s4, 52
    s_lshr_b32 s5, s5, 8
    s_mul_i32 s6, s5, 5
    s_sub_u32 s6, s4, s6
    s_mul_i32 s5, s5, 10240
    s_lshl_b32 s6, s6, 10
    s_add_u32 s5, s5, s6
    s_add_u32 s5, s5, s34
    v_add_u32 v12, s5, v2
    s_lshl_b32 s4, s32, 3
    s_add_u32 s4, s4, 5
    s_min_u32 s4, s4, 14
    s_mul_i32 s5, s4, 52
    s_lshr_b32 s5, s5, 8
    s_mul_i32 s6, s5, 5
    s_sub_u32 s6, s4, s6
    s_mul_i32 s5, s5, 10240
    s_lshl_b32 s6, s6, 10
    s_add_u32 s5, s5, s6
    s_add_u32 s5, s5, s34
    v_add_u32 v13, s5, v2
    s_lshl_b32 s4, s32, 3
    s_add_u32 s4, s4, 6
    s_min_u32 s4, s4, 14
    s_mul_i32 s5, s4, 52
    s_lshr_b32 s5, s5, 8
    s_mul_i32 s6, s5, 5
    s_sub_u32 s6, s4, s6
    s_mul_i32 s5, s5, 10240
    s_lshl_b32 s6, s6, 10
    s_add_u32 s5, s5, s6
    s_add_u32 s5, s5, s34
    v_add_u32 v14, s5, v2
    s_lshl_b32 s4, s32, 3
    s_add_u32 s4, s4, 7
    s_min_u32 s4, s4, 14
    s_mul_i32 s5, s4, 52
    s_lshr_b32 s5, s5, 8
    s_mul_i32 s6, s5, 5
    s_sub_u32 s6, s4, s6
    s_mul_i32 s5, s5, 10240
    s_lshl_b32 s6, s6, 10
    s_add_u32 s5, s5, s6
    s_add_u32 s5, s5, s34
    v_add_u32 v15, s5, v2
    s_barrier
    ds_write_b128 v8, v[100:103] offset:0
    ds_write_b128 v9, v[104:107] offset:0
    ds_write_b128 v10, v[108:111] offset:0
    ds_write_b128 v11, v[112:115] offset:0
    ds_write_b128 v12, v[116:119] offset:0
    ds_write_b128 v13, v[120:123] offset:0
    ds_write_b128 v14, v[124:127] offset:0
    ds_write_b128 v15, v[128:131] offset:0
    s_waitcnt lgkmcnt(0)
    s_barrier
    s_waitcnt vmcnt(0)
    ds_write_b128 v8, v[132:135] offset:30720
    ds_write_b128 v9, v[136:139] offset:30720
    ds_write_b128 v10, v[140:143] offset:30720
    ds_write_b128 v11, v[144:147] offset:30720
    ds_write_b128 v12, v[148:151] offset:30720
    ds_write_b128 v13, v[152:155] offset:30720
    ds_write_b128 v14, v[156:159] offset:30720
    ds_write_b128 v15, v[160:163] offset:30720
    s_waitcnt lgkmcnt(0)
    s_barrier
    ds_write_b128 v8, v[164:167] offset:61440
    ds_write_b128 v9, v[168:171] offset:61440
    ds_write_b128 v10, v[172:175] offset:61440
    ds_write_b128 v11, v[176:179] offset:61440
    ds_write_b128 v12, v[180:183] offset:61440
    ds_write_b128 v13, v[184:187] offset:61440
    ds_write_b128 v14, v[188:191] offset:61440
    ds_write_b128 v15, v[192:195] offset:61440
    s_waitcnt lgkmcnt(0)
    s_barrier
    s_barrier
    s_barrier
    s_barrier
    s_barrier
    s_barrier
    s_mul_i32 s28, s23, 81920
    s_mul_i32 s27, s24, 160
    s_add_u32 s28, s28, s27
    s_lshl_b32 s27, s21, 6
    s_add_u32 s27, s27, 0
    v_add_u32 v3, s27, v1
    v_mul_u32_u24 v4, 6554, v3
    v_lshrrev_b32 v4, 16, v4
    v_mul_u32_u24 v5, 10, v4
    v_sub_u32 v5, v3, v5
    v_mul_u32_u24 v4, 1280, v4
    v_lshl_add_u32 v4, v5, 4, v4
    v_lshlrev_b32 v6, 4, v3
    v_add_u32 v6, 40960, v6
    v_cmp_gt_u32 vcc, 640, v3
    s_nop 1
    v_cndmask_b32 v6, 0, v6, vcc
    ds_read_b128 v[16:19], v6
    v_mov_b32 v6, 0x7ffffff0
    v_cndmask_b32 v28, v6, v4, vcc
    s_lshl_b32 s27, s21, 6
    s_add_u32 s27, s27, 256
    v_add_u32 v3, s27, v1
    v_mul_u32_u24 v4, 6554, v3
    v_lshrrev_b32 v4, 16, v4
    v_mul_u32_u24 v5, 10, v4
    v_sub_u32 v5, v3, v5
    v_mul_u32_u24 v4, 1280, v4
    v_lshl_add_u32 v4, v5, 4, v4
    v_lshlrev_b32 v6, 4, v3
    v_add_u32 v6, 40960, v6
    v_cmp_gt_u32 vcc, 640, v3
    s_nop 1
    v_cndmask_b32 v6, 0, v6, vcc
    ds_read_b128 v[20:23], v6
    v_mov_b32 v6, 0x7ffffff0
    v_cndmask_b32 v29, v6, v4, vcc
    s_lshl_b32 s27, s21, 6
    s_add_u32 s27, s27, 512
    v_add_u32 v3, s27, v1
    v_mul_u32_u24 v4, 6554, v3
    v_lshrrev_b32 v4, 16, v4
    v_mul_u32_u24 v5, 10, v4
    v_sub_u32 v5, v3, v5
    v_mul_u32_u24 v4, 1280, v4
    v_lshl_add_u32 v4, v5, 4, v4
    v_lshlrev_b32 v6, 4, v3
    v_add_u32 v6, 40960, v6
    v_cmp_gt_u32 vcc, 640, v3
    s_nop 1
    v_cndmask_b32 v6, 0, v6, vcc
    ds_read_b128 v[24:27], v6
    v_mov_b32 v6, 0x7ffffff0
    v_cndmask_b32 v30, v6, v4, vcc
    s_waitcnt lgkmcnt(0)
    buffer_store_dwordx4 v[16:19], v28, s[12:15], s28 offen
    buffer_store_dwordx4 v[20:23], v29, s[12:15], s28 offen
    buffer_store_dwordx4 v[24:27], v30, s[12:15], s28 offen
    s_branch L_w2_done
L_w2_compute:
    s_waitcnt vmcnt(0)
    s_lshl_b32 s36, s91, 7
    s_add_u32 s36, s36, 24444928
    v_mov_b32 v5, 163664
    v_mov_b32 v6, 1
    s_mov_b64 exec, 1
    ds_add_rtn_u32 v6, v5, v6
    s_waitcnt lgkmcnt(0)
    v_readfirstlane_b32 s27, v6
    s_mov_b64 exec, -1
    s_nop 2
    s_cmp_eq_u32 s27, 3
    s_cbranch_scc0 L_w2_noflag
    s_lshl_b32 s36, s91, 7
    s_add_u32 s36, s36, 24444928
    s_lshl_b32 s4, s92, 2
    v_mov_b32 v5, s4
    v_mov_b32 v6, 1
    s_mov_b64 exec, 1
    s_cmp_eq_u32 s90, 0
    s_cbranch_scc1 L_fs_slow3
    buffer_store_dword v6, v5, s[16:19], s36 offen
    s_branch L_fs_done3
L_fs_slow3:
    buffer_store_dword v6, v5, s[16:19], s36 offen sc1
L_fs_done3:
    s_mov_b64 exec, -1
L_w2_noflag:
    v_and_b32 v48, 15, v1
    v_lshrrev_b32 v49, 4, v1
    v_lshrrev_b32 v3, 1, v49
    v_lshlrev_b32 v3, 10, v3
    v_and_b32 v4, 1, v49
    v_lshl_add_u32 v3, v4, 9, v3
    v_lshl_add_u32 v3, v48, 4, v3
    s_lshl_b32 s28, s33, 8
    v_add_u32 v50, s28, v3
    s_xor_b32 s28, s28, 256
    v_add_u32 v51, s28, v3
    v_and_b32 v3, 1, v49
    v_lshlrev_b32 v3, 9, v3
    v_lshrrev_b32 v4, 1, v49
    v_lshl_add_u32 v3, v4, 3, v3
    v_lshl_add_u32 v3, v48, 4, v3
    s_lshl_b32 s28, s33, 8
    v_add_u32 v52, s28, v3
    s_lshl_b32 s37, s23, 1
    s_add_u32 s37, s37, s32
    s_mul_i32 s37, s37, 40960
    s_mul_i32 s27, s24, 5120
    s_add_u32 s37, s37, s27
    s_add_u32 s37, s37, 10551296
    s_mul_i32 s27, s33, 5120
    v_add_u32 v53, s27, v2
    v_add_u32 v54, 61440, v53
    v_add_u32 v55, 122880, v53
    v_mov_b32 v8, 0
    v_mov_b32 v9, 0
    v_mov_b32 v10, 0
    v_mov_b32 v11, 0
    v_mov_b32 v12, 0
    v_mov_b32 v13, 0
    v_mov_b32 v14, 0
    v_mov_b32 v15, 0
    v_mov_b32 v16, 0
    v_mov_b32 v17, 0
    v_mov_b32 v18, 0
    v_mov_b32 v19, 0
    v_mov_b32 v20, 0
    v_mov_b32 v21, 0
    v_mov_b32 v22, 0
    v_mov_b32 v23, 0
    v_mov_b32 v24, 0
    v_mov_b32 v25, 0
    v_mov_b32 v26, 0
    v_mov_b32 v27, 0
    v_mov_b32 v28, 0
    v_mov_b32 v29, 0
    v_mov_b32 v30, 0
    v_mov_b32 v31, 0
    v_mov_b32 v32, 0
    v_mov_b32 v33, 0
    v_mov_b32 v34, 0
    v_mov_b32 v35, 0
    v_mov_b32 v36, 0
    v_mov_b32 v37, 0
    v_mov_b32 v38, 0
    v_mov_b32 v39, 0
    v_mov_b32 v40, 0
    v_mov_b32 v41, 0
    v_mov_b32 v42, 0
    v_mov_b32 v43, 0
    v_mov_b32 v44, 0
    v_mov_b32 v45, 0
    v_mov_b32 v46, 0
    v_mov_b32 v47, 0
    buffer_load_dwordx2 v[56:57], v52, s[16:19], s37 offen offset:0 sc1
    buffer_load_dwordx2 v[58:59], v52, s[16:19], s37 offen offset:1024 sc1
    buffer_load_dwordx2 v[60:61], v52, s[16:19], s37 offen offset:2048 sc1
    buffer_load_dwordx2 v[62:63], v52, s[16:19], s37 offen offset:3072 sc1
    s_add_u32 s27, s37, 4096
    buffer_load_dwordx2 v[64:65], v52, s[16:19], s27 offen sc1
    s_lshl_b32 s26, s23, 1
    s_add_u32 s26, s26, s32
    s_mul_i32 s26, s26, 98304
    s_mul_i32 s27, s33, 49152
    s_add_u32 s26, s26, s27
    s_add_u32 s26, s26, 13172736
    s_cmp_lg_u32 s20, 0
    s_cbranch_scc1 L_w2_nopoll
    v_lshlrev_b32 v5, 2, v1
    s_mov_b32 s29, 0
    s_mov_b64 exec, 0xffff
L_poll_w2:
    buffer_load_dword v6, v5, s[16:19], s36 offen sc1
    s_add_u32 s29, s29, 1
    s_waitcnt vmcnt(0)
    v_cmp_gt_u32 vcc, 1, v6
    s_cmp_gt_u32 s29, 40000
    s_cbranch_scc1 L_pollx_w2
    s_nop 1
    s_cbranch_vccz L_pollx_w2
    s_sleep 1
    s_branch L_poll_w2
L_pollx_w2:
    s_mov_b64 exec, -1
    v_mov_b32 v5, 163680
    v_mov_b32 v6, 16
    s_mov_b64 exec, 1
    ds_add_u32 v5, v6
    s_mov_b64 exec, -1
L_w2_nopoll:
    v_mov_b32 v5, 163680
    s_mov_b32 s28, 0
L_spin_z5:
    ds_read_b32 v6, v5
    s_add_u32 s28, s28, 1
    s_waitcnt lgkmcnt(0)
    v_readfirstlane_b32 s27, v6
    s_cmp_gt_u32 s28, 1600000
    s_cbranch_scc1 L_spinx_z5
    s_nop 1
    s_cmp_ge_u32 s27, 20
    s_cbranch_scc0 L_spin_z5
L_spinx_z5:
    buffer_load_dwordx4 v[128:131], v50, s[16:19], s26 offen sc1
    buffer_load_dwordx4 v[132:135], v51, s[16:19], s26 offen sc1
    s_add_u32 s93, s26, 2048
    buffer_load_dwordx4 v[136:139], v50, s[16:19], s93 offen sc1
    buffer_load_dwordx4 v[140:143], v51, s[16:19], s93 offen sc1
    s_add_u32 s93, s26, 4096
    buffer_load_dwordx4 v[144:147], v50, s[16:19], s93 offen sc1
    buffer_load_dwordx4 v[148:151], v51, s[16:19], s93 offen sc1
    s_add_u32 s93, s26, 6144
    buffer_load_dwordx4 v[152:155], v50, s[16:19], s93 offen sc1
    buffer_load_dwordx4 v[156:159], v51, s[16:19], s93 offen sc1
    s_add_u32 s93, s26, 8192
    buffer_load_dwordx4 v[160:163], v50, s[16:19], s93 offen sc1
    buffer_load_dwordx4 v[164:167], v51, s[16:19], s93 offen sc1
    ds_read_b128 v[68:71], v53 offset:0
    ds_read_b128 v[72:75], v53 offset:1024
    ds_read_b128 v[76:79], v53 offset:2048
    ds_read_b128 v[80:83], v53 offset:3072
    ds_read_b128 v[84:87], v53 offset:4096
    ds_read_b128 v[88:91], v53 offset:10240
    ds_read_b128 v[92:95], v53 offset:11264
    ds_read_b128 v[96:99], v53 offset:12288
    ds_read_b128 v[100:103], v53 offset:13312
    ds_read_b128 v[104:107], v53 offset:14336
    s_waitcnt vmcnt(8) lgkmcnt(5)
    v_mfma_f32_16x16x32_bf16 v[8:11], v[68:71], v[128:131], v[8:11]
    ds_read_b128 v[108:111], v53 offset:20480
    v_mfma_f32_16x16x32_bf16 v[28:31], v[68:71], v[132:135], v[28:31]
    ds_read_b128 v[112:115], v53 offset:21504
    v_mfma_f32_16x16x32_bf16 v[12:15], v[72:75], v[128:131], v[12:15]
    ds_read_b128 v[116:119], v53 offset:22528
    v_mfma_f32_16x16x32_bf16 v[32:35], v[72:75], v[132:135], v[32:35]
    ds_read_b128 v[120:123], v53 offset:23552
    v_mfma_f32_16x16x32_bf16 v[16:19], v[76:79], v[128:131], v[16:19]
    ds_read_b128 v[124:127], v53 offset:24576
    v_mfma_f32_16x16x32_bf16 v[36:39], v[76:79], v[132:135], v[36:39]
    s_add_u32 s93, s26, 10240
    v_mfma_f32_16x16x32_bf16 v[20:23], v[80:83], v[128:131], v[20:23]
    buffer_load_dwordx4 v[168:171], v50, s[16:19], s93 offen sc1
    v_mfma_f32_16x16x32_bf16 v[40:43], v[80:83], v[132:135], v[40:43]
    buffer_load_dwordx4 v[172:175], v51, s[16:19], s93 offen sc1
    v_mfma_f32_16x16x32_bf16 v[24:27], v[84:87], v[128:131], v[24:27]
    v_mfma_f32_16x16x32_bf16 v[44:47], v[84:87], v[132:135], v[44:47]
    s_waitcnt vmcnt(8) lgkmcnt(5)
    v_mfma_f32_16x16x32_bf16 v[8:11], v[88:91], v[136:139], v[8:11]
    ds_read_b128 v[68:71], v53 offset:30720
    v_mfma_f32_16x16x32_bf16 v[28:31], v[88:91], v[140:143], v[28:31]
    ds_read_b128 v[72:75], v53 offset:31744
    v_mfma_f32_16x16x32_bf16 v[12:15], v[92:95], v[136:139], v[12:15]
    ds_read_b128 v[76:79], v53 offset:32768
    v_mfma_f32_16x16x32_bf16 v[32:35], v[92:95], v[140:143], v[32:35]
    ds_read_b128 v[80:83], v53 offset:33792
    v_mfma_f32_16x16x32_bf16 v[16:19], v[96:99], v[136:139], v[16:19]
    ds_read_b128 v[84:87], v53 offset:34816
    v_mfma_f32_16x16x32_bf16 v[36:39], v[96:99], v[140:143], v[36:39]
    s_add_u32 s93, s26, 12288
    v_mfma_f32_16x16x32_bf16 v[20:23], v[100:103], v[136:139], v[20:23]
    buffer_load_dwordx4 v[128:131], v50, s[16:19], s93 offen sc1
    v_mfma_f32_16x16x32_bf16 v[40:43], v[100:103], v[140:143], v[40:43]
    buffer_load_dwordx4 v[132:135], v51, s[16:19], s93 offen sc1
    v_mfma_f32_16x16x32_bf16 v[24:27], v[104:107], v[136:139], v[24:27]
    v_mfma_f32_16x16x32_bf16 v[44:47], v[104:107], v[140:143], v[44:47]
    s_waitcnt vmcnt(8) lgkmcnt(5)
    v_mfma_f32_16x16x32_bf16 v[8:11], v[108:111], v[144:147], v[8:11]
    ds_read_b128 v[88:91], v53 offset:40960
    v_mfma_f32_16x16x32_bf16 v[28:31], v[108:111], v[148:151], v[28:31]
    ds_read_b128 v[92:95], v53 offset:41984
    v_mfma_f32_16x16x32_bf16 v[12:15], v[112:115], v[144:147], v[12:15]
    ds_read_b128 v[96:99], v53 offset:43008
    v_mfma_f32_16x16x32_bf16 v[32:35], v[112:115], v[148:151], v[32:35]
    ds_read_b128 v[100:103], v53 offset:44032
    v_mfma_f32_16x16x32_bf16 v[16:19], v[116:119], v[144:147], v[16:19]
    ds_read_b128 v[104:107], v53 offset:45056
    v_mfma_f32_16x16x32_bf16 v[36:39], v[116:119], v[148:151], v[36:39]
    s_add_u32 s93, s26, 14336
    v_mfma_f32_16x16x32_bf16 v[20:23], v[120:123], v[144:147], v[20:23]
    buffer_load_dwordx4 v[136:139], v50, s[16:19], s93 offen sc1
    v_mfma_f32_16x16x32_bf16 v[40:43], v[120:123], v[148:151], v[40:43]
    buffer_load_dwordx4 v[140:143], v51, s[16:19], s93 offen sc1
    v_mfma_f32_16x16x32_bf16 v[24:27], v[124:127], v[144:147], v[24:27]
    v_mfma_f32_16x16x32_bf16 v[44:47], v[124:127], v[148:151], v[44:47]
    s_barrier
    s_waitcnt vmcnt(8) lgkmcnt(5)
    v_mfma_f32_16x16x32_bf16 v[8:11], v[68:71], v[152:155], v[8:11]
    ds_read_b128 v[108:111], v53 offset:51200
    v_mfma_f32_16x16x32_bf16 v[28:31], v[68:71], v[156:159], v[28:31]
    ds_read_b128 v[112:115], v53 offset:52224
    v_mfma_f32_16x16x32_bf16 v[12:15], v[72:75], v[152:155], v[12:15]
    ds_read_b128 v[116:119], v53 offset:53248
    v_mfma_f32_16x16x32_bf16 v[32:35], v[72:75], v[156:159], v[32:35]
    ds_read_b128 v[120:123], v53 offset:54272
    v_mfma_f32_16x16x32_bf16 v[16:19], v[76:79], v[152:155], v[16:19]
    ds_read_b128 v[124:127], v53 offset:55296
    v_mfma_f32_16x16x32_bf16 v[36:39], v[76:79], v[156:159], v[36:39]
    s_add_u32 s93, s26, 16384
    v_mfma_f32_16x16x32_bf16 v[20:23], v[80:83], v[152:155], v[20:23]
    buffer_load_dwordx4 v[144:147], v50, s[16:19], s93 offen sc1
    v_mfma_f32_16x16x32_bf16 v[40:43], v[80:83], v[156:159], v[40:43]
    buffer_load_dwordx4 v[148:151], v51, s[16:19], s93 offen sc1
    v_mfma_f32_16x16x32_bf16 v[24:27], v[84:87], v[152:155], v[24:27]
    v_mfma_f32_16x16x32_bf16 v[44:47], v[84:87], v[156:159], v[44:47]
    s_waitcnt vmcnt(8) lgkmcnt(5)
    v_mfma_f32_16x16x32_bf16 v[8:11], v[88:91], v[160:163], v[8:11]
    ds_read_b128 v[68:71], v54 offset:0
    v_mfma_f32_16x16x32_bf16 v[28:31], v[88:91], v[164:167], v[28:31]
    ds_read_b128 v[72:75], v54 offset:1024
    v_mfma_f32_16x16x32_bf16 v[12:15], v[92:95], v[160:163], v[12:15]
    ds_read_b128 v[76:79], v54 offset:2048
    v_mfma_f32_16x16x32_bf16 v[32:35], v[92:95], v[164:167], v[32:35]
    ds_read_b128 v[80:83], v54 offset:3072
    v_mfma_f32_16x16x32_bf16 v[16:19], v[96:99], v[160:163], v[16:19]
    ds_read_b128 v[84:87], v54 offset:4096
    v_mfma_f32_16x16x32_bf16 v[36:39], v[96:99], v[164:167], v[36:39]
    s_add_u32 s93, s26, 18432
    v_mfma_f32_16x16x32_bf16 v[20:23], v[100:103], v[160:163], v[20:23]
    buffer_load_dwordx4 v[152:155], v50, s[16:19], s93 offen sc1
    v_mfma_f32_16x16x32_bf16 v[40:43], v[100:103], v[164:167], v[40:43]
    buffer_load_dwordx4 v[156:159], v51, s[16:19], s93 offen sc1
    v_mfma_f32_16x16x32_bf16 v[24:27], v[104:107], v[160:163], v[24:27]
    v_mfma_f32_16x16x32_bf16 v[44:47], v[104:107], v[164:167], v[44:47]
    s_waitcnt vmcnt(8) lgkmcnt(5)
    v_mfma_f32_16x16x32_bf16 v[8:11], v[108:111], v[168:171], v[8:11]
    ds_read_b128 v[88:91], v54 offset:10240
    v_mfma_f32_16x16x32_bf16 v[28:31], v[108:111], v[172:175], v[28:31]
    ds_read_b128 v[92:95], v54 offset:11264
    v_mfma_f32_16x16x32_bf16 v[12:15], v[112:115], v[168:171], v[12:15]
    ds_read_b128 v[96:99], v54 offset:12288
    v_mfma_f32_16x16x32_bf16 v[32:35], v[112:115], v[172:175], v[32:35]
    ds_read_b128 v[100:103], v54 offset:13312
    v_mfma_f32_16x16x32_bf16 v[16:19], v[116:119], v[168:171], v[16:19]
    ds_read_b128 v[104:107], v54 offset:14336
    v_mfma_f32_16x16x32_bf16 v[36:39], v[116:119], v[172:175], v[36:39]
    s_add_u32 s93, s26, 20480
    v_mfma_f32_16x16x32_bf16 v[20:23], v[120:123], v[168:171], v[20:23]
    buffer_load_dwordx4 v[160:163], v50, s[16:19], s93 offen sc1
    v_mfma_f32_16x16x32_bf16 v[40:43], v[120:123], v[172:175], v[40:43]
    buffer_load_dwordx4 v[164:167], v51, s[16:19], s93 offen sc1
    v_mfma_f32_16x16x32_bf16 v[24:27], v[124:127], v[168:171], v[24:27]
    v_mfma_f32_16x16x32_bf16 v[44:47], v[124:127], v[172:175], v[44:47]
    s_barrier
    s_waitcnt vmcnt(8) lgkmcnt(5)
    v_mfma_f32_16x16x32_bf16 v[8:11], v[68:71], v[128:131], v[8:11]
    ds_read_b128 v[108:111], v54 offset:20480
    v_mfma_f32_16x16x32_bf16 v[28:31], v[68:71], v[132:135], v[28:31]
    ds_read_b128 v[112:115], v54 offset:21504
    v_mfma_f32_16x16x32_bf16 v[12:15], v[72:75], v[128:131], v[12:15]
    ds_read_b128 v[116:119], v54 offset:22528
    v_mfma_f32_16x16x32_bf16 v[32:35], v[72:75], v[132:135], v[32:35]
    ds_read_b128 v[120:123], v54 offset:23552
    v_mfma_f32_16x16x32_bf16 v[16:19], v[76:79], v[128:131], v[16:19]
    ds_read_b128 v[124:127], v54 offset:24576
    v_mfma_f32_16x16x32_bf16 v[36:39], v[76:79], v[132:135], v[36:39]
    s_add_u32 s93, s26, 22528
    v_mfma_f32_16x16x32_bf16 v[20:23], v[80:83], v[128:131], v[20:23]
    buffer_load_dwordx4 v[168:171], v50, s[16:19], s93 offen sc1
    v_mfma_f32_16x16x32_bf16 v[40:43], v[80:83], v[132:135], v[40:43]
    buffer_load_dwordx4 v[172:175], v51, s[16:19], s93 offen sc1
    v_mfma_f32_16x16x32_bf16 v[24:27], v[84:87], v[128:131], v[24:27]
    v_mfma_f32_16x16x32_bf16 v[44:47], v[84:87], v[132:135], v[44:47]
    s_waitcnt vmcnt(8) lgkmcnt(5)
    v_mfma_f32_16x16x32_bf16 v[8:11], v[88:91], v[136:139], v[8:11]
    ds_read_b128 v[68:71], v54 offset:30720
    v_mfma_f32_16x16x32_bf16 v[28:31], v[88:91], v[140:143], v[28:31]
    ds_read_b128 v[72:75], v54 offset:31744
    v_mfma_f32_16x16x32_bf16 v[12:15], v[92:95], v[136:139], v[12:15]
    ds_read_b128 v[76:79], v54 offset:32768
    v_mfma_f32_16x16x32_bf16 v[32:35], v[92:95], v[140:143], v[32:35]
    ds_read_b128 v[80:83], v54 offset:33792
    v_mfma_f32_16x16x32_bf16 v[16:19], v[96:99], v[136:139], v[16:19]
    ds_read_b128 v[84:87], v54 offset:34816
    v_mfma_f32_16x16x32_bf16 v[36:39], v[96:99], v[140:143], v[36:39]
    s_add_u32 s93, s26, 24576
    v_mfma_f32_16x16x32_bf16 v[20:23], v[100:103], v[136:139], v[20:23]
    buffer_load_dwordx4 v[128:131], v50, s[16:19], s93 offen sc1
    v_mfma_f32_16x16x32_bf16 v[40:43], v[100:103], v[140:143], v[40:43]
    buffer_load_dwordx4 v[132:135], v51, s[16:19], s93 offen sc1
    v_mfma_f32_16x16x32_bf16 v[24:27], v[104:107], v[136:139], v[24:27]
    v_mfma_f32_16x16x32_bf16 v[44:47], v[104:107], v[140:143], v[44:47]
    s_waitcnt vmcnt(8) lgkmcnt(5)
    v_mfma_f32_16x16x32_bf16 v[8:11], v[108:111], v[144:147], v[8:11]
    ds_read_b128 v[88:91], v54 offset:40960
    v_mfma_f32_16x16x32_bf16 v[28:31], v[108:111], v[148:151], v[28:31]
    ds_read_b128 v[92:95], v54 offset:41984
    v_mfma_f32_16x16x32_bf16 v[12:15], v[112:115], v[144:147], v[12:15]
    ds_read_b128 v[96:99], v54 offset:43008
    v_mfma_f32_16x16x32_bf16 v[32:35], v[112:115], v[148:151], v[32:35]
    ds_read_b128 v[100:103], v54 offset:44032
    v_mfma_f32_16x16x32_bf16 v[16:19], v[116:119], v[144:147], v[16:19]
    ds_read_b128 v[104:107], v54 offset:45056
    v_mfma_f32_16x16x32_bf16 v[36:39], v[116:119], v[148:151], v[36:39]
    s_add_u32 s93, s26, 26624
    v_mfma_f32_16x16x32_bf16 v[20:23], v[120:123], v[144:147], v[20:23]
    buffer_load_dwordx4 v[136:139], v50, s[16:19], s93 offen sc1
    v_mfma_f32_16x16x32_bf16 v[40:43], v[120:123], v[148:151], v[40:43]
    buffer_load_dwordx4 v[140:143], v51, s[16:19], s93 offen sc1
    v_mfma_f32_16x16x32_bf16 v[24:27], v[124:127], v[144:147], v[24:27]
    v_mfma_f32_16x16x32_bf16 v[44:47], v[124:127], v[148:151], v[44:47]
    s_barrier
    s_waitcnt vmcnt(8) lgkmcnt(5)
    v_mfma_f32_16x16x32_bf16 v[8:11], v[68:71], v[152:155], v[8:11]
    ds_read_b128 v[108:111], v54 offset:51200
    v_mfma_f32_16x16x32_bf16 v[28:31], v[68:71], v[156:159], v[28:31]
    ds_read_b128 v[112:115], v54 offset:52224
    v_mfma_f32_16x16x32_bf16 v[12:15], v[72:75], v[152:155], v[12:15]
    ds_read_b128 v[116:119], v54 offset:53248
    v_mfma_f32_16x16x32_bf16 v[32:35], v[72:75], v[156:159], v[32:35]
    ds_read_b128 v[120:123], v54 offset:54272
    v_mfma_f32_16x16x32_bf16 v[16:19], v[76:79], v[152:155], v[16:19]
    ds_read_b128 v[124:127], v54 offset:55296
    v_mfma_f32_16x16x32_bf16 v[36:39], v[76:79], v[156:159], v[36:39]
    s_add_u32 s93, s26, 28672
    v_mfma_f32_16x16x32_bf16 v[20:23], v[80:83], v[152:155], v[20:23]
    buffer_load_dwordx4 v[144:147], v50, s[16:19], s93 offen sc1
    v_mfma_f32_16x16x32_bf16 v[40:43], v[80:83], v[156:159], v[40:43]
    buffer_load_dwordx4 v[148:151], v51, s[16:19], s93 offen sc1
    v_mfma_f32_16x16x32_bf16 v[24:27], v[84:87], v[152:155], v[24:27]
    v_mfma_f32_16x16x32_bf16 v[44:47], v[84:87], v[156:159], v[44:47]
    s_waitcnt vmcnt(8) lgkmcnt(5)
    v_mfma_f32_16x16x32_bf16 v[8:11], v[88:91], v[160:163], v[8:11]
    ds_read_b128 v[68:71], v55 offset:0
    v_mfma_f32_16x16x32_bf16 v[28:31], v[88:91], v[164:167], v[28:31]
    ds_read_b128 v[72:75], v55 offset:1024
    v_mfma_f32_16x16x32_bf16 v[12:15], v[92:95], v[160:163], v[12:15]
    ds_read_b128 v[76:79], v55 offset:2048
    v_mfma_f32_16x16x32_bf16 v[32:35], v[92:95], v[164:167], v[32:35]
    ds_read_b128 v[80:83], v55 offset:3072
    v_mfma_f32_16x16x32_bf16 v[16:19], v[96:99], v[160:163], v[16:19]
    ds_read_b128 v[84:87], v55 offset:4096
    v_mfma_f32_16x16x32_bf16 v[36:39], v[96:99], v[164:167], v[36:39]
    s_add_u32 s93, s26, 30720
    v_mfma_f32_16x16x32_bf16 v[20:23], v[100:103], v[160:163], v[20:23]
    buffer_load_dwordx4 v[152:155], v50, s[16:19], s93 offen sc1
    v_mfma_f32_16x16x32_bf16 v[40:43], v[100:103], v[164:167], v[40:43]
    buffer_load_dwordx4 v[156:159], v51, s[16:19], s93 offen sc1
    v_mfma_f32_16x16x32_bf16 v[24:27], v[104:107], v[160:163], v[24:27]
    v_mfma_f32_16x16x32_bf16 v[44:47], v[104:107], v[164:167], v[44:47]
    s_waitcnt vmcnt(8) lgkmcnt(5)
    v_mfma_f32_16x16x32_bf16 v[8:11], v[108:111], v[168:171], v[8:11]
    ds_read_b128 v[88:91], v55 offset:10240
    v_mfma_f32_16x16x32_bf16 v[28:31], v[108:111], v[172:175], v[28:31]
    ds_read_b128 v[92:95], v55 offset:11264
    v_mfma_f32_16x16x32_bf16 v[12:15], v[112:115], v[168:171], v[12:15]
    ds_read_b128 v[96:99], v55 offset:12288
    v_mfma_f32_16x16x32_bf16 v[32:35], v[112:115], v[172:175], v[32:35]
    ds_read_b128 v[100:103], v55 offset:13312
    v_mfma_f32_16x16x32_bf16 v[16:19], v[116:119], v[168:171], v[16:19]
    ds_read_b128 v[104:107], v55 offset:14336
    v_mfma_f32_16x16x32_bf16 v[36:39], v[116:119], v[172:175], v[36:39]
    s_add_u32 s93, s26, 32768
    v_mfma_f32_16x16x32_bf16 v[20:23], v[120:123], v[168:171], v[20:23]
    buffer_load_dwordx4 v[160:163], v50, s[16:19], s93 offen sc1
    v_mfma_f32_16x16x32_bf16 v[40:43], v[120:123], v[172:175], v[40:43]
    buffer_load_dwordx4 v[164:167], v51, s[16:19], s93 offen sc1
    v_mfma_f32_16x16x32_bf16 v[24:27], v[124:127], v[168:171], v[24:27]
    v_mfma_f32_16x16x32_bf16 v[44:47], v[124:127], v[172:175], v[44:47]
    s_waitcnt vmcnt(8) lgkmcnt(5)
    v_mfma_f32_16x16x32_bf16 v[8:11], v[68:71], v[128:131], v[8:11]
    ds_read_b128 v[108:111], v55 offset:20480
    v_mfma_f32_16x16x32_bf16 v[28:31], v[68:71], v[132:135], v[28:31]
    ds_read_b128 v[112:115], v55 offset:21504
    v_mfma_f32_16x16x32_bf16 v[12:15], v[72:75], v[128:131], v[12:15]
    ds_read_b128 v[116:119], v55 offset:22528
    v_mfma_f32_16x16x32_bf16 v[32:35], v[72:75], v[132:135], v[32:35]
    ds_read_b128 v[120:123], v55 offset:23552
    v_mfma_f32_16x16x32_bf16 v[16:19], v[76:79], v[128:131], v[16:19]
    ds_read_b128 v[124:127], v55 offset:24576
    v_mfma_f32_16x16x32_bf16 v[36:39], v[76:79], v[132:135], v[36:39]
    s_add_u32 s93, s26, 34816
    v_mfma_f32_16x16x32_bf16 v[20:23], v[80:83], v[128:131], v[20:23]
    buffer_load_dwordx4 v[168:171], v50, s[16:19], s93 offen sc1
    v_mfma_f32_16x16x32_bf16 v[40:43], v[80:83], v[132:135], v[40:43]
    buffer_load_dwordx4 v[172:175], v51, s[16:19], s93 offen sc1
    v_mfma_f32_16x16x32_bf16 v[24:27], v[84:87], v[128:131], v[24:27]
    v_mfma_f32_16x16x32_bf16 v[44:47], v[84:87], v[132:135], v[44:47]
    s_barrier
    s_waitcnt vmcnt(8) lgkmcnt(5)
    v_mfma_f32_16x16x32_bf16 v[8:11], v[88:91], v[136:139], v[8:11]
    ds_read_b128 v[68:71], v53 offset:0
    v_mfma_f32_16x16x32_bf16 v[28:31], v[88:91], v[140:143], v[28:31]
    ds_read_b128 v[72:75], v53 offset:1024
    v_mfma_f32_16x16x32_bf16 v[12:15], v[92:95], v[136:139], v[12:15]
    ds_read_b128 v[76:79], v53 offset:2048
    v_mfma_f32_16x16x32_bf16 v[32:35], v[92:95], v[140:143], v[32:35]
    ds_read_b128 v[80:83], v53 offset:3072
    v_mfma_f32_16x16x32_bf16 v[16:19], v[96:99], v[136:139], v[16:19]
    ds_read_b128 v[84:87], v53 offset:4096
    v_mfma_f32_16x16x32_bf16 v[36:39], v[96:99], v[140:143], v[36:39]
    s_add_u32 s93, s26, 36864
    v_mfma_f32_16x16x32_bf16 v[20:23], v[100:103], v[136:139], v[20:23]
    buffer_load_dwordx4 v[128:131], v50, s[16:19], s93 offen sc1
    v_mfma_f32_16x16x32_bf16 v[40:43], v[100:103], v[140:143], v[40:43]
    buffer_load_dwordx4 v[132:135], v51, s[16:19], s93 offen sc1
    v_mfma_f32_16x16x32_bf16 v[24:27], v[104:107], v[136:139], v[24:27]
    v_mfma_f32_16x16x32_bf16 v[44:47], v[104:107], v[140:143], v[44:47]
    s_waitcnt vmcnt(8) lgkmcnt(5)
    v_mfma_f32_16x16x32_bf16 v[8:11], v[108:111], v[144:147], v[8:11]
    ds_read_b128 v[88:91], v53 offset:10240
    v_mfma_f32_16x16x32_bf16 v[28:31], v[108:111], v[148:151], v[28:31]
    ds_read_b128 v[92:95], v53 offset:11264
    v_mfma_f32_16x16x32_bf16 v[12:15], v[112:115], v[144:147], v[12:15]
    ds_read_b128 v[96:99], v53 offset:12288
    v_mfma_f32_16x16x32_bf16 v[32:35], v[112:115], v[148:151], v[32:35]
    ds_read_b128 v[100:103], v53 offset:13312
    v_mfma_f32_16x16x32_bf16 v[16:19], v[116:119], v[144:147], v[16:19]
    ds_read_b128 v[104:107], v53 offset:14336
    v_mfma_f32_16x16x32_bf16 v[36:39], v[116:119], v[148:151], v[36:39]
    s_add_u32 s93, s26, 38912
    v_mfma_f32_16x16x32_bf16 v[20:23], v[120:123], v[144:147], v[20:23]
    buffer_load_dwordx4 v[136:139], v50, s[16:19], s93 offen sc1
    v_mfma_f32_16x16x32_bf16 v[40:43], v[120:123], v[148:151], v[40:43]
    buffer_load_dwordx4 v[140:143], v51, s[16:19], s93 offen sc1
    v_mfma_f32_16x16x32_bf16 v[24:27], v[124:127], v[144:147], v[24:27]
    v_mfma_f32_16x16x32_bf16 v[44:47], v[124:127], v[148:151], v[44:47]
    s_waitcnt vmcnt(8) lgkmcnt(5)
    v_mfma_f32_16x16x32_bf16 v[8:11], v[68:71], v[152:155], v[8:11]
    ds_read_b128 v[108:111], v53 offset:20480
    v_mfma_f32_16x16x32_bf16 v[28:31], v[68:71], v[156:159], v[28:31]
    ds_read_b128 v[112:115], v53 offset:21504
    v_mfma_f32_16x16x32_bf16 v[12:15], v[72:75], v[152:155], v[12:15]
    ds_read_b128 v[116:119], v53 offset:22528
    v_mfma_f32_16x16x32_bf16 v[32:35], v[72:75], v[156:159], v[32:35]
    ds_read_b128 v[120:123], v53 offset:23552
    v_mfma_f32_16x16x32_bf16 v[16:19], v[76:79], v[152:155], v[16:19]
    ds_read_b128 v[124:127], v53 offset:24576
    v_mfma_f32_16x16x32_bf16 v[36:39], v[76:79], v[156:159], v[36:39]
    s_add_u32 s93, s26, 40960
    v_mfma_f32_16x16x32_bf16 v[20:23], v[80:83], v[152:155], v[20:23]
    buffer_load_dwordx4 v[144:147], v50, s[16:19], s93 offen sc1
    v_mfma_f32_16x16x32_bf16 v[40:43], v[80:83], v[156:159], v[40:43]
    buffer_load_dwordx4 v[148:151], v51, s[16:19], s93 offen sc1
    v_mfma_f32_16x16x32_bf16 v[24:27], v[84:87], v[152:155], v[24:27]
    v_mfma_f32_16x16x32_bf16 v[44:47], v[84:87], v[156:159], v[44:47]
    s_barrier
    s_waitcnt vmcnt(8) lgkmcnt(5)
    v_mfma_f32_16x16x32_bf16 v[8:11], v[88:91], v[160:163], v[8:11]
    ds_read_b128 v[68:71], v53 offset:30720
    v_mfma_f32_16x16x32_bf16 v[28:31], v[88:91], v[164:167], v[28:31]
    ds_read_b128 v[72:75], v53 offset:31744
    v_mfma_f32_16x16x32_bf16 v[12:15], v[92:95], v[160:163], v[12:15]
    ds_read_b128 v[76:79], v53 offset:32768
    v_mfma_f32_16x16x32_bf16 v[32:35], v[92:95], v[164:167], v[32:35]
    ds_read_b128 v[80:83], v53 offset:33792
    v_mfma_f32_16x16x32_bf16 v[16:19], v[96:99], v[160:163], v[16:19]
    ds_read_b128 v[84:87], v53 offset:34816
    v_mfma_f32_16x16x32_bf16 v[36:39], v[96:99], v[164:167], v[36:39]
    s_add_u32 s93, s26, 43008
    v_mfma_f32_16x16x32_bf16 v[20:23], v[100:103], v[160:163], v[20:23]
    buffer_load_dwordx4 v[152:155], v50, s[16:19], s93 offen sc1
    v_mfma_f32_16x16x32_bf16 v[40:43], v[100:103], v[164:167], v[40:43]
    buffer_load_dwordx4 v[156:159], v51, s[16:19], s93 offen sc1
    v_mfma_f32_16x16x32_bf16 v[24:27], v[104:107], v[160:163], v[24:27]
    v_mfma_f32_16x16x32_bf16 v[44:47], v[104:107], v[164:167], v[44:47]
    s_waitcnt vmcnt(8) lgkmcnt(5)
    v_mfma_f32_16x16x32_bf16 v[8:11], v[108:111], v[168:171], v[8:11]
    ds_read_b128 v[88:91], v53 offset:40960
    v_mfma_f32_16x16x32_bf16 v[28:31], v[108:111], v[172:175], v[28:31]
    ds_read_b128 v[92:95], v53 offset:41984
    v_mfma_f32_16x16x32_bf16 v[12:15], v[112:115], v[168:171], v[12:15]
    ds_read_b128 v[96:99], v53 offset:43008
    v_mfma_f32_16x16x32_bf16 v[32:35], v[112:115], v[172:175], v[32:35]
    ds_read_b128 v[100:103], v53 offset:44032
    v_mfma_f32_16x16x32_bf16 v[16:19], v[116:119], v[168:171], v[16:19]
    ds_read_b128 v[104:107], v53 offset:45056
    v_mfma_f32_16x16x32_bf16 v[36:39], v[116:119], v[172:175], v[36:39]
    s_add_u32 s93, s26, 45056
    v_mfma_f32_16x16x32_bf16 v[20:23], v[120:123], v[168:171], v[20:23]
    buffer_load_dwordx4 v[160:163], v50, s[16:19], s93 offen sc1
    v_mfma_f32_16x16x32_bf16 v[40:43], v[120:123], v[172:175], v[40:43]
    buffer_load_dwordx4 v[164:167], v51, s[16:19], s93 offen sc1
    v_mfma_f32_16x16x32_bf16 v[24:27], v[124:127], v[168:171], v[24:27]
    v_mfma_f32_16x16x32_bf16 v[44:47], v[124:127], v[172:175], v[44:47]
    s_waitcnt vmcnt(8) lgkmcnt(5)
    v_mfma_f32_16x16x32_bf16 v[8:11], v[68:71], v[128:131], v[8:11]
    ds_read_b128 v[108:111], v53 offset:51200
    v_mfma_f32_16x16x32_bf16 v[28:31], v[68:71], v[132:135], v[28:31]
    ds_read_b128 v[112:115], v53 offset:52224
    v_mfma_f32_16x16x32_bf16 v[12:15], v[72:75], v[128:131], v[12:15]
    ds_read_b128 v[116:119], v53 offset:53248
    v_mfma_f32_16x16x32_bf16 v[32:35], v[72:75], v[132:135], v[32:35]
    ds_read_b128 v[120:123], v53 offset:54272
    v_mfma_f32_16x16x32_bf16 v[16:19], v[76:79], v[128:131], v[16:19]
    ds_read_b128 v[124:127], v53 offset:55296
    v_mfma_f32_16x16x32_bf16 v[36:39], v[76:79], v[132:135], v[36:39]
    s_add_u32 s93, s26, 47104
    v_mfma_f32_16x16x32_bf16 v[20:23], v[80:83], v[128:131], v[20:23]
    buffer_load_dwordx4 v[168:171], v50, s[16:19], s93 offen sc1
    v_mfma_f32_16x16x32_bf16 v[40:43], v[80:83], v[132:135], v[40:43]
    buffer_load_dwordx4 v[172:175], v51, s[16:19], s93 offen sc1
    v_mfma_f32_16x16x32_bf16 v[24:27], v[84:87], v[128:131], v[24:27]
    v_mfma_f32_16x16x32_bf16 v[44:47], v[84:87], v[132:135], v[44:47]
    s_barrier
    s_waitcnt vmcnt(8) lgkmcnt(5)
    v_mfma_f32_16x16x32_bf16 v[8:11], v[88:91], v[136:139], v[8:11]
    ds_read_b128 v[68:71], v54 offset:0
    v_mfma_f32_16x16x32_bf16 v[28:31], v[88:91], v[140:143], v[28:31]
    ds_read_b128 v[72:75], v54 offset:1024
    v_mfma_f32_16x16x32_bf16 v[12:15], v[92:95], v[136:139], v[12:15]
    ds_read_b128 v[76:79], v54 offset:2048
    v_mfma_f32_16x16x32_bf16 v[32:35], v[92:95], v[140:143], v[32:35]
    ds_read_b128 v[80:83], v54 offset:3072
    v_mfma_f32_16x16x32_bf16 v[16:19], v[96:99], v[136:139], v[16:19]
    ds_read_b128 v[84:87], v54 offset:4096
    v_mfma_f32_16x16x32_bf16 v[36:39], v[96:99], v[140:143], v[36:39]
    v_mfma_f32_16x16x32_bf16 v[20:23], v[100:103], v[136:139], v[20:23]
    v_mfma_f32_16x16x32_bf16 v[40:43], v[100:103], v[140:143], v[40:43]
    v_mfma_f32_16x16x32_bf16 v[24:27], v[104:107], v[136:139], v[24:27]
    v_mfma_f32_16x16x32_bf16 v[44:47], v[104:107], v[140:143], v[44:47]
    s_waitcnt vmcnt(6) lgkmcnt(5)
    v_mfma_f32_16x16x32_bf16 v[8:11], v[108:111], v[144:147], v[8:11]
    ds_read_b128 v[88:91], v54 offset:10240
    v_mfma_f32_16x16x32_bf16 v[28:31], v[108:111], v[148:151], v[28:31]
    ds_read_b128 v[92:95], v54 offset:11264
    v_mfma_f32_16x16x32_bf16 v[12:15], v[112:115], v[144:147], v[12:15]
    ds_read_b128 v[96:99], v54 offset:12288
    v_mfma_f32_16x16x32_bf16 v[32:35], v[112:115], v[148:151], v[32:35]
    ds_read_b128 v[100:103], v54 offset:13312
    v_mfma_f32_16x16x32_bf16 v[16:19], v[116:119], v[144:147], v[16:19]
    ds_read_b128 v[104:107], v54 offset:14336
    v_mfma_f32_16x16x32_bf16 v[36:39], v[116:119], v[148:151], v[36:39]
    v_mfma_f32_16x16x32_bf16 v[20:23], v[120:123], v[144:147], v[20:23]
    v_mfma_f32_16x16x32_bf16 v[40:43], v[120:123], v[148:151], v[40:43]
    v_mfma_f32_16x16x32_bf16 v[24:27], v[124:127], v[144:147], v[24:27]
    v_mfma_f32_16x16x32_bf16 v[44:47], v[124:127], v[148:151], v[44:47]
    s_waitcnt vmcnt(4) lgkmcnt(5)
    v_mfma_f32_16x16x32_bf16 v[8:11], v[68:71], v[152:155], v[8:11]
    ds_read_b128 v[108:111], v54 offset:20480
    v_mfma_f32_16x16x32_bf16 v[28:31], v[68:71], v[156:159], v[28:31]
    ds_read_b128 v[112:115], v54 offset:21504
    v_mfma_f32_16x16x32_bf16 v[12:15], v[72:75], v[152:155], v[12:15]
    ds_read_b128 v[116:119], v54 offset:22528
    v_mfma_f32_16x16x32_bf16 v[32:35], v[72:75], v[156:159], v[32:35]
    ds_read_b128 v[120:123], v54 offset:23552
    v_mfma_f32_16x16x32_bf16 v[16:19], v[76:79], v[152:155], v[16:19]
    ds_read_b128 v[124:127], v54 offset:24576
    v_mfma_f32_16x16x32_bf16 v[36:39], v[76:79], v[156:159], v[36:39]
    v_mfma_f32_16x16x32_bf16 v[20:23], v[80:83], v[152:155], v[20:23]
    v_mfma_f32_16x16x32_bf16 v[40:43], v[80:83], v[156:159], v[40:43]
    v_mfma_f32_16x16x32_bf16 v[24:27], v[84:87], v[152:155], v[24:27]
    v_mfma_f32_16x16x32_bf16 v[44:47], v[84:87], v[156:159], v[44:47]
    s_waitcnt vmcnt(2) lgkmcnt(5)
    v_mfma_f32_16x16x32_bf16 v[8:11], v[88:91], v[160:163], v[8:11]
    v_mfma_f32_16x16x32_bf16 v[28:31], v[88:91], v[164:167], v[28:31]
    v_mfma_f32_16x16x32_bf16 v[12:15], v[92:95], v[160:163], v[12:15]
    v_mfma_f32_16x16x32_bf16 v[32:35], v[92:95], v[164:167], v[32:35]
    v_mfma_f32_16x16x32_bf16 v[16:19], v[96:99], v[160:163], v[16:19]
    v_mfma_f32_16x16x32_bf16 v[36:39], v[96:99], v[164:167], v[36:39]
    v_mfma_f32_16x16x32_bf16 v[20:23], v[100:103], v[160:163], v[20:23]
    v_mfma_f32_16x16x32_bf16 v[40:43], v[100:103], v[164:167], v[40:43]
    v_mfma_f32_16x16x32_bf16 v[24:27], v[104:107], v[160:163], v[24:27]
    v_mfma_f32_16x16x32_bf16 v[44:47], v[104:107], v[164:167], v[44:47]
    s_waitcnt vmcnt(0) lgkmcnt(0)
    v_mfma_f32_16x16x32_bf16 v[8:11], v[108:111], v[168:171], v[8:11]
    v_mfma_f32_16x16x32_bf16 v[28:31], v[108:111], v[172:175], v[28:31]
    v_mfma_f32_16x16x32_bf16 v[12:15], v[112:115], v[168:171], v[12:15]
    v_mfma_f32_16x16x32_bf16 v[32:35], v[112:115], v[172:175], v[32:35]
    v_mfma_f32_16x16x32_bf16 v[16:19], v[116:119], v[168:171], v[16:19]
    v_mfma_f32_16x16x32_bf16 v[36:39], v[116:119], v[172:175], v[36:39]
    v_mfma_f32_16x16x32_bf16 v[20:23], v[120:123], v[168:171], v[20:23]
    v_mfma_f32_16x16x32_bf16 v[40:43], v[120:123], v[172:175], v[40:43]
    v_mfma_f32_16x16x32_bf16 v[24:27], v[124:127], v[168:171], v[24:27]
    v_mfma_f32_16x16x32_bf16 v[44:47], v[124:127], v[172:175], v[44:47]
    s_waitcnt lgkmcnt(0)
    s_barrier
    s_mul_i32 s27, s21, 5120
    s_add_u32 s27, s27, 0
    v_add_u32 v3, s27, v2
    ds_write_b128 v3, v[28:31] offset:0
    ds_write_b128 v3, v[32:35] offset:1024
    ds_write_b128 v3, v[36:39] offset:2048
    ds_write_b128 v3, v[40:43] offset:3072
    ds_write_b128 v3, v[44:47] offset:4096
    s_waitcnt lgkmcnt(0)
    s_barrier
    s_xor_b32 s27, s21, 1
    s_mul_i32 s27, s27, 5120
    s_add_u32 s27, s27, 0
    v_add_u32 v3, s27, v2
    ds_read_b128 v[28:31], v3 offset:0
    ds_read_b128 v[32:35], v3 offset:1024
    ds_read_b128 v[36:39], v3 offset:2048
    ds_read_b128 v[40:43], v3 offset:3072
    ds_read_b128 v[44:47], v3 offset:4096
    s_lshl_b32 s27, s32, 5
    s_lshl_b32 s28, s33, 4
    s_add_u32 s27, s27, s28
    v_add_u32 v176, s27, v48
    v_mul_u32_u24 v4, 160, v176
    v_lshl_add_u32 v4, v49, 3, v4
    v_add_u32 v4, 40960, v4
    s_waitcnt vmcnt(0) lgkmcnt(0)
    v_add_f32 v8, v8, v28
    v_add_f32 v9, v9, v29
    v_add_f32 v10, v10, v30
    v_add_f32 v11, v11, v31
    v_lshlrev_b32 v5, 16, v56
    v_and_b32 v6, 0xffff0000, v56
    v_add_f32 v8, v8, v5
    v_add_f32 v9, v9, v6
    v_lshlrev_b32 v5, 16, v57
    v_and_b32 v6, 0xffff0000, v57
    v_add_f32 v10, v10, v5
    v_add_f32 v11, v11, v6
    v_cvt_pk_bf16_f32 v178, v8, v9
    v_cvt_pk_bf16_f32 v179, v10, v11
    ds_write_b64 v4, v[178:179] offset:0
    v_add_f32 v12, v12, v32
    v_add_f32 v13, v13, v33
    v_add_f32 v14, v14, v34
    v_add_f32 v15, v15, v35
    v_lshlrev_b32 v5, 16, v58
    v_and_b32 v6, 0xffff0000, v58
    v_add_f32 v12, v12, v5
    v_add_f32 v13, v13, v6
    v_lshlrev_b32 v5, 16, v59
    v_and_b32 v6, 0xffff0000, v59
    v_add_f32 v14, v14, v5
    v_add_f32 v15, v15, v6
    v_cvt_pk_bf16_f32 v180, v12, v13
    v_cvt_pk_bf16_f32 v181, v14, v15
    ds_write_b64 v4, v[180:181] offset:32
    v_add_f32 v16, v16, v36
    v_add_f32 v17, v17, v37
    v_add_f32 v18, v18, v38
    v_add_f32 v19, v19, v39
    v_lshlrev_b32 v5, 16, v60
    v_and_b32 v6, 0xffff0000, v60
    v_add_f32 v16, v16, v5
    v_add_f32 v17, v17, v6
    v_lshlrev_b32 v5, 16, v61
    v_and_b32 v6, 0xffff0000, v61
    v_add_f32 v18, v18, v5
    v_add_f32 v19, v19, v6
    v_cvt_pk_bf16_f32 v182, v16, v17
    v_cvt_pk_bf16_f32 v183, v18, v19
    ds_write_b64 v4, v[182:183] offset:64
    v_add_f32 v20, v20, v40
    v_add_f32 v21, v21, v41
    v_add_f32 v22, v22, v42
    v_add_f32 v23, v23, v43
    v_lshlrev_b32 v5, 16, v62
    v_and_b32 v6, 0xffff0000, v62
    v_add_f32 v20, v20, v5
    v_add_f32 v21, v21, v6
    v_lshlrev_b32 v5, 16, v63
    v_and_b32 v6, 0xffff0000, v63
    v_add_f32 v22, v22, v5
    v_add_f32 v23, v23, v6
    v_cvt_pk_bf16_f32 v184, v20, v21
    v_cvt_pk_bf16_f32 v185, v22, v23
    ds_write_b64 v4, v[184:185] offset:96
    v_add_f32 v24, v24, v44
    v_add_f32 v25, v25, v45
    v_add_f32 v26, v26, v46
    v_add_f32 v27, v27, v47
    v_lshlrev_b32 v5, 16, v64
    v_and_b32 v6, 0xffff0000, v64
    v_add_f32 v24, v24, v5
    v_add_f32 v25, v25, v6
    v_lshlrev_b32 v5, 16, v65
    v_and_b32 v6, 0xffff0000, v65
    v_add_f32 v26, v26, v5
    v_add_f32 v27, v27, v6
    v_cvt_pk_bf16_f32 v186, v24, v25
    v_cvt_pk_bf16_f32 v187, v26, v27
    ds_write_b64 v4, v[186:187] offset:128
    s_waitcnt lgkmcnt(0)
    s_barrier
L_w2_done:
L_done:
L_exit:
    s_endpgm
.section .rodata,"a"
.p2align 6
.amdhsa_kernel sequential_preLN__softmax_full_mha__dense_activation_silu__prompt_kernel
  .amdhsa_next_free_vgpr 256
  .amdhsa_next_free_sgpr 102
  .amdhsa_accum_offset 256
  .amdhsa_group_segment_fixed_size 0
  .amdhsa_kernarg_size 72
  .amdhsa_user_sgpr_count 2
  .amdhsa_user_sgpr_kernarg_segment_ptr 1
  .amdhsa_system_sgpr_workgroup_id_x 1
.end_amdhsa_kernel
```
